```python
import torch

def _softmax(x, axis=-1):
    return torch.softmax(x, dim=axis)

def _gelu(x):
    return torch.nn.functional.gelu(x, approximate='tanh')

def _silu(x):
    return torch.nn.functional.silu(x)

def _sigmoid(x):
    return torch.sigmoid(x)

def _layernorm(x, axis=-1, eps=1e-05):
    m = x.mean(dim=axis, keepdim=True)
    v = x.var(dim=axis, keepdim=True, unbiased=False)
    return (x - m) / torch.sqrt(v + eps)

def _scatter_add(tgt, idx, src, axis=0):
    return tgt.clone().index_add_(axis, idx, src)

def _segment_sum(src, seg, n):
    out = torch.zeros((n,) + src.shape[1:], dtype=src.dtype)
    return out.index_add_(0, seg, src)

def _pad(x, pw):
    flat = tuple((v for pair in reversed(pw) for v in pair))
    return torch.nn.functional.pad(x, flat)
kernel_name = 'gated_mix__ssm_conv_s4d__mixer_gmlp__prompt'

def setup_inputs():

    _w = lambda a: (lambda t: t.to(torch.bfloat16) if t.is_floating_point() else t)(torch.as_tensor(a))

    def _A_setup():
        Bsz, L, D, N = (1, 2048, 576, 128)
        return {'u': _w((lambda *s: torch.randn(*s, dtype=torch.bfloat16) * 0.05)(Bsz, L, D)), 'log_A_real': _w((lambda *s: torch.randn(*s, dtype=torch.bfloat16) * 3.2)(D, N) * 0.5), 'A_imag': _w((lambda *s: torch.randn(*s, dtype=torch.bfloat16) * 0.05)(D, N) * 3.14), 'C_real': _w((lambda *s: torch.randn(*s, dtype=torch.bfloat16) * 3.2)(D, N) / N ** 0.5), 'C_imag': _w((lambda *s: torch.randn(*s, dtype=torch.bfloat16) * 3.2)(D, N) / N ** 0.5), 'log_dt': _w((lambda *s: torch.randn(*s, dtype=torch.bfloat16) * 0.05)(D) * 0.5 - 4.0), 'D_skip': _w((lambda *s: torch.randn(*s, dtype=torch.bfloat16) * 0.4)(D))}
    _A_in = _A_setup()

    def _B_setup():
        B, S, D, F = (1, 2048, 576, 4608)
        Fh = F // 2
        return {'x': _w((lambda *s: torch.randn(*s, dtype=torch.bfloat16) * 0.05)(B, S, D)), 'w_in': _w((lambda *s: torch.randn(*s, dtype=torch.bfloat16) * 0.2)(D, 2 * Fh)), 'w_sp': _w(0.01 * (lambda *s: torch.randn(*s, dtype=torch.bfloat16) * 0.2)(S, S)), 'b_sp': _w(1.0 + 0.01 * (lambda *s: torch.randn(*s, dtype=torch.bfloat16) * 0.05)(S)), 'w_out': _w((lambda *s: torch.randn(*s, dtype=torch.bfloat16) * 0.05)(Fh, D))}
    _B_in = _B_setup()
    return {'A_u': _A_in['u'], 'A_log_A_real': _A_in['log_A_real'], 'A_A_imag': _A_in['A_imag'], 'A_C_real': _A_in['C_real'], 'A_C_imag': _A_in['C_imag'], 'A_log_dt': _A_in['log_dt'], 'A_D_skip': _A_in['D_skip'], 'B_x': _B_in['x'], 'B_w_in': _B_in['w_in'], 'B_w_sp': _B_in['w_sp'], 'B_b_sp': _B_in['b_sp'], 'B_w_out': _B_in['w_out'], 'gate_w': _w((lambda *s: torch.randn(*s, dtype=torch.bfloat16) * 0.05)(576) * 16.0)}

def reference(A_u, A_log_A_real, A_A_imag, A_C_real, A_C_imag, A_log_dt, A_D_skip, B_x, B_w_in, B_w_sp, B_b_sp, B_w_out, gate_w):

    def _A_ref(u, log_A_real, A_imag, C_real, C_imag, log_dt, D_skip):
        L = u.shape[1]
        dt = torch.exp(log_dt)
        A = -torch.exp(log_A_real) + 1j * A_imag
        C = (C_real + 1j * C_imag) * dt[:, None]
        pos = (lambda x, dt: x.to(dt))(torch.arange(L), log_dt.dtype)
        P = torch.exp((A * dt[:, None])[:, :, None] * pos[None, None, :])
        K = 2.0 * torch.einsum('dn,dnl->dl', C, P).real
        L2 = 2 * L
        u_t = (lambda x, *d: x.permute(*d))(u, 0, 2, 1)
        Kf = (lambda x, *a, **k: torch.fft.rfft(x.float(), *a, **k))(K, L2)
        Uf = (lambda x, *a, **k: torch.fft.rfft(x.float(), *a, **k))(u_t, L2)
        y = (lambda x, *a, **k: torch.fft.irfft(x, *a, **k).to(torch.bfloat16))(Uf * Kf[None, :, :], L2)[:, :, :L]
        y = (lambda x, *d: x.permute(*d))(y, 0, 2, 1)
        return y + u * D_skip[None, None, :]

    def _B_ref(x, w_in, w_sp, b_sp, w_out):
        B, S, D = x.shape
        F = w_in.shape[-1]
        Fh = F // 2
        z = _gelu(torch.einsum('bsd,df->bsf', x, w_in))
        z1 = z[..., :Fh].clone()
        z2 = _layernorm(z[..., Fh:], axis=-1)
        g = torch.einsum('ts,bsf->btf', w_sp, z2) + b_sp[None, :, None]
        return torch.einsum('bsf,fd->bsd', z1 * g, w_out)
    x = A_u
    g = _sigmoid((x * gate_w).sum(-1, keepdims=True))
    a = _A_ref(x, A_log_A_real, A_A_imag, A_C_real, A_C_imag, A_log_dt, A_D_skip)
    b = _B_ref(x, B_w_in, B_w_sp, B_b_sp, B_w_out)
    return g * a + (1 - g) * b
```

```asm
; @launch grid=(256,1,1) block=(512,1,1) lds=163840
.amdgcn_target "amdgcn-amd-amdhsa--gfx950"
.text
.globl gated_mix__ssm_conv_s4d__mixer_gmlp__prompt_kernel
.p2align 8
.type gated_mix__ssm_conv_s4d__mixer_gmlp__prompt_kernel,@function
gated_mix__ssm_conv_s4d__mixer_gmlp__prompt_kernel:
    s_cmp_ge_u32 s2, 256
    s_cbranch_scc1 gated_mix__ssm_conv_s4d__mixer_gmlp__prompt_kernel_exit
    s_load_dwordx16 s[32:47], s[0:1], 0
    s_load_dwordx16 s[48:63], s[0:1], 64
    v_lshrrev_b32 v1, 6, v0
    s_and_b32 s3, s2, 7
    s_lshr_b32 s30, s2, 3
    v_readfirstlane_b32 s24, v1
    s_and_b32 s64, s3, 3
    s_lshl_b32 s64, s64, 2
    s_and_b32 s65, s30, 3
    s_add_u32 s26, s64, s65
    s_lshr_b32 s64, s3, 2
    s_lshr_b32 s66, s30, 2
    s_lshl_b32 s66, s66, 1
    s_add_u32 s27, s64, s66
    s_lshr_b32 s64, s3, 1
    s_lshl_b32 s64, s64, 3
    s_lshr_b32 s66, s30, 2
    s_add_u32 s28, s64, s66
    s_and_b32 s64, s3, 1
    s_lshl_b32 s64, s64, 2
    s_add_u32 s29, s64, s65
    s_and_b32 s25, s24, 3
    v_and_b32 v0, 63, v0
    s_cmp_ge_u32 s24, 4
    s_cbranch_scc1 gated_mix__ssm_conv_s4d__mixer_gmlp__prompt_kernel_L
    s_getpc_b64 s[64:65]
gated_mix__ssm_conv_s4d__mixer_gmlp__prompt_kernel_pc:
    s_sub_u32 s4, s64, gated_mix__ssm_conv_s4d__mixer_gmlp__prompt_kernel_pc-gated_mix__ssm_conv_s4d__mixer_gmlp__prompt_kernel
    s_subb_u32 s5, s65, 0
    s_mov_b32 s6, gated_mix__ssm_conv_s4d__mixer_gmlp__prompt_kernel_end-gated_mix__ssm_conv_s4d__mixer_gmlp__prompt_kernel
    s_mov_b32 s7, 0x20000
    s_lshl_b32 s66, s30, 2
    s_add_u32 s66, s66, s25
    s_lshl_b32 s66, s66, 10
    v_lshlrev_b32 v1, 4, v0
    buffer_load_dwordx4 v[240:243], v1, s[4:7], s66 offen
    s_lshl_b32 s64, s27, 4
    s_add_u32 s3, s64, s26
    s_lshl_b32 s64, s28, 3
    s_add_u32 s75, s64, s29
    s_lshl_b32 s31, s2, 2
    s_add_u32 s31, s31, s25
    s_lshl_b32 s64, s26, 4
    s_add_u32 s64, s64, s27
    s_lshl_b32 s64, s64, 2
    s_add_u32 s30, s64, s25
    s_waitcnt lgkmcnt(0)
    s_sub_u32 s67, s30, 576
    s_cmp_ge_u32 s26, 9
    s_cselect_b32 s67, s67, s30
    s_lshl_b32 s64, s67, 8
    v_lshlrev_b32 v2, 2, v0
    s_lshl_b32 s65, s67, 1
    v_mov_b32 v3, s65
    s_mov_b32 s4, s34
    s_mov_b32 s5, s35
    s_mov_b32 s6, 147456
    s_mov_b32 s7, 0x20000
    buffer_load_dword v4, v2, s[4:7], s64 offen
    s_mov_b32 s4, s36
    s_mov_b32 s5, s37
    s_mov_b32 s6, 147456
    s_mov_b32 s7, 0x20000
    buffer_load_dword v5, v2, s[4:7], s64 offen
    s_mov_b32 s4, s38
    s_mov_b32 s5, s39
    s_mov_b32 s6, 147456
    s_mov_b32 s7, 0x20000
    buffer_load_dword v6, v2, s[4:7], s64 offen
    s_mov_b32 s4, s40
    s_mov_b32 s5, s41
    s_mov_b32 s6, 147456
    s_mov_b32 s7, 0x20000
    buffer_load_dword v7, v2, s[4:7], s64 offen
    s_mov_b32 s4, s42
    s_mov_b32 s5, s43
    s_mov_b32 s6, 1152
    s_mov_b32 s7, 0x20000
    buffer_load_ushort v8, v3, s[4:7], 0 offen
    s_branch gated_mix__ssm_conv_s4d__mixer_gmlp__prompt_kernel_C
gated_mix__ssm_conv_s4d__mixer_gmlp__prompt_kernel_L:
    v_lshrrev_b32 v195, 3, v0
    v_lshrrev_b32 v196, 4, v0
    v_and_b32 v197, 7, v0
    s_and_b32 s64, s25, 1
    s_lshl_b32 s65, s64, 2
    v_add_u32 v198, s65, v196
    v_xor_b32 v198, v198, v197
    v_lshlrev_b32 v198, 4, v198
    v_lshrrev_b32 v199, 5, v0
    v_lshlrev_b32 v199, 3, v199
    v_and_b32 v200, 3, v195
    v_add_u32 v199, v199, v200
    s_lshl_b32 s65, s64, 4
    s_lshr_b32 s66, s25, 1
    s_lshl_b32 s66, s66, 2
    s_add_u32 s65, s65, s66
    v_add_u32 v199, s65, v199
    v_mul_u32_u24 v199, 1152, v199
    v_add_u32 v192, v199, v198
    v_lshrrev_b32 v196, 4, v0
    s_and_b32 s64, s25, 1
    s_lshl_b32 s65, s64, 2
    v_add_u32 v197, s65, v196
    v_and_b32 v198, 15, v0
    v_lshlrev_b32 v197, 1, v197
    v_xor_b32 v198, v198, v197
    s_lshl_b32 s65, s64, 3
    s_lshr_b32 s66, s25, 1
    s_lshl_b32 s66, s66, 2
    s_add_u32 s65, s65, s66
    v_add_u32 v196, s65, v196
    v_mul_u32_u24 v196, 9216, v196
    v_lshl_add_u32 v193, v198, 4, v196
    s_lshl_b32 s65, s26, 8
    v_add_u32 v193, s65, v193
    v_lshrrev_b32 v196, 1, v0
    v_and_b32 v197, 3, v196
    v_and_b32 v198, 4, v196
    v_lshl_or_b32 v197, v198, 1, v197
    v_and_b32 v198, 8, v196
    v_lshrrev_b32 v198, 1, v198
    v_or_b32 v197, v197, v198
    s_lshl_b32 s65, s25, 4
    v_add_u32 v197, s65, v197
    v_mul_u32_u24 v197, 9216, v197
    v_and_b32 v198, 1, v0
    v_lshl_add_u32 v194, v198, 4, v197
    s_lshl_b32 s64, s26, 5
    s_add_u32 s64, s64, 4096
    v_add_u32 v194, s64, v194
    s_lshl_b32 s68, s25, 10
    s_lshl_b32 s69, s25, 9
    s_add_u32 s69, s69, 16384
    s_mul_i32 s64, s27, 147456
    s_waitcnt lgkmcnt(0)
    s_add_u32 s8, s32, s64
    s_addc_u32 s9, s33, 0
    s_mov_b32 s10, 147456
    s_mov_b32 s11, 0x20000
    s_mov_b32 s12, s48
    s_mov_b32 s13, s49
    s_mov_b32 s14, 5308416
    s_mov_b32 s15, 0x20000
    s_lshr_b32 s74, s27, 1
    s_and_b32 s64, s26, 3
    s_lshl_b32 s64, s64, 1
    s_add_u32 s74, s74, s64
    s_cmp_ge_u32 s74, 9
    s_cselect_b32 s64, 9, 0
    s_sub_u32 s74, s74, s64
    s_sub_u32 s0, s26, s74
    s_cmp_lt_i32 s0, 0
    s_cselect_b32 s64, 9, 0
    s_add_u32 s0, s0, s64
    s_cmp_ge_u32 s26, 9
    s_cselect_b32 s0, 99, s0
    s_mul_i32 s72, s74, 589824
    s_lshl_b32 s73, s74, 7
    s_add_u32 s72, s72, 4608
    s_add_u32 m0, s68, 0
    s_add_u32 s70, s72, 0
    buffer_load_dwordx4 v193, s[12:15], s70 offen lds
    s_add_u32 m0, s68, 18432
    s_add_u32 s71, s73, 0
    buffer_load_dwordx4 v192, s[8:11], s71 offen lds
    s_add_u32 m0, s68, 4096
    s_add_u32 s70, s72, 147456
    buffer_load_dwordx4 v193, s[12:15], s70 offen lds
    s_add_u32 m0, s68, 22528
    s_add_u32 s71, s73, 36864
    buffer_load_dwordx4 v192, s[8:11], s71 offen lds
    s_add_u32 m0, s68, 8192
    s_add_u32 s70, s72, 294912
    buffer_load_dwordx4 v193, s[12:15], s70 offen lds
    s_add_u32 m0, s68, 26624
    s_add_u32 s71, s73, 73728
    buffer_load_dwordx4 v192, s[8:11], s71 offen lds
    s_add_u32 m0, s68, 12288
    s_add_u32 s70, s72, 442368
    buffer_load_dwordx4 v193, s[12:15], s70 offen lds
    s_add_u32 m0, s68, 30720
    s_add_u32 s71, s73, 110592
    buffer_load_dwordx4 v192, s[8:11], s71 offen lds
    s_add_u32 m0, s69, 0
    s_mov_b64 exec, 0xffffffff
    buffer_load_dwordx4 v194, s[12:15], s72 offen lds
    s_mov_b64 exec, -1
    s_add_u32 s74, s74, 1
    s_cmp_eq_u32 s74, 9
    s_cselect_b32 s74, 0, s74
    s_mul_i32 s72, s74, 589824
    s_lshl_b32 s73, s74, 7
    s_add_u32 s72, s72, 4608
    s_add_u32 m0, s68, 34816
    s_add_u32 s70, s72, 0
    buffer_load_dwordx4 v193, s[12:15], s70 offen lds
    s_add_u32 m0, s68, 53248
    s_add_u32 s71, s73, 0
    buffer_load_dwordx4 v192, s[8:11], s71 offen lds
    s_add_u32 m0, s68, 38912
    s_add_u32 s70, s72, 147456
    buffer_load_dwordx4 v193, s[12:15], s70 offen lds
    s_add_u32 m0, s68, 57344
    s_add_u32 s71, s73, 36864
    buffer_load_dwordx4 v192, s[8:11], s71 offen lds
    s_add_u32 m0, s68, 43008
    s_add_u32 s70, s72, 294912
    buffer_load_dwordx4 v193, s[12:15], s70 offen lds
    s_add_u32 m0, s68, 61440
    s_add_u32 s71, s73, 73728
    buffer_load_dwordx4 v192, s[8:11], s71 offen lds
    s_add_u32 m0, s68, 47104
    s_add_u32 s70, s72, 442368
    buffer_load_dwordx4 v193, s[12:15], s70 offen lds
    s_add_u32 m0, s68, 65536
    s_add_u32 s71, s73, 110592
    buffer_load_dwordx4 v192, s[8:11], s71 offen lds
    s_add_u32 m0, s69, 34816
    s_mov_b64 exec, 0xffffffff
    buffer_load_dwordx4 v194, s[12:15], s72 offen lds
    s_mov_b64 exec, -1
    s_add_u32 s74, s74, 1
    s_cmp_eq_u32 s74, 9
    s_cselect_b32 s74, 0, s74
    s_mul_i32 s72, s74, 589824
    s_lshl_b32 s73, s74, 7
    s_add_u32 s72, s72, 4608
    s_add_u32 m0, s68, 69632
    s_add_u32 s70, s72, 0
    buffer_load_dwordx4 v193, s[12:15], s70 offen lds
    s_add_u32 m0, s68, 88064
    s_add_u32 s71, s73, 0
    buffer_load_dwordx4 v192, s[8:11], s71 offen lds
    s_add_u32 m0, s68, 73728
    s_add_u32 s70, s72, 147456
    buffer_load_dwordx4 v193, s[12:15], s70 offen lds
    s_add_u32 m0, s68, 92160
    s_add_u32 s71, s73, 36864
    buffer_load_dwordx4 v192, s[8:11], s71 offen lds
    s_add_u32 m0, s68, 77824
    s_add_u32 s70, s72, 294912
    buffer_load_dwordx4 v193, s[12:15], s70 offen lds
    s_add_u32 m0, s68, 96256
    s_add_u32 s71, s73, 73728
    buffer_load_dwordx4 v192, s[8:11], s71 offen lds
    s_add_u32 m0, s68, 81920
    s_add_u32 s70, s72, 442368
    buffer_load_dwordx4 v193, s[12:15], s70 offen lds
    s_add_u32 m0, s68, 100352
    s_add_u32 s71, s73, 110592
    buffer_load_dwordx4 v192, s[8:11], s71 offen lds
    s_add_u32 m0, s69, 69632
    s_mov_b64 exec, 0xffffffff
    buffer_load_dwordx4 v194, s[12:15], s72 offen lds
    s_mov_b64 exec, -1
    s_add_u32 s74, s74, 1
    s_cmp_eq_u32 s74, 9
    s_cselect_b32 s74, 0, s74
    s_lshl_b32 s64, s27, 4
    s_add_u32 s3, s64, s26
    s_lshl_b32 s64, s28, 3
    s_add_u32 s75, s64, s29
    s_lshl_b32 s31, s2, 2
    s_add_u32 s31, s31, s25
    s_lshl_b32 s64, s26, 4
    s_add_u32 s64, s64, s27
    s_lshl_b32 s64, s64, 2
    s_add_u32 s30, s64, s25
    s_waitcnt vmcnt(18)
    s_barrier
    v_lshrrev_b32 v195, 3, v0
    v_lshrrev_b32 v196, 4, v0
    v_and_b32 v197, 7, v0
    s_and_b32 s64, s25, 1
    s_lshl_b32 s65, s64, 2
    v_add_u32 v198, s65, v196
    v_xor_b32 v198, v198, v197
    v_lshlrev_b32 v198, 4, v198
    v_lshrrev_b32 v199, 5, v0
    v_lshlrev_b32 v199, 3, v199
    v_and_b32 v200, 3, v195
    v_add_u32 v199, v199, v200
    s_lshl_b32 s65, s64, 4
    s_lshr_b32 s66, s25, 1
    s_lshl_b32 s66, s66, 2
    s_add_u32 s65, s65, s66
    v_add_u32 v199, s65, v199
    v_mul_u32_u24 v199, 4096, v199
    v_add_u32 v250, v199, v198
    v_lshlrev_b32 v251, 4, v0
    s_lshl_b32 s64, s27, 19
    s_add_u32 s16, s50, s64
    s_addc_u32 s17, s51, 0
    s_mov_b32 s18, 524288
    s_mov_b32 s19, 0x20000
    s_mul_i32 s64, s26, 589824
    s_add_u32 s64, s64, 9437184
    s_add_u32 s20, s62, s64
    s_addc_u32 s21, s63, 0
    s_mov_b32 s22, 589824
    s_mov_b32 s23, 0x20000
    s_lshl_b32 s67, s25, 12
    v_and_b32 v195, 15, v0
    v_lshrrev_b32 v196, 4, v0
    v_lshrrev_b32 v197, 2, v195
    v_lshl_add_u32 v198, v196, 2, v197
    v_lshrrev_b32 v199, 1, v198
    s_and_b32 s64, s25, 1
    s_lshl_b32 s64, s64, 2
    v_xor_b32 v199, s64, v199
    v_lshlrev_b32 v199, 4, v199
    v_lshl_add_u32 v199, v198, 7, v199
    v_and_b32 v200, 1, v0
    v_lshl_add_u32 v199, v200, 3, v199
    v_bfe_u32 v200, v0, 1, 1
    v_lshl_add_u32 v199, v200, 12, v199
    s_and_b32 s64, s0, 3
    s_mul_i32 s64, s64, 34816
    s_lshr_b32 s65, s25, 1
    s_lshl_b32 s65, s65, 13
    s_add_u32 s64, s64, s65
    s_add_u32 s64, s64, 18432
    v_add_u32 v203, s64, v199
    v_and_b32 v204, 7, v0
    v_lshlrev_b32 v204, 12, v204
    v_lshl_add_u32 v204, v196, 4, v204
    v_bfe_u32 v200, v0, 3, 1
    v_lshl_add_u32 v204, v200, 6, v204
    s_cmp_lg_u32 s0, 0
    s_cbranch_scc1 gated_mix__ssm_conv_s4d__mixer_gmlp__prompt_kernel_Lut0
    s_getpc_b64 s[64:65]
gated_mix__ssm_conv_s4d__mixer_gmlp__prompt_kernel_Lpc0:
    s_add_u32 s64, s64, gated_mix__ssm_conv_s4d__mixer_gmlp__prompt_kernel_Lutf-gated_mix__ssm_conv_s4d__mixer_gmlp__prompt_kernel_Lpc0
    s_addc_u32 s65, s65, 0
    s_swappc_b64 s[70:71], s[64:65]
gated_mix__ssm_conv_s4d__mixer_gmlp__prompt_kernel_Lut0:
    s_waitcnt vmcnt(9)
    s_barrier
    s_mul_i32 s72, s74, 589824
    s_lshl_b32 s73, s74, 7
    s_add_u32 s72, s72, 4608
    s_add_u32 m0, s68, 104448
    s_add_u32 s70, s72, 0
    buffer_load_dwordx4 v193, s[12:15], s70 offen lds
    s_add_u32 m0, s68, 122880
    s_add_u32 s71, s73, 0
    buffer_load_dwordx4 v192, s[8:11], s71 offen lds
    s_add_u32 m0, s68, 108544
    s_add_u32 s70, s72, 147456
    buffer_load_dwordx4 v193, s[12:15], s70 offen lds
    s_add_u32 m0, s68, 126976
    s_add_u32 s71, s73, 36864
    buffer_load_dwordx4 v192, s[8:11], s71 offen lds
    s_add_u32 m0, s68, 112640
    s_add_u32 s70, s72, 294912
    buffer_load_dwordx4 v193, s[12:15], s70 offen lds
    s_add_u32 m0, s68, 131072
    s_add_u32 s71, s73, 73728
    buffer_load_dwordx4 v192, s[8:11], s71 offen lds
    s_add_u32 m0, s68, 116736
    s_add_u32 s70, s72, 442368
    buffer_load_dwordx4 v193, s[12:15], s70 offen lds
    s_add_u32 m0, s68, 135168
    s_add_u32 s71, s73, 110592
    buffer_load_dwordx4 v192, s[8:11], s71 offen lds
    s_add_u32 m0, s69, 104448
    s_mov_b64 exec, 0xffffffff
    buffer_load_dwordx4 v194, s[12:15], s72 offen lds
    s_mov_b64 exec, -1
    s_add_u32 s74, s74, 1
    s_cmp_eq_u32 s74, 9
    s_cselect_b32 s74, 0, s74
    s_mul_i32 s72, s74, 589824
    s_lshl_b32 s73, s74, 7
    s_add_u32 s72, s72, 4608
    s_add_u32 m0, s68, 0
    s_add_u32 s70, s72, 0
    buffer_load_dwordx4 v193, s[12:15], s70 offen lds
    s_add_u32 m0, s68, 18432
    s_add_u32 s71, s73, 0
    buffer_load_dwordx4 v192, s[8:11], s71 offen lds
    s_add_u32 m0, s68, 4096
    s_add_u32 s70, s72, 147456
    buffer_load_dwordx4 v193, s[12:15], s70 offen lds
    s_add_u32 m0, s68, 22528
    s_add_u32 s71, s73, 36864
    buffer_load_dwordx4 v192, s[8:11], s71 offen lds
    s_add_u32 m0, s68, 8192
    s_add_u32 s70, s72, 294912
    buffer_load_dwordx4 v193, s[12:15], s70 offen lds
    s_add_u32 m0, s68, 26624
    s_add_u32 s71, s73, 73728
    buffer_load_dwordx4 v192, s[8:11], s71 offen lds
    s_add_u32 m0, s68, 12288
    s_add_u32 s70, s72, 442368
    buffer_load_dwordx4 v193, s[12:15], s70 offen lds
    s_add_u32 m0, s68, 30720
    s_add_u32 s71, s73, 110592
    buffer_load_dwordx4 v192, s[8:11], s71 offen lds
    s_add_u32 m0, s69, 0
    s_mov_b64 exec, 0xffffffff
    buffer_load_dwordx4 v194, s[12:15], s72 offen lds
    s_mov_b64 exec, -1
    s_add_u32 s74, s74, 1
    s_cmp_eq_u32 s74, 9
    s_cselect_b32 s74, 0, s74
    s_cmp_lg_u32 s0, 1
    s_cbranch_scc1 gated_mix__ssm_conv_s4d__mixer_gmlp__prompt_kernel_Lut1
    s_getpc_b64 s[64:65]
gated_mix__ssm_conv_s4d__mixer_gmlp__prompt_kernel_Lpc1:
    s_add_u32 s64, s64, gated_mix__ssm_conv_s4d__mixer_gmlp__prompt_kernel_Lutf-gated_mix__ssm_conv_s4d__mixer_gmlp__prompt_kernel_Lpc1
    s_addc_u32 s65, s65, 0
    s_swappc_b64 s[70:71], s[64:65]
gated_mix__ssm_conv_s4d__mixer_gmlp__prompt_kernel_Lut1:
    s_cmp_lg_u32 s25, 0
    s_cbranch_scc1 gated_mix__ssm_conv_s4d__mixer_gmlp__prompt_kernel_Lns0
    s_and_b32 s66, s2, 15
    s_lshl_b32 s66, s66, 2
    s_add_u32 s66, s66, 64
    s_mov_b32 s65, 1
    s_atomic_add s65, s[60:61], s66
gated_mix__ssm_conv_s4d__mixer_gmlp__prompt_kernel_Lns0:
    s_waitcnt vmcnt(18)
    s_barrier
    s_mul_i32 s72, s74, 589824
    s_lshl_b32 s73, s74, 7
    s_add_u32 s72, s72, 4608
    s_add_u32 m0, s68, 34816
    s_add_u32 s70, s72, 0
    buffer_load_dwordx4 v193, s[12:15], s70 offen lds
    s_add_u32 m0, s68, 53248
    s_add_u32 s71, s73, 0
    buffer_load_dwordx4 v192, s[8:11], s71 offen lds
    s_add_u32 m0, s68, 38912
    s_add_u32 s70, s72, 147456
    buffer_load_dwordx4 v193, s[12:15], s70 offen lds
    s_add_u32 m0, s68, 57344
    s_add_u32 s71, s73, 36864
    buffer_load_dwordx4 v192, s[8:11], s71 offen lds
    s_add_u32 m0, s68, 43008
    s_add_u32 s70, s72, 294912
    buffer_load_dwordx4 v193, s[12:15], s70 offen lds
    s_add_u32 m0, s68, 61440
    s_add_u32 s71, s73, 73728
    buffer_load_dwordx4 v192, s[8:11], s71 offen lds
    s_add_u32 m0, s68, 47104
    s_add_u32 s70, s72, 442368
    buffer_load_dwordx4 v193, s[12:15], s70 offen lds
    s_add_u32 m0, s68, 65536
    s_add_u32 s71, s73, 110592
    buffer_load_dwordx4 v192, s[8:11], s71 offen lds
    s_add_u32 m0, s69, 34816
    s_mov_b64 exec, 0xffffffff
    buffer_load_dwordx4 v194, s[12:15], s72 offen lds
    s_mov_b64 exec, -1
    s_add_u32 s74, s74, 1
    s_cmp_eq_u32 s74, 9
    s_cselect_b32 s74, 0, s74
    s_cmp_lg_u32 s0, 2
    s_cbranch_scc1 gated_mix__ssm_conv_s4d__mixer_gmlp__prompt_kernel_Lut2
    s_getpc_b64 s[64:65]
gated_mix__ssm_conv_s4d__mixer_gmlp__prompt_kernel_Lpc2:
    s_add_u32 s64, s64, gated_mix__ssm_conv_s4d__mixer_gmlp__prompt_kernel_Lutf-gated_mix__ssm_conv_s4d__mixer_gmlp__prompt_kernel_Lpc2
    s_addc_u32 s65, s65, 0
    s_swappc_b64 s[70:71], s[64:65]
gated_mix__ssm_conv_s4d__mixer_gmlp__prompt_kernel_Lut2:
    s_waitcnt vmcnt(18)
    s_barrier
    s_mul_i32 s72, s74, 589824
    s_lshl_b32 s73, s74, 7
    s_add_u32 s72, s72, 4608
    s_add_u32 m0, s68, 69632
    s_add_u32 s70, s72, 0
    buffer_load_dwordx4 v193, s[12:15], s70 offen lds
    s_add_u32 m0, s68, 88064
    s_add_u32 s71, s73, 0
    buffer_load_dwordx4 v192, s[8:11], s71 offen lds
    s_add_u32 m0, s68, 73728
    s_add_u32 s70, s72, 147456
    buffer_load_dwordx4 v193, s[12:15], s70 offen lds
    s_add_u32 m0, s68, 92160
    s_add_u32 s71, s73, 36864
    buffer_load_dwordx4 v192, s[8:11], s71 offen lds
    s_add_u32 m0, s68, 77824
    s_add_u32 s70, s72, 294912
    buffer_load_dwordx4 v193, s[12:15], s70 offen lds
    s_add_u32 m0, s68, 96256
    s_add_u32 s71, s73, 73728
    buffer_load_dwordx4 v192, s[8:11], s71 offen lds
    s_add_u32 m0, s68, 81920
    s_add_u32 s70, s72, 442368
    buffer_load_dwordx4 v193, s[12:15], s70 offen lds
    s_add_u32 m0, s68, 100352
    s_add_u32 s71, s73, 110592
    buffer_load_dwordx4 v192, s[8:11], s71 offen lds
    s_add_u32 m0, s69, 69632
    s_mov_b64 exec, 0xffffffff
    buffer_load_dwordx4 v194, s[12:15], s72 offen lds
    s_mov_b64 exec, -1
    s_add_u32 s74, s74, 1
    s_cmp_eq_u32 s74, 9
    s_cselect_b32 s74, 0, s74
    s_cmp_lg_u32 s0, 3
    s_cbranch_scc1 gated_mix__ssm_conv_s4d__mixer_gmlp__prompt_kernel_Lut3
    s_getpc_b64 s[64:65]
gated_mix__ssm_conv_s4d__mixer_gmlp__prompt_kernel_Lpc3:
    s_add_u32 s64, s64, gated_mix__ssm_conv_s4d__mixer_gmlp__prompt_kernel_Lutf-gated_mix__ssm_conv_s4d__mixer_gmlp__prompt_kernel_Lpc3
    s_addc_u32 s65, s65, 0
    s_swappc_b64 s[70:71], s[64:65]
gated_mix__ssm_conv_s4d__mixer_gmlp__prompt_kernel_Lut3:
    s_waitcnt vmcnt(18)
    s_barrier
    s_mul_i32 s72, s74, 589824
    s_lshl_b32 s73, s74, 7
    s_add_u32 s72, s72, 4608
    s_add_u32 m0, s68, 104448
    s_add_u32 s70, s72, 0
    buffer_load_dwordx4 v193, s[12:15], s70 offen lds
    s_add_u32 m0, s68, 122880
    s_add_u32 s71, s73, 0
    buffer_load_dwordx4 v192, s[8:11], s71 offen lds
    s_add_u32 m0, s68, 108544
    s_add_u32 s70, s72, 147456
    buffer_load_dwordx4 v193, s[12:15], s70 offen lds
    s_add_u32 m0, s68, 126976
    s_add_u32 s71, s73, 36864
    buffer_load_dwordx4 v192, s[8:11], s71 offen lds
    s_add_u32 m0, s68, 112640
    s_add_u32 s70, s72, 294912
    buffer_load_dwordx4 v193, s[12:15], s70 offen lds
    s_add_u32 m0, s68, 131072
    s_add_u32 s71, s73, 73728
    buffer_load_dwordx4 v192, s[8:11], s71 offen lds
    s_add_u32 m0, s68, 116736
    s_add_u32 s70, s72, 442368
    buffer_load_dwordx4 v193, s[12:15], s70 offen lds
    s_add_u32 m0, s68, 135168
    s_add_u32 s71, s73, 110592
    buffer_load_dwordx4 v192, s[8:11], s71 offen lds
    s_add_u32 m0, s69, 104448
    s_mov_b64 exec, 0xffffffff
    buffer_load_dwordx4 v194, s[12:15], s72 offen lds
    s_mov_b64 exec, -1
    s_add_u32 s74, s74, 1
    s_cmp_eq_u32 s74, 9
    s_cselect_b32 s74, 0, s74
    s_cmp_lg_u32 s0, 4
    s_cbranch_scc1 gated_mix__ssm_conv_s4d__mixer_gmlp__prompt_kernel_Lut4
    s_getpc_b64 s[64:65]
gated_mix__ssm_conv_s4d__mixer_gmlp__prompt_kernel_Lpc4:
    s_add_u32 s64, s64, gated_mix__ssm_conv_s4d__mixer_gmlp__prompt_kernel_Lutf-gated_mix__ssm_conv_s4d__mixer_gmlp__prompt_kernel_Lpc4
    s_addc_u32 s65, s65, 0
    s_swappc_b64 s[70:71], s[64:65]
gated_mix__ssm_conv_s4d__mixer_gmlp__prompt_kernel_Lut4:
    s_waitcnt vmcnt(18)
    s_barrier
    s_mul_i32 s72, s74, 589824
    s_lshl_b32 s73, s74, 7
    s_add_u32 s72, s72, 4608
    s_add_u32 m0, s68, 0
    s_add_u32 s70, s72, 0
    buffer_load_dwordx4 v193, s[12:15], s70 offen lds
    s_add_u32 m0, s68, 18432
    s_add_u32 s71, s73, 0
    buffer_load_dwordx4 v192, s[8:11], s71 offen lds
    s_add_u32 m0, s68, 4096
    s_add_u32 s70, s72, 147456
    buffer_load_dwordx4 v193, s[12:15], s70 offen lds
    s_add_u32 m0, s68, 22528
    s_add_u32 s71, s73, 36864
    buffer_load_dwordx4 v192, s[8:11], s71 offen lds
    s_add_u32 m0, s68, 8192
    s_add_u32 s70, s72, 294912
    buffer_load_dwordx4 v193, s[12:15], s70 offen lds
    s_add_u32 m0, s68, 26624
    s_add_u32 s71, s73, 73728
    buffer_load_dwordx4 v192, s[8:11], s71 offen lds
    s_add_u32 m0, s68, 12288
    s_add_u32 s70, s72, 442368
    buffer_load_dwordx4 v193, s[12:15], s70 offen lds
    s_add_u32 m0, s68, 30720
    s_add_u32 s71, s73, 110592
    buffer_load_dwordx4 v192, s[8:11], s71 offen lds
    s_add_u32 m0, s69, 0
    s_mov_b64 exec, 0xffffffff
    buffer_load_dwordx4 v194, s[12:15], s72 offen lds
    s_mov_b64 exec, -1
    s_add_u32 s74, s74, 1
    s_cmp_eq_u32 s74, 9
    s_cselect_b32 s74, 0, s74
    s_cmp_lg_u32 s0, 5
    s_cbranch_scc1 gated_mix__ssm_conv_s4d__mixer_gmlp__prompt_kernel_Lut5
    s_getpc_b64 s[64:65]
gated_mix__ssm_conv_s4d__mixer_gmlp__prompt_kernel_Lpc5:
    s_add_u32 s64, s64, gated_mix__ssm_conv_s4d__mixer_gmlp__prompt_kernel_Lutf-gated_mix__ssm_conv_s4d__mixer_gmlp__prompt_kernel_Lpc5
    s_addc_u32 s65, s65, 0
    s_swappc_b64 s[70:71], s[64:65]
gated_mix__ssm_conv_s4d__mixer_gmlp__prompt_kernel_Lut5:
    s_waitcnt vmcnt(18)
    s_barrier
    s_mul_i32 s72, s74, 589824
    s_lshl_b32 s73, s74, 7
    s_add_u32 m0, s68, 34816
    s_add_u32 s70, s72, 0
    buffer_load_dwordx4 v193, s[12:15], s70 offen lds
    s_add_u32 m0, s68, 53248
    s_add_u32 s71, s73, 0
    buffer_load_dwordx4 v192, s[8:11], s71 offen lds
    s_add_u32 m0, s68, 38912
    s_add_u32 s70, s72, 147456
    buffer_load_dwordx4 v193, s[12:15], s70 offen lds
    s_add_u32 m0, s68, 57344
    s_add_u32 s71, s73, 36864
    buffer_load_dwordx4 v192, s[8:11], s71 offen lds
    s_add_u32 m0, s68, 43008
    s_add_u32 s70, s72, 294912
    buffer_load_dwordx4 v193, s[12:15], s70 offen lds
    s_add_u32 m0, s68, 61440
    s_add_u32 s71, s73, 73728
    buffer_load_dwordx4 v192, s[8:11], s71 offen lds
    s_add_u32 m0, s68, 47104
    s_add_u32 s70, s72, 442368
    buffer_load_dwordx4 v193, s[12:15], s70 offen lds
    s_add_u32 m0, s68, 65536
    s_add_u32 s71, s73, 110592
    buffer_load_dwordx4 v192, s[8:11], s71 offen lds
    s_add_u32 m0, s69, 34816
    s_mov_b64 exec, 0xffffffff
    buffer_load_dwordx4 v194, s[12:15], s72 offen lds
    s_mov_b64 exec, -1
    s_add_u32 s74, s74, 1
    s_cmp_eq_u32 s74, 9
    s_cselect_b32 s74, 0, s74
    s_cmp_lg_u32 s0, 6
    s_cbranch_scc1 gated_mix__ssm_conv_s4d__mixer_gmlp__prompt_kernel_Lut6
    s_getpc_b64 s[64:65]
gated_mix__ssm_conv_s4d__mixer_gmlp__prompt_kernel_Lpc6:
    s_add_u32 s64, s64, gated_mix__ssm_conv_s4d__mixer_gmlp__prompt_kernel_Lutf-gated_mix__ssm_conv_s4d__mixer_gmlp__prompt_kernel_Lpc6
    s_addc_u32 s65, s65, 0
    s_swappc_b64 s[70:71], s[64:65]
gated_mix__ssm_conv_s4d__mixer_gmlp__prompt_kernel_Lut6:
    s_waitcnt vmcnt(18)
    s_barrier
    s_mul_i32 s72, s74, 589824
    s_lshl_b32 s73, s74, 7
    s_add_u32 m0, s68, 69632
    s_add_u32 s70, s72, 0
    buffer_load_dwordx4 v193, s[12:15], s70 offen lds
    s_add_u32 m0, s68, 88064
    s_add_u32 s71, s73, 0
    buffer_load_dwordx4 v192, s[8:11], s71 offen lds
    s_add_u32 m0, s68, 73728
    s_add_u32 s70, s72, 147456
    buffer_load_dwordx4 v193, s[12:15], s70 offen lds
    s_add_u32 m0, s68, 92160
    s_add_u32 s71, s73, 36864
    buffer_load_dwordx4 v192, s[8:11], s71 offen lds
    s_add_u32 m0, s68, 77824
    s_add_u32 s70, s72, 294912
    buffer_load_dwordx4 v193, s[12:15], s70 offen lds
    s_add_u32 m0, s68, 96256
    s_add_u32 s71, s73, 73728
    buffer_load_dwordx4 v192, s[8:11], s71 offen lds
    s_add_u32 m0, s68, 81920
    s_add_u32 s70, s72, 442368
    buffer_load_dwordx4 v193, s[12:15], s70 offen lds
    s_add_u32 m0, s68, 100352
    s_add_u32 s71, s73, 110592
    buffer_load_dwordx4 v192, s[8:11], s71 offen lds
    s_add_u32 m0, s69, 69632
    s_mov_b64 exec, 0xffffffff
    buffer_load_dwordx4 v194, s[12:15], s72 offen lds
    s_mov_b64 exec, -1
    s_add_u32 s74, s74, 1
    s_cmp_eq_u32 s74, 9
    s_cselect_b32 s74, 0, s74
    s_cmp_lg_u32 s0, 7
    s_cbranch_scc1 gated_mix__ssm_conv_s4d__mixer_gmlp__prompt_kernel_Lut7
    s_getpc_b64 s[64:65]
gated_mix__ssm_conv_s4d__mixer_gmlp__prompt_kernel_Lpc7:
    s_add_u32 s64, s64, gated_mix__ssm_conv_s4d__mixer_gmlp__prompt_kernel_Lutf-gated_mix__ssm_conv_s4d__mixer_gmlp__prompt_kernel_Lpc7
    s_addc_u32 s65, s65, 0
    s_swappc_b64 s[70:71], s[64:65]
gated_mix__ssm_conv_s4d__mixer_gmlp__prompt_kernel_Lut7:
    s_waitcnt vmcnt(18)
    s_barrier
    s_mul_i32 s72, s74, 589824
    s_lshl_b32 s73, s74, 7
    s_add_u32 m0, s68, 104448
    s_add_u32 s70, s72, 0
    buffer_load_dwordx4 v193, s[12:15], s70 offen lds
    s_add_u32 m0, s68, 122880
    s_add_u32 s71, s73, 0
    buffer_load_dwordx4 v192, s[8:11], s71 offen lds
    s_add_u32 m0, s68, 108544
    s_add_u32 s70, s72, 147456
    buffer_load_dwordx4 v193, s[12:15], s70 offen lds
    s_add_u32 m0, s68, 126976
    s_add_u32 s71, s73, 36864
    buffer_load_dwordx4 v192, s[8:11], s71 offen lds
    s_add_u32 m0, s68, 112640
    s_add_u32 s70, s72, 294912
    buffer_load_dwordx4 v193, s[12:15], s70 offen lds
    s_add_u32 m0, s68, 131072
    s_add_u32 s71, s73, 73728
    buffer_load_dwordx4 v192, s[8:11], s71 offen lds
    s_add_u32 m0, s68, 116736
    s_add_u32 s70, s72, 442368
    buffer_load_dwordx4 v193, s[12:15], s70 offen lds
    s_add_u32 m0, s68, 135168
    s_add_u32 s71, s73, 110592
    buffer_load_dwordx4 v192, s[8:11], s71 offen lds
    s_add_u32 m0, s69, 104448
    s_mov_b64 exec, 0xffffffff
    buffer_load_dwordx4 v194, s[12:15], s72 offen lds
    s_mov_b64 exec, -1
    s_add_u32 s74, s74, 1
    s_cmp_eq_u32 s74, 9
    s_cselect_b32 s74, 0, s74
    s_cmp_lg_u32 s0, 8
    s_cbranch_scc1 gated_mix__ssm_conv_s4d__mixer_gmlp__prompt_kernel_Lut8
    s_getpc_b64 s[64:65]
gated_mix__ssm_conv_s4d__mixer_gmlp__prompt_kernel_Lpc8:
    s_add_u32 s64, s64, gated_mix__ssm_conv_s4d__mixer_gmlp__prompt_kernel_Lutf-gated_mix__ssm_conv_s4d__mixer_gmlp__prompt_kernel_Lpc8
    s_addc_u32 s65, s65, 0
    s_swappc_b64 s[70:71], s[64:65]
gated_mix__ssm_conv_s4d__mixer_gmlp__prompt_kernel_Lut8:
    v_add_u32 v198, 0, v0
    v_mul_u32_u24 v199, 7282, v198
    v_lshrrev_b32 v199, 16, v199
    v_mul_u32_u24 v200, 9, v199
    v_sub_u32 v200, v198, v200
    v_mul_u32_u24 v199, 1152, v199
    v_lshl_add_u32 v230, v200, 4, v199
    v_add_u32 v198, 64, v0
    v_mul_u32_u24 v199, 7282, v198
    v_lshrrev_b32 v199, 16, v199
    v_mul_u32_u24 v200, 9, v199
    v_sub_u32 v200, v198, v200
    v_mul_u32_u24 v199, 1152, v199
    v_lshl_add_u32 v231, v200, 4, v199
    v_add_u32 v198, 128, v0
    v_mul_u32_u24 v199, 7282, v198
    v_lshrrev_b32 v199, 16, v199
    v_mul_u32_u24 v200, 9, v199
    v_sub_u32 v200, v198, v200
    v_mul_u32_u24 v199, 1152, v199
    v_lshl_add_u32 v232, v200, 4, v199
    v_add_u32 v198, 192, v0
    v_mul_u32_u24 v199, 7282, v198
    v_lshrrev_b32 v199, 16, v199
    v_mul_u32_u24 v200, 9, v199
    v_sub_u32 v200, v198, v200
    v_mul_u32_u24 v199, 1152, v199
    v_lshl_add_u32 v233, v200, 4, v199
    v_add_u32 v198, 256, v0
    v_mul_u32_u24 v199, 7282, v198
    v_lshrrev_b32 v199, 16, v199
    v_mul_u32_u24 v200, 9, v199
    v_sub_u32 v200, v198, v200
    v_mul_u32_u24 v199, 1152, v199
    v_lshl_add_u32 v234, v200, 4, v199
    s_sub_u32 s65, s30, 576
    s_lshr_b32 s1, s65, 2
    s_cmp_ge_u32 s1, 72
    s_cbranch_scc1 gated_mix__ssm_conv_s4d__mixer_gmlp__prompt_kernel_sj1
    s_mul_i32 s64, s1, 57
    s_lshr_b32 s64, s64, 9
    s_mul_i32 s66, s64, 9
    s_sub_u32 s66, s1, s66
    s_lshl_b32 s66, s66, 2
    s_add_u32 s66, s66, s25
    s_lshl_b32 s66, s66, 1
    s_mul_i32 s24, s64, 72
    s_add_u32 s24, s24, s66
    s_mul_i32 s0, s66, 36864
    s_mul_i32 s64, s64, 144
    s_add_u32 s0, s0, s64
    s_mul_i32 s31, s25, 4800
    s_add_u32 s31, s31, 140288
    s_mov_b32 s4, s54
    s_mov_b32 s5, s55
    s_mov_b32 s6, 2654208
    s_mov_b32 s7, 0x20000
    s_add_u32 m0, s31, 0
    s_nop 0
    buffer_load_dwordx4 v230, s[4:7], s0 offen lds
    s_add_u32 m0, s31, 1024
    s_nop 0
    buffer_load_dwordx4 v231, s[4:7], s0 offen lds
    s_add_u32 m0, s31, 2048
    s_nop 0
    buffer_load_dwordx4 v232, s[4:7], s0 offen lds
    s_add_u32 m0, s31, 3072
    s_nop 0
    buffer_load_dwordx4 v233, s[4:7], s0 offen lds
    s_add_u32 m0, s31, 4096
    s_mov_b64 exec, 0xffffffff
    buffer_load_dwordx4 v234, s[4:7], s0 offen lds
    s_mov_b64 exec, -1
gated_mix__ssm_conv_s4d__mixer_gmlp__prompt_kernel_sj1:
    s_waitcnt vmcnt(18)
    s_barrier
    s_mul_i32 s72, s74, 589824
    s_lshl_b32 s73, s74, 7
    s_add_u32 m0, s68, 0
    s_add_u32 s70, s72, 0
    buffer_load_dwordx4 v193, s[12:15], s70 offen lds
    s_add_u32 m0, s68, 18432
    s_add_u32 s71, s73, 0
    buffer_load_dwordx4 v192, s[8:11], s71 offen lds
    s_add_u32 m0, s68, 4096
    s_add_u32 s70, s72, 147456
    buffer_load_dwordx4 v193, s[12:15], s70 offen lds
    s_add_u32 m0, s68, 22528
    s_add_u32 s71, s73, 36864
    buffer_load_dwordx4 v192, s[8:11], s71 offen lds
    s_add_u32 m0, s68, 8192
    s_add_u32 s70, s72, 294912
    buffer_load_dwordx4 v193, s[12:15], s70 offen lds
    s_add_u32 m0, s68, 26624
    s_add_u32 s71, s73, 73728
    buffer_load_dwordx4 v192, s[8:11], s71 offen lds
    s_add_u32 m0, s68, 12288
    s_add_u32 s70, s72, 442368
    buffer_load_dwordx4 v193, s[12:15], s70 offen lds
    s_add_u32 m0, s68, 30720
    s_add_u32 s71, s73, 110592
    buffer_load_dwordx4 v192, s[8:11], s71 offen lds
    s_add_u32 m0, s69, 0
    s_mov_b64 exec, 0xffffffff
    buffer_load_dwordx4 v194, s[12:15], s72 offen lds
    s_mov_b64 exec, -1
    s_add_u32 s74, s74, 1
    s_cmp_eq_u32 s74, 9
    s_cselect_b32 s74, 0, s74
    s_mov_b32 s4, s60
    s_mov_b32 s5, s61
    s_mov_b32 s6, 256
    s_mov_b32 s7, 0x20000
    v_and_b32 v195, 15, v0
    v_lshlrev_b32 v195, 2, v195
    s_mov_b32 s65, 0
gated_mix__ssm_conv_s4d__mixer_gmlp__prompt_kernel_Li_poll:
    buffer_load_dword v196, v195, s[4:7], 0 offen offset:64 sc1
    s_waitcnt vmcnt(0)
    v_cmp_le_u32 vcc, 16, v196
    s_add_u32 s65, s65, 1
    s_cmp_eq_u32 vcc_lo, -1
    s_cbranch_scc1 gated_mix__ssm_conv_s4d__mixer_gmlp__prompt_kernel_Li_ok
    s_sleep 16
    s_cmp_lt_u32 s65, 30000
    s_cbranch_scc1 gated_mix__ssm_conv_s4d__mixer_gmlp__prompt_kernel_Li_poll
gated_mix__ssm_conv_s4d__mixer_gmlp__prompt_kernel_Li_ok:
    s_cmp_ge_u32 s26, 9
    s_cbranch_scc1 gated_mix__ssm_conv_s4d__mixer_gmlp__prompt_kernel_Lus
    s_lshl_b32 s64, s26, 18
    s_lshl_b32 s65, s27, 8
    s_add_u32 s64, s64, s65
    s_lshr_b32 s65, s25, 1
    s_lshl_b32 s65, s65, 7
    s_add_u32 s64, s64, s65
    s_and_b32 s65, s25, 1
    s_lshl_b32 s65, s65, 17
    s_add_u32 s64, s64, s65
    s_add_u32 s64, s64, 37748736
    s_add_u32 s4, s62, s64
    s_addc_u32 s5, s63, 0
    s_mov_b32 s6, 127104
    s_mov_b32 s7, 0x20000
    s_mov_b32 s64, 0
    buffer_store_dwordx4 v[160:163], v204, s[4:7], s64 offen sc1
    s_mov_b32 s64, 32768
    buffer_store_dwordx4 v[164:167], v204, s[4:7], s64 offen sc1
    s_mov_b32 s64, 65536
    buffer_store_dwordx4 v[168:171], v204, s[4:7], s64 offen sc1
    s_mov_b32 s64, 98304
    buffer_store_dwordx4 v[172:175], v204, s[4:7], s64 offen sc1
gated_mix__ssm_conv_s4d__mixer_gmlp__prompt_kernel_Lus:
    s_sub_u32 s65, s30, 576
    s_cmp_ge_u32 s65, 288
    s_cbranch_scc1 gated_mix__ssm_conv_s4d__mixer_gmlp__prompt_kernel_sj20
    v_lshrrev_b32 v195, 2, v0
    v_mul_u32_u24 v195, 144, v195
    v_and_b32 v196, 3, v0
    v_lshl_add_u32 v197, v196, 4, v195
    v_add_u32 v197, s31, v197
    v_lshl_add_u32 v198, v196, 3, v195
    v_add_u32 v198, s31, v198
    v_lshlrev_b32 v199, 4, v0
    v_and_b32 v200, 7, v0
    v_lshrrev_b32 v203, 4, v0
    v_lshl_add_u32 v200, v203, 3, v200
    v_lshlrev_b32 v200, 4, v200
    v_add_u32 v200, 4096, v200
    ds_read_b64_tr_b16 v[206:207], v197 offset:0
    ds_read_b64_tr_b16 v[208:209], v197 offset:2304
    ds_read_b64_tr_b16 v[210:211], v197 offset:8
    ds_read_b64_tr_b16 v[212:213], v197 offset:2312
    ds_read_b64_tr_b16 v[214:215], v197 offset:64
    ds_read_b64_tr_b16 v[216:217], v197 offset:2368
    ds_read_b64_tr_b16 v[218:219], v197 offset:72
    ds_read_b64_tr_b16 v[220:221], v197 offset:2376
    ds_read_b64_tr_b16 v[222:223], v198 offset:128
    ds_read_b64_tr_b16 v[224:225], v198 offset:2432
    s_waitcnt lgkmcnt(0)
    s_mov_b32 s4, s54
    s_mov_b32 s5, s55
    s_mov_b32 s6, 2654208
    s_mov_b32 s7, 0x20000
    s_add_u32 s0, s0, 36864
    s_add_u32 m0, s31, 0
    s_nop 0
    buffer_load_dwordx4 v230, s[4:7], s0 offen lds
    s_add_u32 m0, s31, 1024
    s_nop 0
    buffer_load_dwordx4 v231, s[4:7], s0 offen lds
    s_add_u32 m0, s31, 2048
    s_nop 0
    buffer_load_dwordx4 v232, s[4:7], s0 offen lds
    s_add_u32 m0, s31, 3072
    s_nop 0
    buffer_load_dwordx4 v233, s[4:7], s0 offen lds
    s_add_u32 m0, s31, 4096
    s_mov_b64 exec, 0xffffffff
    buffer_load_dwordx4 v234, s[4:7], s0 offen lds
    s_mov_b64 exec, -1
    s_mul_i32 s64, s24, 4608
    s_add_u32 s64, s64, 31457280
    s_add_u32 s4, s62, s64
    s_addc_u32 s5, s63, 0
    s_mov_b32 s6, 4608
    s_mov_b32 s7, 0x20000
    buffer_store_dwordx4 v[206:209], v199, s[4:7], 0 offen offset:0 sc1
    buffer_store_dwordx4 v[210:213], v199, s[4:7], 0 offen offset:1024 sc1
    buffer_store_dwordx4 v[214:217], v199, s[4:7], 0 offen offset:2048 sc1
    buffer_store_dwordx4 v[218:221], v199, s[4:7], 0 offen offset:3072 sc1
    s_mov_b32 exec_lo, 16711935
    s_mov_b32 exec_hi, 16711935
    buffer_store_dwordx4 v[222:225], v200, s[4:7], 0 offen sc1
    s_mov_b64 exec, -1
gated_mix__ssm_conv_s4d__mixer_gmlp__prompt_kernel_sj20:
    s_waitcnt vmcnt(18)
    s_barrier
    s_mul_i32 s72, s74, 589824
    s_lshl_b32 s73, s74, 7
    s_add_u32 m0, s68, 34816
    s_add_u32 s70, s72, 0
    buffer_load_dwordx4 v193, s[12:15], s70 offen lds
    s_add_u32 m0, s68, 53248
    s_add_u32 s71, s73, 0
    buffer_load_dwordx4 v192, s[8:11], s71 offen lds
    s_add_u32 m0, s68, 38912
    s_add_u32 s70, s72, 147456
    buffer_load_dwordx4 v193, s[12:15], s70 offen lds
    s_add_u32 m0, s68, 57344
    s_add_u32 s71, s73, 36864
    buffer_load_dwordx4 v192, s[8:11], s71 offen lds
    s_add_u32 m0, s68, 43008
    s_add_u32 s70, s72, 294912
    buffer_load_dwordx4 v193, s[12:15], s70 offen lds
    s_add_u32 m0, s68, 61440
    s_add_u32 s71, s73, 73728
    buffer_load_dwordx4 v192, s[8:11], s71 offen lds
    s_add_u32 m0, s68, 47104
    s_add_u32 s70, s72, 442368
    buffer_load_dwordx4 v193, s[12:15], s70 offen lds
    s_add_u32 m0, s68, 65536
    s_add_u32 s71, s73, 110592
    buffer_load_dwordx4 v192, s[8:11], s71 offen lds
    s_add_u32 m0, s69, 34816
    s_mov_b64 exec, 0xffffffff
    buffer_load_dwordx4 v194, s[12:15], s72 offen lds
    s_mov_b64 exec, -1
    s_add_u32 s74, s74, 1
    s_cmp_eq_u32 s74, 9
    s_cselect_b32 s74, 0, s74
    s_waitcnt vmcnt(18)
    s_barrier
    s_lshl_b32 s65, s27, 14
    s_add_u32 s65, s65, 34603008
    s_add_u32 s4, s62, s65
    s_addc_u32 s5, s63, 0
    s_mov_b32 s6, 16384
    s_mov_b32 s7, 0x20000
    v_and_b32 v196, 31, v0
    v_lshlrev_b32 v196, 3, v196
    v_lshrrev_b32 v197, 5, v0
    v_lshl_add_u32 v197, v197, 13, v196
    s_lshl_b32 s0, s25, 8
    v_add_u32 v199, 4096, v197
    buffer_load_dwordx2 v[206:207], v197, s[4:7], s0 offen offset:0 sc1
    buffer_load_dwordx2 v[208:209], v197, s[4:7], s0 offen offset:1024 sc1
    buffer_load_dwordx2 v[210:211], v197, s[4:7], s0 offen offset:2048 sc1
    buffer_load_dwordx2 v[212:213], v197, s[4:7], s0 offen offset:3072 sc1
    buffer_load_dwordx2 v[214:215], v199, s[4:7], s0 offen offset:0 sc1
    buffer_load_dwordx2 v[216:217], v199, s[4:7], s0 offen offset:1024 sc1
    buffer_load_dwordx2 v[218:219], v199, s[4:7], s0 offen offset:2048 sc1
    buffer_load_dwordx2 v[220:221], v199, s[4:7], s0 offen offset:3072 sc1
    s_mul_i32 s72, s74, 589824
    s_lshl_b32 s73, s74, 7
    s_add_u32 m0, s68, 69632
    s_add_u32 s70, s72, 0
    buffer_load_dwordx4 v193, s[12:15], s70 offen lds
    s_add_u32 m0, s68, 88064
    s_add_u32 s71, s73, 0
    buffer_load_dwordx4 v192, s[8:11], s71 offen lds
    s_add_u32 m0, s68, 73728
    s_add_u32 s70, s72, 147456
    buffer_load_dwordx4 v193, s[12:15], s70 offen lds
    s_add_u32 m0, s68, 92160
    s_add_u32 s71, s73, 36864
    buffer_load_dwordx4 v192, s[8:11], s71 offen lds
    s_add_u32 m0, s68, 77824
    s_add_u32 s70, s72, 294912
    buffer_load_dwordx4 v193, s[12:15], s70 offen lds
    s_add_u32 m0, s68, 96256
    s_add_u32 s71, s73, 73728
    buffer_load_dwordx4 v192, s[8:11], s71 offen lds
    s_add_u32 m0, s68, 81920
    s_add_u32 s70, s72, 442368
    buffer_load_dwordx4 v193, s[12:15], s70 offen lds
    s_add_u32 m0, s68, 100352
    s_add_u32 s71, s73, 110592
    buffer_load_dwordx4 v192, s[8:11], s71 offen lds
    s_add_u32 m0, s69, 69632
    s_mov_b64 exec, 0xffffffff
    buffer_load_dwordx4 v194, s[12:15], s72 offen lds
    s_mov_b64 exec, -1
    s_add_u32 s74, s74, 1
    s_cmp_eq_u32 s74, 9
    s_cselect_b32 s74, 0, s74
    s_waitcnt vmcnt(26)
    s_barrier
    s_mul_i32 s72, s74, 589824
    s_lshl_b32 s73, s74, 7
    s_add_u32 m0, s68, 104448
    s_add_u32 s70, s72, 0
    buffer_load_dwordx4 v193, s[12:15], s70 offen lds
    s_add_u32 m0, s68, 122880
    s_add_u32 s71, s73, 0
    buffer_load_dwordx4 v192, s[8:11], s71 offen lds
    s_add_u32 m0, s68, 108544
    s_add_u32 s70, s72, 147456
    buffer_load_dwordx4 v193, s[12:15], s70 offen lds
    s_add_u32 m0, s68, 126976
    s_add_u32 s71, s73, 36864
    buffer_load_dwordx4 v192, s[8:11], s71 offen lds
    s_add_u32 m0, s68, 112640
    s_add_u32 s70, s72, 294912
    buffer_load_dwordx4 v193, s[12:15], s70 offen lds
    s_add_u32 m0, s68, 131072
    s_add_u32 s71, s73, 73728
    buffer_load_dwordx4 v192, s[8:11], s71 offen lds
    s_add_u32 m0, s68, 116736
    s_add_u32 s70, s72, 442368
    buffer_load_dwordx4 v193, s[12:15], s70 offen lds
    s_add_u32 m0, s68, 135168
    s_add_u32 s71, s73, 110592
    buffer_load_dwordx4 v192, s[8:11], s71 offen lds
    s_add_u32 m0, s69, 104448
    s_mov_b64 exec, 0xffffffff
    buffer_load_dwordx4 v194, s[12:15], s72 offen lds
    s_mov_b64 exec, -1
    s_add_u32 s74, s74, 1
    s_cmp_eq_u32 s74, 9
    s_cselect_b32 s74, 0, s74
    s_mov_b32 s65, 0
    s_waitcnt vmcnt(18)
    s_branch gated_mix__ssm_conv_s4d__mixer_gmlp__prompt_kernel_Lst_chk
gated_mix__ssm_conv_s4d__mixer_gmlp__prompt_kernel_Lst_poll:
    buffer_load_dwordx2 v[206:207], v197, s[4:7], s0 offen offset:0 sc1
    buffer_load_dwordx2 v[208:209], v197, s[4:7], s0 offen offset:1024 sc1
    buffer_load_dwordx2 v[210:211], v197, s[4:7], s0 offen offset:2048 sc1
    buffer_load_dwordx2 v[212:213], v197, s[4:7], s0 offen offset:3072 sc1
    buffer_load_dwordx2 v[214:215], v199, s[4:7], s0 offen offset:0 sc1
    buffer_load_dwordx2 v[216:217], v199, s[4:7], s0 offen offset:1024 sc1
    buffer_load_dwordx2 v[218:219], v199, s[4:7], s0 offen offset:2048 sc1
    buffer_load_dwordx2 v[220:221], v199, s[4:7], s0 offen offset:3072 sc1
    s_waitcnt vmcnt(0)
gated_mix__ssm_conv_s4d__mixer_gmlp__prompt_kernel_Lst_chk:
    v_max_u32 v198, v206, v207
    v_max3_u32 v198, v198, v208, v209
    v_max3_u32 v198, v198, v210, v211
    v_max3_u32 v198, v198, v212, v213
    v_max3_u32 v198, v198, v214, v215
    v_max3_u32 v198, v198, v216, v217
    v_max3_u32 v198, v198, v218, v219
    v_max3_u32 v198, v198, v220, v221
    v_cmp_eq_u32 vcc, -1, v198
    s_add_u32 s65, s65, 1
    s_cmp_eq_u64 vcc, 0
    s_cbranch_scc1 gated_mix__ssm_conv_s4d__mixer_gmlp__prompt_kernel_Lst_ok
    s_sleep 4
    s_cmp_lt_u32 s65, 50000
    s_cbranch_scc1 gated_mix__ssm_conv_s4d__mixer_gmlp__prompt_kernel_Lst_poll
gated_mix__ssm_conv_s4d__mixer_gmlp__prompt_kernel_Lst_ok:
    s_add_u32 s66, s0, 139264
    v_add_u32 v196, s66, v196
    v_add_f32 v206, v206, v214
    v_add_f32 v207, v207, v215
    v_add_f32 v208, v208, v216
    v_add_f32 v209, v209, v217
    v_add_f32 v210, v210, v218
    v_add_f32 v211, v211, v219
    v_add_f32 v212, v212, v220
    v_add_f32 v213, v213, v221
    v_add_f32 v206, v206, v210
    v_add_f32 v207, v207, v211
    v_add_f32 v208, v208, v212
    v_add_f32 v209, v209, v213
    v_add_f32 v206, v206, v208
    v_add_f32 v207, v207, v209
    v_mov_b32 v208, v206
    v_mov_b32 v209, v207
    s_nop 1
    v_permlane32_swap_b32 v206, v208
    v_permlane32_swap_b32 v207, v209
    s_nop 1
    v_add_f32 v206, v206, v208
    v_add_f32 v207, v207, v209
    v_mul_f32 v206, 0x39e38e39, v206
    v_mul_f32 v207, 0x39e38e39, v207
    v_fma_f32 v207, -v206, v206, v207
    v_max_f32 v207, 0, v207
    v_cvt_pk_bf16_f32 v206, v206, v206
    v_and_b32 v206, 0xffff0000, v206
    v_cvt_pk_bf16_f32 v207, v207, v207
    v_and_b32 v207, 0xffff0000, v207
    v_add_f32 v207, 0x3727c5ac, v207
    v_cvt_pk_bf16_f32 v207, v207, v207
    v_and_b32 v207, 0xffff0000, v207
    v_sqrt_f32 v207, v207
    s_nop 0
    v_cvt_pk_bf16_f32 v207, v207, v207
    v_and_b32 v207, 0xffff0000, v207
    v_rcp_f32 v208, v207
    s_nop 0
    v_mul_f32 v209, v206, v208
    v_sub_f32 v209, 0, v209
    ds_write_b64 v196, v[208:209]
    s_waitcnt lgkmcnt(0)
    s_waitcnt vmcnt(26)
    s_barrier
    s_mul_i32 s72, s74, 589824
    s_lshl_b32 s73, s74, 7
    s_add_u32 m0, s68, 0
    s_add_u32 s70, s72, 0
    buffer_load_dwordx4 v193, s[12:15], s70 offen lds
    s_add_u32 m0, s68, 18432
    s_add_u32 s71, s73, 0
    buffer_load_dwordx4 v192, s[8:11], s71 offen lds
    s_add_u32 m0, s68, 4096
    s_add_u32 s70, s72, 147456
    buffer_load_dwordx4 v193, s[12:15], s70 offen lds
    s_add_u32 m0, s68, 22528
    s_add_u32 s71, s73, 36864
    buffer_load_dwordx4 v192, s[8:11], s71 offen lds
    s_add_u32 m0, s68, 8192
    s_add_u32 s70, s72, 294912
    buffer_load_dwordx4 v193, s[12:15], s70 offen lds
    s_add_u32 m0, s68, 26624
    s_add_u32 s71, s73, 73728
    buffer_load_dwordx4 v192, s[8:11], s71 offen lds
    s_add_u32 m0, s68, 12288
    s_add_u32 s70, s72, 442368
    buffer_load_dwordx4 v193, s[12:15], s70 offen lds
    s_add_u32 m0, s68, 30720
    s_add_u32 s71, s73, 110592
    buffer_load_dwordx4 v192, s[8:11], s71 offen lds
    s_add_u32 m0, s69, 0
    s_mov_b64 exec, 0xffffffff
    buffer_load_dwordx4 v194, s[12:15], s72 offen lds
    s_mov_b64 exec, -1
    s_add_u32 s74, s74, 1
    s_cmp_eq_u32 s74, 9
    s_cselect_b32 s74, 0, s74
    s_waitcnt vmcnt(18)
    s_barrier
    s_mul_i32 s72, s74, 589824
    s_lshl_b32 s73, s74, 7
    s_add_u32 m0, s68, 34816
    s_add_u32 s70, s72, 0
    buffer_load_dwordx4 v193, s[12:15], s70 offen lds
    s_add_u32 m0, s68, 53248
    s_add_u32 s71, s73, 0
    buffer_load_dwordx4 v192, s[8:11], s71 offen lds
    s_add_u32 m0, s68, 38912
    s_add_u32 s70, s72, 147456
    buffer_load_dwordx4 v193, s[12:15], s70 offen lds
    s_add_u32 m0, s68, 57344
    s_add_u32 s71, s73, 36864
    buffer_load_dwordx4 v192, s[8:11], s71 offen lds
    s_add_u32 m0, s68, 43008
    s_add_u32 s70, s72, 294912
    buffer_load_dwordx4 v193, s[12:15], s70 offen lds
    s_add_u32 m0, s68, 61440
    s_add_u32 s71, s73, 73728
    buffer_load_dwordx4 v192, s[8:11], s71 offen lds
    s_add_u32 m0, s68, 47104
    s_add_u32 s70, s72, 442368
    buffer_load_dwordx4 v193, s[12:15], s70 offen lds
    s_add_u32 m0, s68, 65536
    s_add_u32 s71, s73, 110592
    buffer_load_dwordx4 v192, s[8:11], s71 offen lds
    s_add_u32 m0, s69, 34816
    s_mov_b64 exec, 0xffffffff
    buffer_load_dwordx4 v194, s[12:15], s72 offen lds
    s_mov_b64 exec, -1
    s_add_u32 s74, s74, 1
    s_cmp_eq_u32 s74, 9
    s_cselect_b32 s74, 0, s74
    s_mov_b32 s72, -2
    s_mov_b32 s73, 0
    s_lshl_b32 s1, s27, 1
    s_add_u32 s1, s1, 2
    s_waitcnt vmcnt(18)
    s_barrier
    s_add_u32 s66, s72, s26
    s_and_b32 s66, s66, 3
    s_andn2_b32 s64, s72, 3
    s_or_b32 s66, s66, s64
    s_andn2_b32 s64, s26, 3
    s_lshl_b32 s64, s64, 1
    s_add_u32 s66, s66, s64
    s_cmp_ge_u32 s66, 28
    s_cselect_b32 s64, 28, 0
    s_sub_u32 s66, s66, s64
    s_cmp_lt_u32 s72, 28
    s_cselect_b32 s66, s66, s72
    s_add_u32 s66, s66, s1
    s_and_b32 s66, s66, 31
    s_add_u32 s72, s72, 1
    s_lshl_b32 s66, s66, 7
    s_add_u32 m0, s68, 88064
    s_add_u32 s70, s66, 0
    buffer_load_dwordx4 v250, s[16:19], s70 offen lds
    s_add_u32 m0, s68, 92160
    s_add_u32 s70, s66, 131072
    buffer_load_dwordx4 v250, s[16:19], s70 offen lds
    s_add_u32 m0, s68, 96256
    s_add_u32 s70, s66, 262144
    buffer_load_dwordx4 v250, s[16:19], s70 offen lds
    s_add_u32 m0, s68, 100352
    s_add_u32 s70, s66, 393216
    buffer_load_dwordx4 v250, s[16:19], s70 offen lds
    s_waitcnt vmcnt(4)
    s_barrier
    s_add_u32 s4, s62, 35127296
    s_addc_u32 s5, s63, 0
    s_mov_b32 s6, 262144
    s_mov_b32 s7, 0x20000
    s_cmp_lg_u32 s25, 0
    s_cbranch_scc1 gated_mix__ssm_conv_s4d__mixer_gmlp__prompt_kernel_Lnz
    v_lshlrev_b32 v200, 4, v0
    v_add_u32 v200, s26, v200
    v_lshlrev_b32 v200, 8, v200
    s_lshl_b32 s64, s27, 2
    s_add_u32 s64, s64, 0
    v_mov_b32 v201, 1
    s_mov_b64 exec, 0xffff
    buffer_store_dword v201, v200, s[4:7], s64 offen sc1
    s_mov_b64 exec, -1
gated_mix__ssm_conv_s4d__mixer_gmlp__prompt_kernel_Lnz:
    s_add_u32 s8, s62, 35127296
    s_addc_u32 s9, s63, 0
    s_mov_b32 s10, 262144
    s_mov_b32 s11, 0x20000
    s_add_u32 s66, s72, s26
    s_and_b32 s66, s66, 3
    s_andn2_b32 s64, s72, 3
    s_or_b32 s66, s66, s64
    s_andn2_b32 s64, s26, 3
    s_lshl_b32 s64, s64, 1
    s_add_u32 s66, s66, s64
    s_cmp_ge_u32 s66, 28
    s_cselect_b32 s64, 28, 0
    s_sub_u32 s66, s66, s64
    s_cmp_lt_u32 s72, 28
    s_cselect_b32 s66, s66, s72
    s_add_u32 s66, s66, s1
    s_and_b32 s66, s66, 31
    s_add_u32 s72, s72, 1
    s_lshl_b32 s66, s66, 7
    s_add_u32 m0, s68, 122880
    s_add_u32 s70, s66, 0
    buffer_load_dwordx4 v250, s[16:19], s70 offen lds
    s_add_u32 m0, s68, 126976
    s_add_u32 s70, s66, 131072
    buffer_load_dwordx4 v250, s[16:19], s70 offen lds
    s_add_u32 m0, s68, 131072
    s_add_u32 s70, s66, 262144
    buffer_load_dwordx4 v250, s[16:19], s70 offen lds
    s_add_u32 m0, s68, 135168
    s_add_u32 s70, s66, 393216
    buffer_load_dwordx4 v250, s[16:19], s70 offen lds
    s_sub_u32 s65, s30, 576
    s_cmp_ge_u32 s65, 288
    s_cbranch_scc1 gated_mix__ssm_conv_s4d__mixer_gmlp__prompt_kernel_sj21
    v_lshrrev_b32 v195, 2, v0
    v_mul_u32_u24 v195, 144, v195
    v_and_b32 v196, 3, v0
    v_lshl_add_u32 v197, v196, 4, v195
    v_add_u32 v197, s31, v197
    v_lshl_add_u32 v198, v196, 3, v195
    v_add_u32 v198, s31, v198
    v_lshlrev_b32 v199, 4, v0
    v_and_b32 v200, 7, v0
    v_lshrrev_b32 v203, 4, v0
    v_lshl_add_u32 v200, v203, 3, v200
    v_lshlrev_b32 v200, 4, v200
    v_add_u32 v200, 4096, v200
    ds_read_b64_tr_b16 v[206:207], v197 offset:0
    ds_read_b64_tr_b16 v[208:209], v197 offset:2304
    ds_read_b64_tr_b16 v[210:211], v197 offset:8
    ds_read_b64_tr_b16 v[212:213], v197 offset:2312
    ds_read_b64_tr_b16 v[214:215], v197 offset:64
    ds_read_b64_tr_b16 v[216:217], v197 offset:2368
    ds_read_b64_tr_b16 v[218:219], v197 offset:72
    ds_read_b64_tr_b16 v[220:221], v197 offset:2376
    ds_read_b64_tr_b16 v[222:223], v198 offset:128
    ds_read_b64_tr_b16 v[224:225], v198 offset:2432
    s_waitcnt lgkmcnt(0)
    s_mul_i32 s64, s24, 4608
    s_add_u32 s64, s64, 31461888
    s_add_u32 s4, s62, s64
    s_addc_u32 s5, s63, 0
    s_mov_b32 s6, 4608
    s_mov_b32 s7, 0x20000
    buffer_store_dwordx4 v[206:209], v199, s[4:7], 0 offen offset:0 sc1
    buffer_store_dwordx4 v[210:213], v199, s[4:7], 0 offen offset:1024 sc1
    buffer_store_dwordx4 v[214:217], v199, s[4:7], 0 offen offset:2048 sc1
    buffer_store_dwordx4 v[218:221], v199, s[4:7], 0 offen offset:3072 sc1
    s_mov_b32 exec_lo, 16711935
    s_mov_b32 exec_hi, 16711935
    buffer_store_dwordx4 v[222:225], v200, s[4:7], 0 offen sc1
    s_mov_b64 exec, -1
gated_mix__ssm_conv_s4d__mixer_gmlp__prompt_kernel_sj21:
    s_cmp_lg_u32 s25, 0
    s_cbranch_scc1 gated_mix__ssm_conv_s4d__mixer_gmlp__prompt_kernel_Lgz_oth
    s_lshl_b32 s64, s3, 8
    s_add_u32 s64, s64, 0
    v_min_u32 v202, 15, v0
    v_lshlrev_b32 v202, 2, v202
    s_mov_b32 s65, 0
    buffer_load_dword v203, v202, s[8:11], s64 offen sc1
    s_sleep 4
gated_mix__ssm_conv_s4d__mixer_gmlp__prompt_kernel_Lz2_poll:
    buffer_load_dword v204, v202, s[8:11], s64 offen sc1
    s_waitcnt vmcnt(1)
    v_cmp_eq_u32 vcc, 0, v203
    s_add_u32 s65, s65, 1
    s_cmp_eq_u64 vcc, 0
    s_cbranch_scc1 gated_mix__ssm_conv_s4d__mixer_gmlp__prompt_kernel_Lz2_ok
    s_sleep 4
    buffer_load_dword v203, v202, s[8:11], s64 offen sc1
    s_waitcnt vmcnt(1)
    v_cmp_eq_u32 vcc, 0, v204
    s_add_u32 s65, s65, 1
    s_cmp_eq_u64 vcc, 0
    s_cbranch_scc1 gated_mix__ssm_conv_s4d__mixer_gmlp__prompt_kernel_Lz2_ok
    s_sleep 4
    s_cmp_lt_u32 s65, 100000
    s_cbranch_scc1 gated_mix__ssm_conv_s4d__mixer_gmlp__prompt_kernel_Lz2_poll
gated_mix__ssm_conv_s4d__mixer_gmlp__prompt_kernel_Lz2_ok:
    v_mov_b32 v200, 163600
    v_mov_b32 v201, 1
    ds_write_b32 v200, v201
    s_branch gated_mix__ssm_conv_s4d__mixer_gmlp__prompt_kernel_Lgz_done
gated_mix__ssm_conv_s4d__mixer_gmlp__prompt_kernel_Lgz_oth:
    v_mov_b32 v200, 163600
    s_mov_b32 s65, 0
gated_mix__ssm_conv_s4d__mixer_gmlp__prompt_kernel_Lgz_spin:
    ds_read_b32 v201, v200
    s_waitcnt lgkmcnt(0)
    v_readfirstlane_b32 s66, v201
    s_add_u32 s65, s65, 1
    s_cmp_lg_u32 s66, 0
    s_cbranch_scc1 gated_mix__ssm_conv_s4d__mixer_gmlp__prompt_kernel_Lgz_done
    s_sleep 1
    s_cmp_lt_u32 s65, 2000000
    s_cbranch_scc1 gated_mix__ssm_conv_s4d__mixer_gmlp__prompt_kernel_Lgz_spin
gated_mix__ssm_conv_s4d__mixer_gmlp__prompt_kernel_Lgz_done:
    s_waitcnt vmcnt(0)
    v_mov_b32 v200, 163588
    s_mov_b32 s65, 0
gated_mix__ssm_conv_s4d__mixer_gmlp__prompt_kernel_Lrf:
    ds_read_b32 v201, v200
    s_waitcnt lgkmcnt(0)
    v_readfirstlane_b32 s66, v201
    s_add_u32 s65, s65, 1
    s_cmp_ge_u32 s66, 4
    s_cbranch_scc1 gated_mix__ssm_conv_s4d__mixer_gmlp__prompt_kernel_Lrf2
    s_sleep 1
    s_cmp_lt_u32 s65, 2000000
    s_cbranch_scc1 gated_mix__ssm_conv_s4d__mixer_gmlp__prompt_kernel_Lrf
gated_mix__ssm_conv_s4d__mixer_gmlp__prompt_kernel_Lrf2:
    s_add_u32 s66, s73, s26
    s_and_b32 s66, s66, 3
    s_andn2_b32 s64, s73, 3
    s_or_b32 s66, s66, s64
    s_andn2_b32 s64, s26, 3
    s_lshl_b32 s64, s64, 1
    s_add_u32 s66, s66, s64
    s_cmp_ge_u32 s66, 28
    s_cselect_b32 s64, 28, 0
    s_sub_u32 s66, s66, s64
    s_cmp_lt_u32 s73, 28
    s_cselect_b32 s66, s66, s73
    s_add_u32 s66, s66, s1
    s_and_b32 s66, s66, 31
    s_add_u32 s73, s73, 1
    s_mul_i32 s66, s66, 18432
    s_add_u32 m0, s67, 0
    s_add_u32 s70, s66, s67
    buffer_load_dwordx4 v251, s[20:23], s70 offen offset:0 sc1 lds
    buffer_load_dwordx4 v251, s[20:23], s70 offen offset:1024 sc1 lds
    buffer_load_dwordx4 v251, s[20:23], s70 offen offset:2048 sc1 lds
    buffer_load_dwordx4 v251, s[20:23], s70 offen offset:3072 sc1 lds
    s_add_u32 m0, s69, 0
    s_add_u32 s70, s66, s69
    s_mov_b64 exec, 0xffffffff
    buffer_load_dwordx4 v251, s[20:23], s70 offen sc1 lds
    s_mov_b64 exec, -1
    s_add_u32 s66, s72, s26
    s_and_b32 s66, s66, 3
    s_andn2_b32 s64, s72, 3
    s_or_b32 s66, s66, s64
    s_andn2_b32 s64, s26, 3
    s_lshl_b32 s64, s64, 1
    s_add_u32 s66, s66, s64
    s_cmp_ge_u32 s66, 28
    s_cselect_b32 s64, 28, 0
    s_sub_u32 s66, s66, s64
    s_cmp_lt_u32 s72, 28
    s_cselect_b32 s66, s66, s72
    s_add_u32 s66, s66, s1
    s_and_b32 s66, s66, 31
    s_add_u32 s72, s72, 1
    s_lshl_b32 s66, s66, 7
    s_add_u32 m0, s68, 18432
    s_add_u32 s70, s66, 0
    buffer_load_dwordx4 v250, s[16:19], s70 offen lds
    s_add_u32 m0, s68, 22528
    s_add_u32 s70, s66, 131072
    buffer_load_dwordx4 v250, s[16:19], s70 offen lds
    s_add_u32 m0, s68, 26624
    s_add_u32 s70, s66, 262144
    buffer_load_dwordx4 v250, s[16:19], s70 offen lds
    s_add_u32 m0, s68, 30720
    s_add_u32 s70, s66, 393216
    buffer_load_dwordx4 v250, s[16:19], s70 offen lds
    s_add_u32 s66, s73, s26
    s_and_b32 s66, s66, 3
    s_andn2_b32 s64, s73, 3
    s_or_b32 s66, s66, s64
    s_andn2_b32 s64, s26, 3
    s_lshl_b32 s64, s64, 1
    s_add_u32 s66, s66, s64
    s_cmp_ge_u32 s66, 28
    s_cselect_b32 s64, 28, 0
    s_sub_u32 s66, s66, s64
    s_cmp_lt_u32 s73, 28
    s_cselect_b32 s66, s66, s73
    s_add_u32 s66, s66, s1
    s_and_b32 s66, s66, 31
    s_add_u32 s73, s73, 1
    s_mul_i32 s66, s66, 18432
    s_add_u32 m0, s67, 34816
    s_add_u32 s70, s66, s67
    buffer_load_dwordx4 v251, s[20:23], s70 offen offset:0 sc1 lds
    buffer_load_dwordx4 v251, s[20:23], s70 offen offset:1024 sc1 lds
    buffer_load_dwordx4 v251, s[20:23], s70 offen offset:2048 sc1 lds
    buffer_load_dwordx4 v251, s[20:23], s70 offen offset:3072 sc1 lds
    s_add_u32 m0, s69, 34816
    s_add_u32 s70, s66, s69
    s_mov_b64 exec, 0xffffffff
    buffer_load_dwordx4 v251, s[20:23], s70 offen sc1 lds
    s_mov_b64 exec, -1
    s_add_u32 s66, s72, s26
    s_and_b32 s66, s66, 3
    s_andn2_b32 s64, s72, 3
    s_or_b32 s66, s66, s64
    s_andn2_b32 s64, s26, 3
    s_lshl_b32 s64, s64, 1
    s_add_u32 s66, s66, s64
    s_cmp_ge_u32 s66, 28
    s_cselect_b32 s64, 28, 0
    s_sub_u32 s66, s66, s64
    s_cmp_lt_u32 s72, 28
    s_cselect_b32 s66, s66, s72
    s_add_u32 s66, s66, s1
    s_and_b32 s66, s66, 31
    s_add_u32 s72, s72, 1
    s_lshl_b32 s66, s66, 7
    s_add_u32 m0, s68, 53248
    s_add_u32 s70, s66, 0
    buffer_load_dwordx4 v250, s[16:19], s70 offen lds
    s_add_u32 m0, s68, 57344
    s_add_u32 s70, s66, 131072
    buffer_load_dwordx4 v250, s[16:19], s70 offen lds
    s_add_u32 m0, s68, 61440
    s_add_u32 s70, s66, 262144
    buffer_load_dwordx4 v250, s[16:19], s70 offen lds
    s_add_u32 m0, s68, 65536
    s_add_u32 s70, s66, 393216
    buffer_load_dwordx4 v250, s[16:19], s70 offen lds
    s_barrier
    s_cmp_lg_u32 s25, 0
    s_cbranch_scc1 gated_mix__ssm_conv_s4d__mixer_gmlp__prompt_kernel_Lnw
    s_sub_u32 s65, s30, 576
    s_lshr_b32 s65, s65, 2
    s_cmp_ge_u32 s65, 72
    s_cbranch_scc1 gated_mix__ssm_conv_s4d__mixer_gmlp__prompt_kernel_Lnw
    s_mul_i32 s66, s65, 57
    s_lshr_b32 s66, s66, 9
    s_mul_i32 s70, s66, 9
    s_sub_u32 s70, s65, s70
    v_lshlrev_b32 v210, 3, v0
    v_add_u32 v210, s66, v210
    v_lshlrev_b32 v210, 8, v210
    s_lshl_b32 s64, s70, 2
    s_add_u32 s64, s64, 196608
    v_mov_b32 v211, 1
    s_mov_b64 exec, 0xffffffff
    buffer_store_dword v211, v210, s[8:11], s64 offen sc1
    s_mov_b64 exec, -1
gated_mix__ssm_conv_s4d__mixer_gmlp__prompt_kernel_Lnw:
    s_barrier
    s_add_u32 s66, s72, s26
    s_and_b32 s66, s66, 3
    s_andn2_b32 s64, s72, 3
    s_or_b32 s66, s66, s64
    s_andn2_b32 s64, s26, 3
    s_lshl_b32 s64, s64, 1
    s_add_u32 s66, s66, s64
    s_cmp_ge_u32 s66, 28
    s_cselect_b32 s64, 28, 0
    s_sub_u32 s66, s66, s64
    s_cmp_lt_u32 s72, 28
    s_cselect_b32 s66, s66, s72
    s_add_u32 s66, s66, s1
    s_and_b32 s66, s66, 31
    s_add_u32 s72, s72, 1
    s_lshl_b32 s66, s66, 7
    s_add_u32 m0, s68, 88064
    s_add_u32 s70, s66, 0
    buffer_load_dwordx4 v250, s[16:19], s70 offen lds
    s_add_u32 m0, s68, 92160
    s_add_u32 s70, s66, 131072
    buffer_load_dwordx4 v250, s[16:19], s70 offen lds
    s_add_u32 m0, s68, 96256
    s_add_u32 s70, s66, 262144
    buffer_load_dwordx4 v250, s[16:19], s70 offen lds
    s_add_u32 m0, s68, 100352
    s_add_u32 s70, s66, 393216
    buffer_load_dwordx4 v250, s[16:19], s70 offen lds
    s_add_u32 s66, s73, s26
    s_and_b32 s66, s66, 3
    s_andn2_b32 s64, s73, 3
    s_or_b32 s66, s66, s64
    s_andn2_b32 s64, s26, 3
    s_lshl_b32 s64, s64, 1
    s_add_u32 s66, s66, s64
    s_cmp_ge_u32 s66, 28
    s_cselect_b32 s64, 28, 0
    s_sub_u32 s66, s66, s64
    s_cmp_lt_u32 s73, 28
    s_cselect_b32 s66, s66, s73
    s_add_u32 s66, s66, s1
    s_and_b32 s66, s66, 31
    s_add_u32 s73, s73, 1
    s_mul_i32 s66, s66, 18432
    s_add_u32 m0, s67, 69632
    s_add_u32 s70, s66, s67
    buffer_load_dwordx4 v251, s[20:23], s70 offen offset:0 sc1 lds
    buffer_load_dwordx4 v251, s[20:23], s70 offen offset:1024 sc1 lds
    buffer_load_dwordx4 v251, s[20:23], s70 offen offset:2048 sc1 lds
    buffer_load_dwordx4 v251, s[20:23], s70 offen offset:3072 sc1 lds
    s_add_u32 m0, s69, 69632
    s_add_u32 s70, s66, s69
    s_mov_b64 exec, 0xffffffff
    buffer_load_dwordx4 v251, s[20:23], s70 offen sc1 lds
    s_mov_b64 exec, -1
    s_waitcnt vmcnt(18)
    s_barrier
    s_add_u32 s66, s72, s26
    s_and_b32 s66, s66, 3
    s_andn2_b32 s64, s72, 3
    s_or_b32 s66, s66, s64
    s_andn2_b32 s64, s26, 3
    s_lshl_b32 s64, s64, 1
    s_add_u32 s66, s66, s64
    s_cmp_ge_u32 s66, 28
    s_cselect_b32 s64, 28, 0
    s_sub_u32 s66, s66, s64
    s_cmp_lt_u32 s72, 28
    s_cselect_b32 s66, s66, s72
    s_add_u32 s66, s66, s1
    s_and_b32 s66, s66, 31
    s_add_u32 s72, s72, 1
    s_lshl_b32 s66, s66, 7
    s_add_u32 m0, s68, 122880
    s_add_u32 s70, s66, 0
    buffer_load_dwordx4 v250, s[16:19], s70 offen lds
    s_add_u32 m0, s68, 126976
    s_add_u32 s70, s66, 131072
    buffer_load_dwordx4 v250, s[16:19], s70 offen lds
    s_add_u32 m0, s68, 131072
    s_add_u32 s70, s66, 262144
    buffer_load_dwordx4 v250, s[16:19], s70 offen lds
    s_add_u32 m0, s68, 135168
    s_add_u32 s70, s66, 393216
    buffer_load_dwordx4 v250, s[16:19], s70 offen lds
    s_add_u32 s66, s73, s26
    s_and_b32 s66, s66, 3
    s_andn2_b32 s64, s73, 3
    s_or_b32 s66, s66, s64
    s_andn2_b32 s64, s26, 3
    s_lshl_b32 s64, s64, 1
    s_add_u32 s66, s66, s64
    s_cmp_ge_u32 s66, 28
    s_cselect_b32 s64, 28, 0
    s_sub_u32 s66, s66, s64
    s_cmp_lt_u32 s73, 28
    s_cselect_b32 s66, s66, s73
    s_add_u32 s66, s66, s1
    s_and_b32 s66, s66, 31
    s_add_u32 s73, s73, 1
    s_mul_i32 s66, s66, 18432
    s_add_u32 m0, s67, 104448
    s_add_u32 s70, s66, s67
    buffer_load_dwordx4 v251, s[20:23], s70 offen offset:0 sc1 lds
    buffer_load_dwordx4 v251, s[20:23], s70 offen offset:1024 sc1 lds
    buffer_load_dwordx4 v251, s[20:23], s70 offen offset:2048 sc1 lds
    buffer_load_dwordx4 v251, s[20:23], s70 offen offset:3072 sc1 lds
    s_add_u32 m0, s69, 104448
    s_add_u32 s70, s66, s69
    s_mov_b64 exec, 0xffffffff
    buffer_load_dwordx4 v251, s[20:23], s70 offen sc1 lds
    s_mov_b64 exec, -1
    s_waitcnt vmcnt(18)
    s_barrier
    s_add_u32 s66, s72, s26
    s_and_b32 s66, s66, 3
    s_andn2_b32 s64, s72, 3
    s_or_b32 s66, s66, s64
    s_andn2_b32 s64, s26, 3
    s_lshl_b32 s64, s64, 1
    s_add_u32 s66, s66, s64
    s_cmp_ge_u32 s66, 28
    s_cselect_b32 s64, 28, 0
    s_sub_u32 s66, s66, s64
    s_cmp_lt_u32 s72, 28
    s_cselect_b32 s66, s66, s72
    s_add_u32 s66, s66, s1
    s_and_b32 s66, s66, 31
    s_add_u32 s72, s72, 1
    s_lshl_b32 s66, s66, 7
    s_add_u32 m0, s68, 18432
    s_add_u32 s70, s66, 0
    buffer_load_dwordx4 v250, s[16:19], s70 offen lds
    s_add_u32 m0, s68, 22528
    s_add_u32 s70, s66, 131072
    buffer_load_dwordx4 v250, s[16:19], s70 offen lds
    s_add_u32 m0, s68, 26624
    s_add_u32 s70, s66, 262144
    buffer_load_dwordx4 v250, s[16:19], s70 offen lds
    s_add_u32 m0, s68, 30720
    s_add_u32 s70, s66, 393216
    buffer_load_dwordx4 v250, s[16:19], s70 offen lds
    s_add_u32 s66, s73, s26
    s_and_b32 s66, s66, 3
    s_andn2_b32 s64, s73, 3
    s_or_b32 s66, s66, s64
    s_andn2_b32 s64, s26, 3
    s_lshl_b32 s64, s64, 1
    s_add_u32 s66, s66, s64
    s_cmp_ge_u32 s66, 28
    s_cselect_b32 s64, 28, 0
    s_sub_u32 s66, s66, s64
    s_cmp_lt_u32 s73, 28
    s_cselect_b32 s66, s66, s73
    s_add_u32 s66, s66, s1
    s_and_b32 s66, s66, 31
    s_add_u32 s73, s73, 1
    s_mul_i32 s66, s66, 18432
    s_add_u32 m0, s67, 0
    s_add_u32 s70, s66, s67
    buffer_load_dwordx4 v251, s[20:23], s70 offen offset:0 sc1 lds
    buffer_load_dwordx4 v251, s[20:23], s70 offen offset:1024 sc1 lds
    buffer_load_dwordx4 v251, s[20:23], s70 offen offset:2048 sc1 lds
    buffer_load_dwordx4 v251, s[20:23], s70 offen offset:3072 sc1 lds
    s_add_u32 m0, s69, 0
    s_add_u32 s70, s66, s69
    s_mov_b64 exec, 0xffffffff
    buffer_load_dwordx4 v251, s[20:23], s70 offen sc1 lds
    s_mov_b64 exec, -1
    s_mov_b32 s74, 34816
    s_mov_b32 s71, 12
gated_mix__ssm_conv_s4d__mixer_gmlp__prompt_kernel_Lg2:
    s_waitcnt vmcnt(18)
    s_barrier
    s_add_u32 s66, s72, s26
    s_and_b32 s66, s66, 3
    s_andn2_b32 s64, s72, 3
    s_or_b32 s66, s66, s64
    s_andn2_b32 s64, s26, 3
    s_lshl_b32 s64, s64, 1
    s_add_u32 s66, s66, s64
    s_cmp_ge_u32 s66, 28
    s_cselect_b32 s64, 28, 0
    s_sub_u32 s66, s66, s64
    s_cmp_lt_u32 s72, 28
    s_cselect_b32 s66, s66, s72
    s_add_u32 s66, s66, s1
    s_and_b32 s66, s66, 31
    s_add_u32 s72, s72, 1
    s_lshl_b32 s66, s66, 7
    s_add_u32 m0, s68, s74
    s_add_u32 m0, m0, 18432
    s_add_u32 s70, s66, 0
    buffer_load_dwordx4 v250, s[16:19], s70 offen lds
    s_add_u32 m0, s68, s74
    s_add_u32 m0, m0, 22528
    s_add_u32 s70, s66, 131072
    buffer_load_dwordx4 v250, s[16:19], s70 offen lds
    s_add_u32 m0, s68, s74
    s_add_u32 m0, m0, 26624
    s_add_u32 s70, s66, 262144
    buffer_load_dwordx4 v250, s[16:19], s70 offen lds
    s_add_u32 m0, s68, s74
    s_add_u32 m0, m0, 30720
    s_add_u32 s70, s66, 393216
    buffer_load_dwordx4 v250, s[16:19], s70 offen lds
    s_add_u32 s66, s73, s26
    s_and_b32 s66, s66, 3
    s_andn2_b32 s64, s73, 3
    s_or_b32 s66, s66, s64
    s_andn2_b32 s64, s26, 3
    s_lshl_b32 s64, s64, 1
    s_add_u32 s66, s66, s64
    s_cmp_ge_u32 s66, 28
    s_cselect_b32 s64, 28, 0
    s_sub_u32 s66, s66, s64
    s_cmp_lt_u32 s73, 28
    s_cselect_b32 s66, s66, s73
    s_add_u32 s66, s66, s1
    s_and_b32 s66, s66, 31
    s_add_u32 s73, s73, 1
    s_mul_i32 s66, s66, 18432
    s_add_u32 m0, s67, s74
    s_add_u32 s70, s66, s67
    buffer_load_dwordx4 v251, s[20:23], s70 offen offset:0 sc1 lds
    buffer_load_dwordx4 v251, s[20:23], s70 offen offset:1024 sc1 lds
    buffer_load_dwordx4 v251, s[20:23], s70 offen offset:2048 sc1 lds
    buffer_load_dwordx4 v251, s[20:23], s70 offen offset:3072 sc1 lds
    s_add_u32 m0, s69, s74
    s_add_u32 s70, s66, s69
    s_mov_b64 exec, 0xffffffff
    buffer_load_dwordx4 v251, s[20:23], s70 offen sc1 lds
    s_mov_b64 exec, -1
    s_add_u32 s74, s74, 34816
    s_cmp_eq_u32 s74, 139264
    s_cselect_b32 s74, 0, s74
    s_sub_u32 s71, s71, 1
    s_cmp_lg_u32 s71, 0
    s_cbranch_scc1 gated_mix__ssm_conv_s4d__mixer_gmlp__prompt_kernel_Lg2
    s_lshl_b32 s64, s75, 8
    s_add_u32 s64, s64, 196608
    v_min_u32 v200, 8, v0
    v_lshlrev_b32 v200, 2, v200
    buffer_load_dword v201, v200, s[8:11], s64 offen sc1
    s_lshl_b32 s64, s3, 8
    s_add_u32 s64, s64, 0
    v_min_u32 v202, 19, v0
    v_lshlrev_b32 v202, 2, v202
    buffer_load_dword v203, v202, s[8:11], s64 offen sc1
    s_mov_b32 s71, 7
gated_mix__ssm_conv_s4d__mixer_gmlp__prompt_kernel_Lg2b:
    s_waitcnt vmcnt(18)
    s_barrier
    s_add_u32 s66, s72, s26
    s_and_b32 s66, s66, 3
    s_andn2_b32 s64, s72, 3
    s_or_b32 s66, s66, s64
    s_andn2_b32 s64, s26, 3
    s_lshl_b32 s64, s64, 1
    s_add_u32 s66, s66, s64
    s_cmp_ge_u32 s66, 28
    s_cselect_b32 s64, 28, 0
    s_sub_u32 s66, s66, s64
    s_cmp_lt_u32 s72, 28
    s_cselect_b32 s66, s66, s72
    s_add_u32 s66, s66, s1
    s_and_b32 s66, s66, 31
    s_add_u32 s72, s72, 1
    s_lshl_b32 s66, s66, 7
    s_add_u32 m0, s68, s74
    s_add_u32 m0, m0, 18432
    s_add_u32 s70, s66, 0
    buffer_load_dwordx4 v250, s[16:19], s70 offen lds
    s_add_u32 m0, s68, s74
    s_add_u32 m0, m0, 22528
    s_add_u32 s70, s66, 131072
    buffer_load_dwordx4 v250, s[16:19], s70 offen lds
    s_add_u32 m0, s68, s74
    s_add_u32 m0, m0, 26624
    s_add_u32 s70, s66, 262144
    buffer_load_dwordx4 v250, s[16:19], s70 offen lds
    s_add_u32 m0, s68, s74
    s_add_u32 m0, m0, 30720
    s_add_u32 s70, s66, 393216
    buffer_load_dwordx4 v250, s[16:19], s70 offen lds
    s_add_u32 s66, s73, s26
    s_and_b32 s66, s66, 3
    s_andn2_b32 s64, s73, 3
    s_or_b32 s66, s66, s64
    s_andn2_b32 s64, s26, 3
    s_lshl_b32 s64, s64, 1
    s_add_u32 s66, s66, s64
    s_cmp_ge_u32 s66, 28
    s_cselect_b32 s64, 28, 0
    s_sub_u32 s66, s66, s64
    s_cmp_lt_u32 s73, 28
    s_cselect_b32 s66, s66, s73
    s_add_u32 s66, s66, s1
    s_and_b32 s66, s66, 31
    s_add_u32 s73, s73, 1
    s_mul_i32 s66, s66, 18432
    s_add_u32 m0, s67, s74
    s_add_u32 s70, s66, s67
    buffer_load_dwordx4 v251, s[20:23], s70 offen offset:0 sc1 lds
    buffer_load_dwordx4 v251, s[20:23], s70 offen offset:1024 sc1 lds
    buffer_load_dwordx4 v251, s[20:23], s70 offen offset:2048 sc1 lds
    buffer_load_dwordx4 v251, s[20:23], s70 offen offset:3072 sc1 lds
    s_add_u32 m0, s69, s74
    s_add_u32 s70, s66, s69
    s_mov_b64 exec, 0xffffffff
    buffer_load_dwordx4 v251, s[20:23], s70 offen sc1 lds
    s_mov_b64 exec, -1
    s_add_u32 s74, s74, 34816
    s_cmp_eq_u32 s74, 139264
    s_cselect_b32 s74, 0, s74
    s_sub_u32 s71, s71, 1
    s_cmp_lg_u32 s71, 0
    s_cbranch_scc1 gated_mix__ssm_conv_s4d__mixer_gmlp__prompt_kernel_Lg2b
    v_cmp_eq_u32 vcc, 0, v201
    s_nop 0
    s_cmp_eq_u64 vcc, 0
    s_cbranch_scc1 gated_mix__ssm_conv_s4d__mixer_gmlp__prompt_kernel_Lw_ok
    s_lshl_b32 s64, s75, 8
    s_add_u32 s64, s64, 196608
    v_min_u32 v200, 8, v0
    v_lshlrev_b32 v200, 2, v200
    s_mov_b32 s65, 0
gated_mix__ssm_conv_s4d__mixer_gmlp__prompt_kernel_Lw_poll:
    buffer_load_dword v201, v200, s[8:11], s64 offen sc1
    s_waitcnt vmcnt(0)
    v_cmp_eq_u32 vcc, 0, v201
    s_add_u32 s65, s65, 1
    s_cmp_eq_u64 vcc, 0
    s_cbranch_scc1 gated_mix__ssm_conv_s4d__mixer_gmlp__prompt_kernel_Lw_ok
    s_sleep 4
    s_cmp_lt_u32 s65, 100000
    s_cbranch_scc1 gated_mix__ssm_conv_s4d__mixer_gmlp__prompt_kernel_Lw_poll
gated_mix__ssm_conv_s4d__mixer_gmlp__prompt_kernel_Lw_ok:
    s_cmp_ge_u32 s26, 9
    s_cbranch_scc1 gated_mix__ssm_conv_s4d__mixer_gmlp__prompt_kernel_Lnkb
    v_cmp_eq_u32 vcc, 0, v203
    s_nop 0
    s_cmp_eq_u64 vcc, 0
    s_cbranch_scc1 gated_mix__ssm_conv_s4d__mixer_gmlp__prompt_kernel_Lkb_ok
    s_lshl_b32 s64, s3, 8
    s_add_u32 s64, s64, 0
    v_min_u32 v200, 19, v0
    v_lshlrev_b32 v200, 2, v200
    s_mov_b32 s65, 0
gated_mix__ssm_conv_s4d__mixer_gmlp__prompt_kernel_Lkb_poll:
    buffer_load_dword v201, v200, s[8:11], s64 offen sc1
    s_waitcnt vmcnt(0)
    v_cmp_eq_u32 vcc, 0, v201
    s_add_u32 s65, s65, 1
    s_cmp_eq_u64 vcc, 0
    s_cbranch_scc1 gated_mix__ssm_conv_s4d__mixer_gmlp__prompt_kernel_Lkb_ok
    s_sleep 4
    s_cmp_lt_u32 s65, 100000
    s_cbranch_scc1 gated_mix__ssm_conv_s4d__mixer_gmlp__prompt_kernel_Lkb_poll
gated_mix__ssm_conv_s4d__mixer_gmlp__prompt_kernel_Lkb_ok:
    s_mul_i32 s64, s30, 2304
    s_add_u32 s64, s64, 41943040
    s_add_u32 s4, s62, s64
    s_addc_u32 s5, s63, 0
    s_mov_b32 s6, 2304
    s_mov_b32 s7, 0x20000
    s_mul_i32 s65, s25, 4800
    s_add_u32 m0, s65, 140928
    v_lshlrev_b32 v200, 2, v0
    buffer_load_dwordx4 v251, s[4:7], 0 offen offset:0 sc1 lds
    buffer_load_dwordx4 v251, s[4:7], 0 offen offset:1024 sc1 lds
    s_mov_b64 exec, 0x7f
    buffer_load_dword v200, s[4:7], 0 offen offset:2048 sc1 lds
    s_mov_b64 exec, -1
gated_mix__ssm_conv_s4d__mixer_gmlp__prompt_kernel_Lnkb:
    v_lshlrev_b32 v2, 4, v0
    v_and_b32 v3, 7, v0
    v_lshrrev_b32 v1, 4, v0
    v_lshl_add_u32 v3, v1, 3, v3
    v_lshlrev_b32 v3, 4, v3
    v_add_u32 v3, 4096, v3
    s_mul_i32 s64, s29, 331776
    s_add_u32 s64, s64, 31457280
    s_add_u32 s4, s62, s64
    s_addc_u32 s5, s63, 0
    s_mov_b32 s6, 331776
    s_mov_b32 s7, 0x20000
    s_mul_i32 s64, s28, 294912
    s_add_u32 s64, s64, 18874368
    s_add_u32 s12, s62, s64
    s_addc_u32 s13, s63, 0
    s_mov_b32 s14, 294912
    s_mov_b32 s15, 0x20000
    s_and_b32 s64, s28, 3
    s_lshl_b32 s64, s64, 1
    s_add_u32 s64, s64, s29
    s_and_b32 s64, s64, 7
    s_mul_i32 s64, s64, 9
    s_mov_b32 s64, 0
    s_add_u32 s64, s64, s25
    s_mul_i32 s0, s64, 4608
    s_lshl_b32 s31, s64, 12
    s_waitcnt vmcnt(18)
    s_barrier
    s_add_u32 s66, s72, s26
    s_and_b32 s66, s66, 3
    s_andn2_b32 s64, s72, 3
    s_or_b32 s66, s66, s64
    s_andn2_b32 s64, s26, 3
    s_lshl_b32 s64, s64, 1
    s_add_u32 s66, s66, s64
    s_cmp_ge_u32 s66, 28
    s_cselect_b32 s64, 28, 0
    s_sub_u32 s66, s66, s64
    s_cmp_lt_u32 s72, 28
    s_cselect_b32 s66, s66, s72
    s_add_u32 s66, s66, s1
    s_and_b32 s66, s66, 31
    s_add_u32 s72, s72, 1
    s_lshl_b32 s66, s66, 7
    s_add_u32 m0, s68, 18432
    s_add_u32 s70, s66, 0
    buffer_load_dwordx4 v250, s[16:19], s70 offen lds
    s_add_u32 m0, s68, 22528
    s_add_u32 s70, s66, 131072
    buffer_load_dwordx4 v250, s[16:19], s70 offen lds
    s_add_u32 m0, s68, 26624
    s_add_u32 s70, s66, 262144
    buffer_load_dwordx4 v250, s[16:19], s70 offen lds
    s_add_u32 m0, s68, 30720
    s_add_u32 s70, s66, 393216
    buffer_load_dwordx4 v250, s[16:19], s70 offen lds
    s_add_u32 s66, s73, s26
    s_and_b32 s66, s66, 3
    s_andn2_b32 s64, s73, 3
    s_or_b32 s66, s66, s64
    s_andn2_b32 s64, s26, 3
    s_lshl_b32 s64, s64, 1
    s_add_u32 s66, s66, s64
    s_cmp_ge_u32 s66, 28
    s_cselect_b32 s64, 28, 0
    s_sub_u32 s66, s66, s64
    s_cmp_lt_u32 s73, 28
    s_cselect_b32 s66, s66, s73
    s_add_u32 s66, s66, s1
    s_and_b32 s66, s66, 31
    s_add_u32 s73, s73, 1
    s_mul_i32 s66, s66, 18432
    s_add_u32 m0, s67, 0
    s_add_u32 s70, s66, s67
    buffer_load_dwordx4 v251, s[20:23], s70 offen offset:0 sc1 lds
    buffer_load_dwordx4 v251, s[20:23], s70 offen offset:1024 sc1 lds
    buffer_load_dwordx4 v251, s[20:23], s70 offen offset:2048 sc1 lds
    buffer_load_dwordx4 v251, s[20:23], s70 offen offset:3072 sc1 lds
    s_add_u32 m0, s69, 0
    s_add_u32 s70, s66, s69
    s_mov_b64 exec, 0xffffffff
    buffer_load_dwordx4 v251, s[20:23], s70 offen sc1 lds
    s_mov_b64 exec, -1
    s_waitcnt vmcnt(18)
    s_barrier
    s_add_u32 s66, s72, s26
    s_and_b32 s66, s66, 3
    s_andn2_b32 s64, s72, 3
    s_or_b32 s66, s66, s64
    s_andn2_b32 s64, s26, 3
    s_lshl_b32 s64, s64, 1
    s_add_u32 s66, s66, s64
    s_cmp_ge_u32 s66, 28
    s_cselect_b32 s64, 28, 0
    s_sub_u32 s66, s66, s64
    s_cmp_lt_u32 s72, 28
    s_cselect_b32 s66, s66, s72
    s_add_u32 s66, s66, s1
    s_and_b32 s66, s66, 31
    s_add_u32 s72, s72, 1
    s_lshl_b32 s66, s66, 7
    s_add_u32 m0, s68, 53248
    s_add_u32 s70, s66, 0
    buffer_load_dwordx4 v250, s[16:19], s70 offen lds
    s_add_u32 m0, s68, 57344
    s_add_u32 s70, s66, 131072
    buffer_load_dwordx4 v250, s[16:19], s70 offen lds
    s_add_u32 m0, s68, 61440
    s_add_u32 s70, s66, 262144
    buffer_load_dwordx4 v250, s[16:19], s70 offen lds
    s_add_u32 m0, s68, 65536
    s_add_u32 s70, s66, 393216
    buffer_load_dwordx4 v250, s[16:19], s70 offen lds
    s_add_u32 s66, s73, s26
    s_and_b32 s66, s66, 3
    s_andn2_b32 s64, s73, 3
    s_or_b32 s66, s66, s64
    s_andn2_b32 s64, s26, 3
    s_lshl_b32 s64, s64, 1
    s_add_u32 s66, s66, s64
    s_cmp_ge_u32 s66, 28
    s_cselect_b32 s64, 28, 0
    s_sub_u32 s66, s66, s64
    s_cmp_lt_u32 s73, 28
    s_cselect_b32 s66, s66, s73
    s_add_u32 s66, s66, s1
    s_and_b32 s66, s66, 31
    s_add_u32 s73, s73, 1
    s_mul_i32 s66, s66, 18432
    s_add_u32 m0, s67, 34816
    s_add_u32 s70, s66, s67
    buffer_load_dwordx4 v251, s[20:23], s70 offen offset:0 sc1 lds
    buffer_load_dwordx4 v251, s[20:23], s70 offen offset:1024 sc1 lds
    buffer_load_dwordx4 v251, s[20:23], s70 offen offset:2048 sc1 lds
    buffer_load_dwordx4 v251, s[20:23], s70 offen offset:3072 sc1 lds
    s_add_u32 m0, s69, 34816
    s_add_u32 s70, s66, s69
    s_mov_b64 exec, 0xffffffff
    buffer_load_dwordx4 v251, s[20:23], s70 offen sc1 lds
    s_mov_b64 exec, -1
    s_waitcnt vmcnt(18)
    s_barrier
    s_add_u32 s66, s72, s26
    s_and_b32 s66, s66, 3
    s_andn2_b32 s64, s72, 3
    s_or_b32 s66, s66, s64
    s_andn2_b32 s64, s26, 3
    s_lshl_b32 s64, s64, 1
    s_add_u32 s66, s66, s64
    s_cmp_ge_u32 s66, 28
    s_cselect_b32 s64, 28, 0
    s_sub_u32 s66, s66, s64
    s_cmp_lt_u32 s72, 28
    s_cselect_b32 s66, s66, s72
    s_add_u32 s66, s66, s1
    s_and_b32 s66, s66, 31
    s_add_u32 s72, s72, 1
    s_lshl_b32 s66, s66, 7
    s_add_u32 m0, s68, 88064
    s_add_u32 s70, s66, 0
    buffer_load_dwordx4 v250, s[16:19], s70 offen lds
    s_add_u32 m0, s68, 92160
    s_add_u32 s70, s66, 131072
    buffer_load_dwordx4 v250, s[16:19], s70 offen lds
    s_add_u32 m0, s68, 96256
    s_add_u32 s70, s66, 262144
    buffer_load_dwordx4 v250, s[16:19], s70 offen lds
    s_add_u32 m0, s68, 100352
    s_add_u32 s70, s66, 393216
    buffer_load_dwordx4 v250, s[16:19], s70 offen lds
    s_add_u32 s66, s73, s26
    s_and_b32 s66, s66, 3
    s_andn2_b32 s64, s73, 3
    s_or_b32 s66, s66, s64
    s_andn2_b32 s64, s26, 3
    s_lshl_b32 s64, s64, 1
    s_add_u32 s66, s66, s64
    s_cmp_ge_u32 s66, 28
    s_cselect_b32 s64, 28, 0
    s_sub_u32 s66, s66, s64
    s_cmp_lt_u32 s73, 28
    s_cselect_b32 s66, s66, s73
    s_add_u32 s66, s66, s1
    s_and_b32 s66, s66, 31
    s_add_u32 s73, s73, 1
    s_mul_i32 s66, s66, 18432
    s_add_u32 m0, s67, 69632
    s_add_u32 s70, s66, s67
    buffer_load_dwordx4 v251, s[20:23], s70 offen offset:0 sc1 lds
    buffer_load_dwordx4 v251, s[20:23], s70 offen offset:1024 sc1 lds
    buffer_load_dwordx4 v251, s[20:23], s70 offen offset:2048 sc1 lds
    buffer_load_dwordx4 v251, s[20:23], s70 offen offset:3072 sc1 lds
    s_add_u32 m0, s69, 69632
    s_add_u32 s70, s66, s69
    s_mov_b64 exec, 0xffffffff
    buffer_load_dwordx4 v251, s[20:23], s70 offen sc1 lds
    s_mov_b64 exec, -1
    s_waitcnt vmcnt(18)
    s_barrier
    s_add_u32 s66, s72, s26
    s_and_b32 s66, s66, 3
    s_andn2_b32 s64, s72, 3
    s_or_b32 s66, s66, s64
    s_andn2_b32 s64, s26, 3
    s_lshl_b32 s64, s64, 1
    s_add_u32 s66, s66, s64
    s_cmp_ge_u32 s66, 28
    s_cselect_b32 s64, 28, 0
    s_sub_u32 s66, s66, s64
    s_cmp_lt_u32 s72, 28
    s_cselect_b32 s66, s66, s72
    s_add_u32 s66, s66, s1
    s_and_b32 s66, s66, 31
    s_add_u32 s72, s72, 1
    s_lshl_b32 s66, s66, 7
    s_add_u32 m0, s68, 122880
    s_add_u32 s70, s66, 0
    buffer_load_dwordx4 v250, s[16:19], s70 offen lds
    s_add_u32 m0, s68, 126976
    s_add_u32 s70, s66, 131072
    buffer_load_dwordx4 v250, s[16:19], s70 offen lds
    s_add_u32 m0, s68, 131072
    s_add_u32 s70, s66, 262144
    buffer_load_dwordx4 v250, s[16:19], s70 offen lds
    s_add_u32 m0, s68, 135168
    s_add_u32 s70, s66, 393216
    buffer_load_dwordx4 v250, s[16:19], s70 offen lds
    s_add_u32 s66, s73, s26
    s_and_b32 s66, s66, 3
    s_andn2_b32 s64, s73, 3
    s_or_b32 s66, s66, s64
    s_andn2_b32 s64, s26, 3
    s_lshl_b32 s64, s64, 1
    s_add_u32 s66, s66, s64
    s_cmp_ge_u32 s66, 28
    s_cselect_b32 s64, 28, 0
    s_sub_u32 s66, s66, s64
    s_cmp_lt_u32 s73, 28
    s_cselect_b32 s66, s66, s73
    s_add_u32 s66, s66, s1
    s_and_b32 s66, s66, 31
    s_add_u32 s73, s73, 1
    s_mul_i32 s66, s66, 18432
    s_add_u32 m0, s67, 104448
    s_add_u32 s70, s66, s67
    buffer_load_dwordx4 v251, s[20:23], s70 offen offset:0 sc1 lds
    buffer_load_dwordx4 v251, s[20:23], s70 offen offset:1024 sc1 lds
    buffer_load_dwordx4 v251, s[20:23], s70 offen offset:2048 sc1 lds
    buffer_load_dwordx4 v251, s[20:23], s70 offen offset:3072 sc1 lds
    s_add_u32 m0, s69, 104448
    s_add_u32 s70, s66, s69
    s_mov_b64 exec, 0xffffffff
    buffer_load_dwordx4 v251, s[20:23], s70 offen sc1 lds
    s_mov_b64 exec, -1
    s_waitcnt vmcnt(18)
    s_barrier
    s_add_u32 s66, s72, s26
    s_and_b32 s66, s66, 3
    s_andn2_b32 s64, s72, 3
    s_or_b32 s66, s66, s64
    s_andn2_b32 s64, s26, 3
    s_lshl_b32 s64, s64, 1
    s_add_u32 s66, s66, s64
    s_cmp_ge_u32 s66, 28
    s_cselect_b32 s64, 28, 0
    s_sub_u32 s66, s66, s64
    s_cmp_lt_u32 s72, 28
    s_cselect_b32 s66, s66, s72
    s_add_u32 s66, s66, s1
    s_and_b32 s66, s66, 31
    s_add_u32 s72, s72, 1
    s_lshl_b32 s66, s66, 7
    s_add_u32 m0, s68, 18432
    s_add_u32 s70, s66, 0
    buffer_load_dwordx4 v250, s[16:19], s70 offen lds
    s_add_u32 m0, s68, 22528
    s_add_u32 s70, s66, 131072
    buffer_load_dwordx4 v250, s[16:19], s70 offen lds
    s_add_u32 m0, s68, 26624
    s_add_u32 s70, s66, 262144
    buffer_load_dwordx4 v250, s[16:19], s70 offen lds
    s_add_u32 m0, s68, 30720
    s_add_u32 s70, s66, 393216
    buffer_load_dwordx4 v250, s[16:19], s70 offen lds
    s_add_u32 s66, s73, s26
    s_and_b32 s66, s66, 3
    s_andn2_b32 s64, s73, 3
    s_or_b32 s66, s66, s64
    s_andn2_b32 s64, s26, 3
    s_lshl_b32 s64, s64, 1
    s_add_u32 s66, s66, s64
    s_cmp_ge_u32 s66, 28
    s_cselect_b32 s64, 28, 0
    s_sub_u32 s66, s66, s64
    s_cmp_lt_u32 s73, 28
    s_cselect_b32 s66, s66, s73
    s_add_u32 s66, s66, s1
    s_and_b32 s66, s66, 31
    s_add_u32 s73, s73, 1
    s_mul_i32 s66, s66, 18432
    s_add_u32 m0, s67, 0
    s_add_u32 s70, s66, s67
    buffer_load_dwordx4 v251, s[20:23], s70 offen offset:0 sc1 lds
    buffer_load_dwordx4 v251, s[20:23], s70 offen offset:1024 sc1 lds
    buffer_load_dwordx4 v251, s[20:23], s70 offen offset:2048 sc1 lds
    buffer_load_dwordx4 v251, s[20:23], s70 offen offset:3072 sc1 lds
    s_add_u32 m0, s69, 0
    s_add_u32 s70, s66, s69
    s_mov_b64 exec, 0xffffffff
    buffer_load_dwordx4 v251, s[20:23], s70 offen sc1 lds
    s_mov_b64 exec, -1
    s_waitcnt vmcnt(18)
    s_barrier
    s_add_u32 s66, s72, s26
    s_and_b32 s66, s66, 3
    s_andn2_b32 s64, s72, 3
    s_or_b32 s66, s66, s64
    s_andn2_b32 s64, s26, 3
    s_lshl_b32 s64, s64, 1
    s_add_u32 s66, s66, s64
    s_cmp_ge_u32 s66, 28
    s_cselect_b32 s64, 28, 0
    s_sub_u32 s66, s66, s64
    s_cmp_lt_u32 s72, 28
    s_cselect_b32 s66, s66, s72
    s_add_u32 s66, s66, s1
    s_and_b32 s66, s66, 31
    s_add_u32 s72, s72, 1
    s_lshl_b32 s66, s66, 7
    s_add_u32 m0, s68, 53248
    s_add_u32 s70, s66, 0
    buffer_load_dwordx4 v250, s[16:19], s70 offen lds
    s_add_u32 m0, s68, 57344
    s_add_u32 s70, s66, 131072
    buffer_load_dwordx4 v250, s[16:19], s70 offen lds
    s_add_u32 m0, s68, 61440
    s_add_u32 s70, s66, 262144
    buffer_load_dwordx4 v250, s[16:19], s70 offen lds
    s_add_u32 m0, s68, 65536
    s_add_u32 s70, s66, 393216
    buffer_load_dwordx4 v250, s[16:19], s70 offen lds
    s_add_u32 s66, s73, s26
    s_and_b32 s66, s66, 3
    s_andn2_b32 s64, s73, 3
    s_or_b32 s66, s66, s64
    s_andn2_b32 s64, s26, 3
    s_lshl_b32 s64, s64, 1
    s_add_u32 s66, s66, s64
    s_cmp_ge_u32 s66, 28
    s_cselect_b32 s64, 28, 0
    s_sub_u32 s66, s66, s64
    s_cmp_lt_u32 s73, 28
    s_cselect_b32 s66, s66, s73
    s_add_u32 s66, s66, s1
    s_and_b32 s66, s66, 31
    s_add_u32 s73, s73, 1
    s_mul_i32 s66, s66, 18432
    s_add_u32 m0, s67, 34816
    s_add_u32 s70, s66, s67
    buffer_load_dwordx4 v251, s[20:23], s70 offen offset:0 sc1 lds
    buffer_load_dwordx4 v251, s[20:23], s70 offen offset:1024 sc1 lds
    buffer_load_dwordx4 v251, s[20:23], s70 offen offset:2048 sc1 lds
    buffer_load_dwordx4 v251, s[20:23], s70 offen offset:3072 sc1 lds
    s_add_u32 m0, s69, 34816
    s_add_u32 s70, s66, s69
    s_mov_b64 exec, 0xffffffff
    buffer_load_dwordx4 v251, s[20:23], s70 offen sc1 lds
    s_mov_b64 exec, -1
    s_waitcnt vmcnt(18)
    s_barrier
    s_cmp_ge_u32 s26, 9
    s_cbranch_scc1 gated_mix__ssm_conv_s4d__mixer_gmlp__prompt_kernel_Lnu1
    s_lshl_b32 s64, s30, 12
    s_add_u32 s64, s64, 37748736
    s_add_u32 s16, s62, s64
    s_addc_u32 s17, s63, 0
    s_mov_b32 s18, 4096
    s_mov_b32 s19, 0x20000
    s_mul_i32 s66, s25, 4608
    s_add_u32 m0, s66, 82400
    s_nop 0
    buffer_load_dwordx4 v2, s[16:19], 0 offen offset:0 sc1 lds
    buffer_load_dwordx4 v2, s[16:19], 0 offen offset:1024 sc1 lds
    buffer_load_dwordx4 v2, s[16:19], 0 offen offset:2048 sc1 lds
    buffer_load_dwordx4 v2, s[16:19], 0 offen offset:3072 sc1 lds
gated_mix__ssm_conv_s4d__mixer_gmlp__prompt_kernel_Lnu1:
    s_waitcnt vmcnt(9)
    s_barrier
    v_mov_b32 v4, 0
    v_mov_b32 v5, 0
    v_mov_b32 v6, 0
    v_mov_b32 v7, 0
    v_mov_b32 v8, 0
    v_mov_b32 v9, 0
    v_mov_b32 v10, 0
    v_mov_b32 v11, 0
    v_mov_b32 v12, 0
    v_mov_b32 v13, 0
    v_mov_b32 v14, 0
    v_mov_b32 v15, 0
    v_mov_b32 v16, 0
    v_mov_b32 v17, 0
    v_mov_b32 v18, 0
    v_mov_b32 v19, 0
    v_mov_b32 v20, 0
    v_mov_b32 v21, 0
    v_mov_b32 v22, 0
    v_mov_b32 v23, 0
    v_mov_b32 v24, 0
    v_mov_b32 v25, 0
    v_mov_b32 v26, 0
    v_mov_b32 v27, 0
    v_mov_b32 v28, 0
    v_mov_b32 v29, 0
    v_mov_b32 v30, 0
    v_mov_b32 v31, 0
    v_mov_b32 v32, 0
    v_mov_b32 v33, 0
    v_mov_b32 v34, 0
    v_mov_b32 v35, 0
    v_mov_b32 v36, 0
    v_mov_b32 v37, 0
    v_mov_b32 v38, 0
    v_mov_b32 v39, 0
    v_mov_b32 v40, 0
    v_mov_b32 v41, 0
    v_mov_b32 v42, 0
    v_mov_b32 v43, 0
    v_mov_b32 v44, 0
    v_mov_b32 v45, 0
    v_mov_b32 v46, 0
    v_mov_b32 v47, 0
    v_mov_b32 v48, 0
    v_mov_b32 v49, 0
    v_mov_b32 v50, 0
    v_mov_b32 v51, 0
    v_mov_b32 v52, 0
    v_mov_b32 v53, 0
    v_mov_b32 v54, 0
    v_mov_b32 v55, 0
    v_mov_b32 v56, 0
    v_mov_b32 v57, 0
    v_mov_b32 v58, 0
    v_mov_b32 v59, 0
    v_mov_b32 v60, 0
    v_mov_b32 v61, 0
    v_mov_b32 v62, 0
    v_mov_b32 v63, 0
    v_mov_b32 v64, 0
    v_mov_b32 v65, 0
    v_mov_b32 v66, 0
    v_mov_b32 v67, 0
    v_mov_b32 v68, 0
    v_mov_b32 v69, 0
    v_mov_b32 v70, 0
    v_mov_b32 v71, 0
    v_mov_b32 v72, 0
    v_mov_b32 v73, 0
    v_mov_b32 v74, 0
    v_mov_b32 v75, 0
    v_mov_b32 v76, 0
    v_mov_b32 v77, 0
    v_mov_b32 v78, 0
    v_mov_b32 v79, 0
    v_mov_b32 v80, 0
    v_mov_b32 v81, 0
    v_mov_b32 v82, 0
    v_mov_b32 v83, 0
    s_waitcnt vmcnt(0)
    buffer_load_dwordx4 v[84:87], v2, s[4:7], s0 offen offset:0 sc1
    buffer_load_dwordx4 v[88:91], v2, s[4:7], s0 offen offset:1024 sc1
    buffer_load_dwordx4 v[92:95], v2, s[4:7], s0 offen offset:2048 sc1
    buffer_load_dwordx4 v[96:99], v2, s[4:7], s0 offen offset:3072 sc1
    buffer_load_dwordx4 v[100:103], v3, s[4:7], s0 offen sc1
    s_add_u32 s0, s0, 18432
    s_cmp_ge_u32 s0, 331776
    s_cselect_b32 s24, 331776, 0
    s_sub_u32 s0, s0, s24
    s_barrier
    buffer_load_dwordx4 v[104:107], v2, s[4:7], s0 offen offset:0 sc1
    buffer_load_dwordx4 v[108:111], v2, s[4:7], s0 offen offset:1024 sc1
    buffer_load_dwordx4 v[112:115], v2, s[4:7], s0 offen offset:2048 sc1
    buffer_load_dwordx4 v[116:119], v2, s[4:7], s0 offen offset:3072 sc1
    buffer_load_dwordx4 v[120:123], v3, s[4:7], s0 offen sc1
    s_add_u32 s0, s0, 18432
    s_cmp_ge_u32 s0, 331776
    s_cselect_b32 s24, 331776, 0
    s_sub_u32 s0, s0, s24
    s_barrier
    s_barrier
    buffer_load_dwordx4 v[124:127], v2, s[4:7], s0 offen offset:0 sc1
    buffer_load_dwordx4 v[128:131], v2, s[4:7], s0 offen offset:1024 sc1
    buffer_load_dwordx4 v[132:135], v2, s[4:7], s0 offen offset:2048 sc1
    buffer_load_dwordx4 v[136:139], v2, s[4:7], s0 offen offset:3072 sc1
    buffer_load_dwordx4 v[140:143], v3, s[4:7], s0 offen sc1
    s_add_u32 s0, s0, 18432
    s_cmp_ge_u32 s0, 331776
    s_cselect_b32 s24, 331776, 0
    s_sub_u32 s0, s0, s24
    buffer_load_dwordx4 v[144:147], v2, s[4:7], s0 offen offset:0 sc1
    buffer_load_dwordx4 v[148:151], v2, s[4:7], s0 offen offset:1024 sc1
    buffer_load_dwordx4 v[152:155], v2, s[4:7], s0 offen offset:2048 sc1
    buffer_load_dwordx4 v[156:159], v2, s[4:7], s0 offen offset:3072 sc1
    buffer_load_dwordx4 v[160:163], v3, s[4:7], s0 offen sc1
    s_add_u32 s0, s0, 18432
    s_cmp_ge_u32 s0, 331776
    s_cselect_b32 s24, 331776, 0
    s_sub_u32 s0, s0, s24
    buffer_load_dwordx4 v[164:167], v2, s[4:7], s0 offen offset:0 sc1
    buffer_load_dwordx4 v[168:171], v2, s[4:7], s0 offen offset:1024 sc1
    buffer_load_dwordx4 v[172:175], v2, s[4:7], s0 offen offset:2048 sc1
    buffer_load_dwordx4 v[176:179], v2, s[4:7], s0 offen offset:3072 sc1
    buffer_load_dwordx4 v[180:183], v3, s[4:7], s0 offen sc1
    s_add_u32 s0, s0, 18432
    s_cmp_ge_u32 s0, 331776
    s_cselect_b32 s24, 331776, 0
    s_sub_u32 s0, s0, s24
    s_mul_i32 s73, s25, 20480
    s_mul_i32 s70, s25, 4608
    s_lshl_b32 s71, s25, 12
    s_add_u32 m0, s73, 0
    s_add_u32 s74, s70, 221184
    buffer_load_dwordx4 v2, s[4:7], s74 offen offset:0 sc1 lds
    buffer_load_dwordx4 v2, s[4:7], s74 offen offset:1024 sc1 lds
    buffer_load_dwordx4 v2, s[4:7], s74 offen offset:2048 sc1 lds
    buffer_load_dwordx4 v2, s[4:7], s74 offen offset:3072 sc1 lds
    s_add_u32 m0, s73, 4096
    s_add_u32 s24, s74, 4096
    s_mov_b64 exec, 0xffffffff
    buffer_load_dwordx4 v2, s[4:7], s24 offen sc1 lds
    s_mov_b64 exec, -1
    s_add_u32 m0, s73, 4608
    s_add_u32 s74, s70, 239616
    buffer_load_dwordx4 v2, s[4:7], s74 offen offset:0 sc1 lds
    buffer_load_dwordx4 v2, s[4:7], s74 offen offset:1024 sc1 lds
    buffer_load_dwordx4 v2, s[4:7], s74 offen offset:2048 sc1 lds
    buffer_load_dwordx4 v2, s[4:7], s74 offen offset:3072 sc1 lds
    s_add_u32 m0, s73, 8704
    s_add_u32 s24, s74, 4096
    s_mov_b64 exec, 0xffffffff
    buffer_load_dwordx4 v2, s[4:7], s24 offen sc1 lds
    s_mov_b64 exec, -1
    s_add_u32 m0, s73, 9216
    s_add_u32 s74, s70, 258048
    buffer_load_dwordx4 v2, s[4:7], s74 offen offset:0 sc1 lds
    buffer_load_dwordx4 v2, s[4:7], s74 offen offset:1024 sc1 lds
    buffer_load_dwordx4 v2, s[4:7], s74 offen offset:2048 sc1 lds
    buffer_load_dwordx4 v2, s[4:7], s74 offen offset:3072 sc1 lds
    s_add_u32 m0, s73, 13312
    s_add_u32 s24, s74, 4096
    s_mov_b64 exec, 0xffffffff
    buffer_load_dwordx4 v2, s[4:7], s24 offen sc1 lds
    s_mov_b64 exec, -1
    s_add_u32 m0, s73, 13824
    s_add_u32 s74, s70, 276480
    buffer_load_dwordx4 v2, s[4:7], s74 offen offset:0 sc1 lds
    buffer_load_dwordx4 v2, s[4:7], s74 offen offset:1024 sc1 lds
    buffer_load_dwordx4 v2, s[4:7], s74 offen offset:2048 sc1 lds
    buffer_load_dwordx4 v2, s[4:7], s74 offen offset:3072 sc1 lds
    s_add_u32 m0, s73, 17920
    s_add_u32 s24, s74, 4096
    s_mov_b64 exec, 0xffffffff
    buffer_load_dwordx4 v2, s[4:7], s24 offen sc1 lds
    s_mov_b64 exec, -1
    v_add_u32 v1, s73, v2
    v_add_u32 v3, s73, v3
    v_subrev_u32 v255, s73, v3
    s_cmp_lg_u32 s25, 0
    s_cbranch_scc1 gated_mix__ssm_conv_s4d__mixer_gmlp__prompt_kernel_Lgh_oth
    s_lshl_b32 s64, s75, 8
    s_add_u32 s64, s64, 65536
    v_min_u32 v250, 15, v0
    v_lshlrev_b32 v250, 2, v250
    s_mov_b32 s65, 0
    buffer_load_dword v251, v250, s[8:11], s64 offen sc1
    s_sleep 4
gated_mix__ssm_conv_s4d__mixer_gmlp__prompt_kernel_Lh_poll:
    buffer_load_dword v252, v250, s[8:11], s64 offen sc1
    s_waitcnt vmcnt(1)
    v_cmp_eq_u32 vcc, 0, v251
    s_add_u32 s65, s65, 1
    s_cmp_eq_u64 vcc, 0
    s_cbranch_scc1 gated_mix__ssm_conv_s4d__mixer_gmlp__prompt_kernel_Lh_ok
    s_sleep 4
    buffer_load_dword v251, v250, s[8:11], s64 offen sc1
    s_waitcnt vmcnt(1)
    v_cmp_eq_u32 vcc, 0, v252
    s_add_u32 s65, s65, 1
    s_cmp_eq_u64 vcc, 0
    s_cbranch_scc1 gated_mix__ssm_conv_s4d__mixer_gmlp__prompt_kernel_Lh_ok
    s_sleep 4
    s_cmp_lt_u32 s65, 100000
    s_cbranch_scc1 gated_mix__ssm_conv_s4d__mixer_gmlp__prompt_kernel_Lh_poll
gated_mix__ssm_conv_s4d__mixer_gmlp__prompt_kernel_Lh_ok:
    v_mov_b32 v248, 163604
    v_mov_b32 v249, 1
    ds_write_b32 v248, v249
    s_branch gated_mix__ssm_conv_s4d__mixer_gmlp__prompt_kernel_Lgh_done
gated_mix__ssm_conv_s4d__mixer_gmlp__prompt_kernel_Lgh_oth:
    v_mov_b32 v248, 163604
    s_mov_b32 s65, 0
gated_mix__ssm_conv_s4d__mixer_gmlp__prompt_kernel_Lgh_spin:
    ds_read_b32 v249, v248
    s_waitcnt lgkmcnt(0)
    v_readfirstlane_b32 s66, v249
    s_add_u32 s65, s65, 1
    s_cmp_lg_u32 s66, 0
    s_cbranch_scc1 gated_mix__ssm_conv_s4d__mixer_gmlp__prompt_kernel_Lgh_done
    s_sleep 1
    s_cmp_lt_u32 s65, 2000000
    s_cbranch_scc1 gated_mix__ssm_conv_s4d__mixer_gmlp__prompt_kernel_Lgh_spin
gated_mix__ssm_conv_s4d__mixer_gmlp__prompt_kernel_Lgh_done:
    buffer_load_dwordx4 v[184:187], v2, s[12:15], s31 offen offset:0 sc1
    buffer_load_dwordx4 v[188:191], v2, s[12:15], s31 offen offset:1024 sc1
    buffer_load_dwordx4 v[192:195], v2, s[12:15], s31 offen offset:2048 sc1
    buffer_load_dwordx4 v[196:199], v2, s[12:15], s31 offen offset:3072 sc1
    s_add_u32 s31, s31, 16384
    s_cmp_ge_u32 s31, 294912
    s_cselect_b32 s24, 294912, 0
    s_sub_u32 s31, s31, s24
    buffer_load_dwordx4 v[200:203], v2, s[12:15], s31 offen offset:0 sc1
    buffer_load_dwordx4 v[204:207], v2, s[12:15], s31 offen offset:1024 sc1
    buffer_load_dwordx4 v[208:211], v2, s[12:15], s31 offen offset:2048 sc1
    buffer_load_dwordx4 v[212:215], v2, s[12:15], s31 offen offset:3072 sc1
    s_add_u32 s31, s31, 16384
    s_cmp_ge_u32 s31, 294912
    s_cselect_b32 s24, 294912, 0
    s_sub_u32 s31, s31, s24
    buffer_load_dwordx4 v[216:219], v2, s[12:15], s31 offen offset:0 sc1
    buffer_load_dwordx4 v[220:223], v2, s[12:15], s31 offen offset:1024 sc1
    buffer_load_dwordx4 v[224:227], v2, s[12:15], s31 offen offset:2048 sc1
    buffer_load_dwordx4 v[228:231], v2, s[12:15], s31 offen offset:3072 sc1
    s_add_u32 s31, s31, 16384
    s_cmp_ge_u32 s31, 294912
    s_cselect_b32 s24, 294912, 0
    s_sub_u32 s31, s31, s24
    buffer_load_dwordx4 v[232:235], v2, s[12:15], s31 offen offset:0 sc1
    buffer_load_dwordx4 v[236:239], v2, s[12:15], s31 offen offset:1024 sc1
    buffer_load_dwordx4 v[240:243], v2, s[12:15], s31 offen offset:2048 sc1
    buffer_load_dwordx4 v[244:247], v2, s[12:15], s31 offen offset:3072 sc1
    s_add_u32 s31, s31, 16384
    s_cmp_ge_u32 s31, 294912
    s_cselect_b32 s24, 294912, 0
    s_sub_u32 s31, s31, s24
    s_waitcnt vmcnt(12)
    s_add_u32 s31, s71, 65536
    v_mfma_f32_16x16x32_bf16 v[4:7], v[84:87], v[184:187], v[4:7]
    v_mfma_f32_16x16x32_bf16 v[8:11], v[88:91], v[184:187], v[8:11]
    v_mfma_f32_16x16x32_bf16 v[12:15], v[92:95], v[184:187], v[12:15]
    v_mfma_f32_16x16x32_bf16 v[16:19], v[96:99], v[184:187], v[16:19]
    v_mfma_f32_16x16x32_bf16 v[20:23], v[100:103], v[184:187], v[20:23]
    buffer_load_dwordx4 v[184:187], v2, s[12:15], s31 offen offset:0 sc1
    v_mfma_f32_16x16x32_bf16 v[24:27], v[84:87], v[188:191], v[24:27]
    v_mfma_f32_16x16x32_bf16 v[28:31], v[88:91], v[188:191], v[28:31]
    v_mfma_f32_16x16x32_bf16 v[32:35], v[92:95], v[188:191], v[32:35]
    v_mfma_f32_16x16x32_bf16 v[36:39], v[96:99], v[188:191], v[36:39]
    v_mfma_f32_16x16x32_bf16 v[40:43], v[100:103], v[188:191], v[40:43]
    buffer_load_dwordx4 v[188:191], v2, s[12:15], s31 offen offset:1024 sc1
    v_mfma_f32_16x16x32_bf16 v[44:47], v[84:87], v[192:195], v[44:47]
    v_mfma_f32_16x16x32_bf16 v[48:51], v[88:91], v[192:195], v[48:51]
    v_mfma_f32_16x16x32_bf16 v[52:55], v[92:95], v[192:195], v[52:55]
    v_mfma_f32_16x16x32_bf16 v[56:59], v[96:99], v[192:195], v[56:59]
    v_mfma_f32_16x16x32_bf16 v[60:63], v[100:103], v[192:195], v[60:63]
    buffer_load_dwordx4 v[192:195], v2, s[12:15], s31 offen offset:2048 sc1
    v_mfma_f32_16x16x32_bf16 v[64:67], v[84:87], v[196:199], v[64:67]
    v_mfma_f32_16x16x32_bf16 v[68:71], v[88:91], v[196:199], v[68:71]
    v_mfma_f32_16x16x32_bf16 v[72:75], v[92:95], v[196:199], v[72:75]
    v_mfma_f32_16x16x32_bf16 v[76:79], v[96:99], v[196:199], v[76:79]
    v_mfma_f32_16x16x32_bf16 v[80:83], v[100:103], v[196:199], v[80:83]
    buffer_load_dwordx4 v[196:199], v2, s[12:15], s31 offen offset:3072 sc1
    s_waitcnt vmcnt(12)
    s_add_u32 s31, s71, 81920
    s_add_u32 s0, s70, 92160
    v_mfma_f32_16x16x32_bf16 v[4:7], v[104:107], v[200:203], v[4:7]
    buffer_load_dwordx4 v[84:87], v2, s[4:7], s0 offen offset:0 sc1
    v_mfma_f32_16x16x32_bf16 v[8:11], v[108:111], v[200:203], v[8:11]
    v_mfma_f32_16x16x32_bf16 v[12:15], v[112:115], v[200:203], v[12:15]
    buffer_load_dwordx4 v[88:91], v2, s[4:7], s0 offen offset:1024 sc1
    v_mfma_f32_16x16x32_bf16 v[16:19], v[116:119], v[200:203], v[16:19]
    v_mfma_f32_16x16x32_bf16 v[20:23], v[120:123], v[200:203], v[20:23]
    buffer_load_dwordx4 v[200:203], v2, s[12:15], s31 offen offset:0 sc1
    v_mfma_f32_16x16x32_bf16 v[24:27], v[104:107], v[204:207], v[24:27]
    v_mfma_f32_16x16x32_bf16 v[28:31], v[108:111], v[204:207], v[28:31]
    v_mfma_f32_16x16x32_bf16 v[32:35], v[112:115], v[204:207], v[32:35]
    buffer_load_dwordx4 v[92:95], v2, s[4:7], s0 offen offset:2048 sc1
    v_mfma_f32_16x16x32_bf16 v[36:39], v[116:119], v[204:207], v[36:39]
    v_mfma_f32_16x16x32_bf16 v[40:43], v[120:123], v[204:207], v[40:43]
    buffer_load_dwordx4 v[204:207], v2, s[12:15], s31 offen offset:1024 sc1
    v_mfma_f32_16x16x32_bf16 v[44:47], v[104:107], v[208:211], v[44:47]
    v_mfma_f32_16x16x32_bf16 v[48:51], v[108:111], v[208:211], v[48:51]
    v_mfma_f32_16x16x32_bf16 v[52:55], v[112:115], v[208:211], v[52:55]
    buffer_load_dwordx4 v[96:99], v2, s[4:7], s0 offen offset:3072 sc1
    v_mfma_f32_16x16x32_bf16 v[56:59], v[116:119], v[208:211], v[56:59]
    v_mfma_f32_16x16x32_bf16 v[60:63], v[120:123], v[208:211], v[60:63]
    buffer_load_dwordx4 v[208:211], v2, s[12:15], s31 offen offset:2048 sc1
    v_mfma_f32_16x16x32_bf16 v[64:67], v[104:107], v[212:215], v[64:67]
    v_mfma_f32_16x16x32_bf16 v[68:71], v[108:111], v[212:215], v[68:71]
    v_mfma_f32_16x16x32_bf16 v[72:75], v[112:115], v[212:215], v[72:75]
    buffer_load_dwordx4 v[100:103], v255, s[4:7], s0 offen sc1
    v_mfma_f32_16x16x32_bf16 v[76:79], v[116:119], v[212:215], v[76:79]
    v_mfma_f32_16x16x32_bf16 v[80:83], v[120:123], v[212:215], v[80:83]
    buffer_load_dwordx4 v[212:215], v2, s[12:15], s31 offen offset:3072 sc1
    s_waitcnt vmcnt(17)
    s_add_u32 s31, s71, 262144
    s_add_u32 s0, s70, 294912
    v_mfma_f32_16x16x32_bf16 v[4:7], v[124:127], v[216:219], v[4:7]
    buffer_load_dwordx4 v[104:107], v2, s[4:7], s0 offen offset:0 sc1
    v_mfma_f32_16x16x32_bf16 v[8:11], v[128:131], v[216:219], v[8:11]
    v_mfma_f32_16x16x32_bf16 v[12:15], v[132:135], v[216:219], v[12:15]
    buffer_load_dwordx4 v[108:111], v2, s[4:7], s0 offen offset:1024 sc1
    v_mfma_f32_16x16x32_bf16 v[16:19], v[136:139], v[216:219], v[16:19]
    v_mfma_f32_16x16x32_bf16 v[20:23], v[140:143], v[216:219], v[20:23]
    buffer_load_dwordx4 v[216:219], v2, s[12:15], s31 offen offset:0 sc1
    v_mfma_f32_16x16x32_bf16 v[24:27], v[124:127], v[220:223], v[24:27]
    v_mfma_f32_16x16x32_bf16 v[28:31], v[128:131], v[220:223], v[28:31]
    v_mfma_f32_16x16x32_bf16 v[32:35], v[132:135], v[220:223], v[32:35]
    buffer_load_dwordx4 v[112:115], v2, s[4:7], s0 offen offset:2048 sc1
    v_mfma_f32_16x16x32_bf16 v[36:39], v[136:139], v[220:223], v[36:39]
    v_mfma_f32_16x16x32_bf16 v[40:43], v[140:143], v[220:223], v[40:43]
    buffer_load_dwordx4 v[220:223], v2, s[12:15], s31 offen offset:1024 sc1
    v_mfma_f32_16x16x32_bf16 v[44:47], v[124:127], v[224:227], v[44:47]
    v_mfma_f32_16x16x32_bf16 v[48:51], v[128:131], v[224:227], v[48:51]
    v_mfma_f32_16x16x32_bf16 v[52:55], v[132:135], v[224:227], v[52:55]
    buffer_load_dwordx4 v[116:119], v2, s[4:7], s0 offen offset:3072 sc1
    v_mfma_f32_16x16x32_bf16 v[56:59], v[136:139], v[224:227], v[56:59]
    v_mfma_f32_16x16x32_bf16 v[60:63], v[140:143], v[224:227], v[60:63]
    buffer_load_dwordx4 v[224:227], v2, s[12:15], s31 offen offset:2048 sc1
    v_mfma_f32_16x16x32_bf16 v[64:67], v[124:127], v[228:231], v[64:67]
    v_mfma_f32_16x16x32_bf16 v[68:71], v[128:131], v[228:231], v[68:71]
    v_mfma_f32_16x16x32_bf16 v[72:75], v[132:135], v[228:231], v[72:75]
    buffer_load_dwordx4 v[120:123], v255, s[4:7], s0 offen sc1
    v_mfma_f32_16x16x32_bf16 v[76:79], v[136:139], v[228:231], v[76:79]
    v_mfma_f32_16x16x32_bf16 v[80:83], v[140:143], v[228:231], v[80:83]
    buffer_load_dwordx4 v[228:231], v2, s[12:15], s31 offen offset:3072 sc1
    s_waitcnt vmcnt(22)
    s_add_u32 s31, s71, 278528
    s_add_u32 s0, s70, 313344
    v_mfma_f32_16x16x32_bf16 v[4:7], v[144:147], v[232:235], v[4:7]
    buffer_load_dwordx4 v[124:127], v2, s[4:7], s0 offen offset:0 sc1
    v_mfma_f32_16x16x32_bf16 v[8:11], v[148:151], v[232:235], v[8:11]
    v_mfma_f32_16x16x32_bf16 v[12:15], v[152:155], v[232:235], v[12:15]
    buffer_load_dwordx4 v[128:131], v2, s[4:7], s0 offen offset:1024 sc1
    v_mfma_f32_16x16x32_bf16 v[16:19], v[156:159], v[232:235], v[16:19]
    v_mfma_f32_16x16x32_bf16 v[20:23], v[160:163], v[232:235], v[20:23]
    buffer_load_dwordx4 v[232:235], v2, s[12:15], s31 offen offset:0 sc1
    v_mfma_f32_16x16x32_bf16 v[24:27], v[144:147], v[236:239], v[24:27]
    v_mfma_f32_16x16x32_bf16 v[28:31], v[148:151], v[236:239], v[28:31]
    v_mfma_f32_16x16x32_bf16 v[32:35], v[152:155], v[236:239], v[32:35]
    buffer_load_dwordx4 v[132:135], v2, s[4:7], s0 offen offset:2048 sc1
    v_mfma_f32_16x16x32_bf16 v[36:39], v[156:159], v[236:239], v[36:39]
    v_mfma_f32_16x16x32_bf16 v[40:43], v[160:163], v[236:239], v[40:43]
    buffer_load_dwordx4 v[236:239], v2, s[12:15], s31 offen offset:1024 sc1
    v_mfma_f32_16x16x32_bf16 v[44:47], v[144:147], v[240:243], v[44:47]
    v_mfma_f32_16x16x32_bf16 v[48:51], v[148:151], v[240:243], v[48:51]
    v_mfma_f32_16x16x32_bf16 v[52:55], v[152:155], v[240:243], v[52:55]
    buffer_load_dwordx4 v[136:139], v2, s[4:7], s0 offen offset:3072 sc1
    v_mfma_f32_16x16x32_bf16 v[56:59], v[156:159], v[240:243], v[56:59]
    v_mfma_f32_16x16x32_bf16 v[60:63], v[160:163], v[240:243], v[60:63]
    buffer_load_dwordx4 v[240:243], v2, s[12:15], s31 offen offset:2048 sc1
    v_mfma_f32_16x16x32_bf16 v[64:67], v[144:147], v[244:247], v[64:67]
    v_mfma_f32_16x16x32_bf16 v[68:71], v[148:151], v[244:247], v[68:71]
    v_mfma_f32_16x16x32_bf16 v[72:75], v[152:155], v[244:247], v[72:75]
    buffer_load_dwordx4 v[140:143], v255, s[4:7], s0 offen sc1
    v_mfma_f32_16x16x32_bf16 v[76:79], v[156:159], v[244:247], v[76:79]
    v_mfma_f32_16x16x32_bf16 v[80:83], v[160:163], v[244:247], v[80:83]
    buffer_load_dwordx4 v[244:247], v2, s[12:15], s31 offen offset:3072 sc1
    s_waitcnt vmcnt(27)
    s_add_u32 s31, s71, 98304
    s_add_u32 s0, s70, 110592
    v_mfma_f32_16x16x32_bf16 v[4:7], v[164:167], v[184:187], v[4:7]
    buffer_load_dwordx4 v[144:147], v2, s[4:7], s0 offen offset:0 sc1
    v_mfma_f32_16x16x32_bf16 v[8:11], v[168:171], v[184:187], v[8:11]
    v_mfma_f32_16x16x32_bf16 v[12:15], v[172:175], v[184:187], v[12:15]
    buffer_load_dwordx4 v[148:151], v2, s[4:7], s0 offen offset:1024 sc1
    v_mfma_f32_16x16x32_bf16 v[16:19], v[176:179], v[184:187], v[16:19]
    v_mfma_f32_16x16x32_bf16 v[20:23], v[180:183], v[184:187], v[20:23]
    buffer_load_dwordx4 v[184:187], v2, s[12:15], s31 offen offset:0 sc1
    v_mfma_f32_16x16x32_bf16 v[24:27], v[164:167], v[188:191], v[24:27]
    v_mfma_f32_16x16x32_bf16 v[28:31], v[168:171], v[188:191], v[28:31]
    v_mfma_f32_16x16x32_bf16 v[32:35], v[172:175], v[188:191], v[32:35]
    buffer_load_dwordx4 v[152:155], v2, s[4:7], s0 offen offset:2048 sc1
    v_mfma_f32_16x16x32_bf16 v[36:39], v[176:179], v[188:191], v[36:39]
    v_mfma_f32_16x16x32_bf16 v[40:43], v[180:183], v[188:191], v[40:43]
    buffer_load_dwordx4 v[188:191], v2, s[12:15], s31 offen offset:1024 sc1
    v_mfma_f32_16x16x32_bf16 v[44:47], v[164:167], v[192:195], v[44:47]
    v_mfma_f32_16x16x32_bf16 v[48:51], v[168:171], v[192:195], v[48:51]
    v_mfma_f32_16x16x32_bf16 v[52:55], v[172:175], v[192:195], v[52:55]
    buffer_load_dwordx4 v[156:159], v2, s[4:7], s0 offen offset:3072 sc1
    v_mfma_f32_16x16x32_bf16 v[56:59], v[176:179], v[192:195], v[56:59]
    v_mfma_f32_16x16x32_bf16 v[60:63], v[180:183], v[192:195], v[60:63]
    buffer_load_dwordx4 v[192:195], v2, s[12:15], s31 offen offset:2048 sc1
    v_mfma_f32_16x16x32_bf16 v[64:67], v[164:167], v[196:199], v[64:67]
    v_mfma_f32_16x16x32_bf16 v[68:71], v[168:171], v[196:199], v[68:71]
    v_mfma_f32_16x16x32_bf16 v[72:75], v[172:175], v[196:199], v[72:75]
    buffer_load_dwordx4 v[160:163], v255, s[4:7], s0 offen sc1
    v_mfma_f32_16x16x32_bf16 v[76:79], v[176:179], v[196:199], v[76:79]
    v_mfma_f32_16x16x32_bf16 v[80:83], v[180:183], v[196:199], v[80:83]
    buffer_load_dwordx4 v[196:199], v2, s[12:15], s31 offen offset:3072 sc1
    s_waitcnt vmcnt(27)
    s_add_u32 s31, s71, 114688
    s_add_u32 s0, s70, 129024
    v_mfma_f32_16x16x32_bf16 v[4:7], v[84:87], v[200:203], v[4:7]
    buffer_load_dwordx4 v[164:167], v2, s[4:7], s0 offen offset:0 sc1
    v_mfma_f32_16x16x32_bf16 v[8:11], v[88:91], v[200:203], v[8:11]
    v_mfma_f32_16x16x32_bf16 v[12:15], v[92:95], v[200:203], v[12:15]
    buffer_load_dwordx4 v[168:171], v2, s[4:7], s0 offen offset:1024 sc1
    v_mfma_f32_16x16x32_bf16 v[16:19], v[96:99], v[200:203], v[16:19]
    v_mfma_f32_16x16x32_bf16 v[20:23], v[100:103], v[200:203], v[20:23]
    buffer_load_dwordx4 v[200:203], v2, s[12:15], s31 offen offset:0 sc1
    v_mfma_f32_16x16x32_bf16 v[24:27], v[84:87], v[204:207], v[24:27]
    v_mfma_f32_16x16x32_bf16 v[28:31], v[88:91], v[204:207], v[28:31]
    v_mfma_f32_16x16x32_bf16 v[32:35], v[92:95], v[204:207], v[32:35]
    buffer_load_dwordx4 v[172:175], v2, s[4:7], s0 offen offset:2048 sc1
    v_mfma_f32_16x16x32_bf16 v[36:39], v[96:99], v[204:207], v[36:39]
    v_mfma_f32_16x16x32_bf16 v[40:43], v[100:103], v[204:207], v[40:43]
    buffer_load_dwordx4 v[204:207], v2, s[12:15], s31 offen offset:1024 sc1
    v_mfma_f32_16x16x32_bf16 v[44:47], v[84:87], v[208:211], v[44:47]
    v_mfma_f32_16x16x32_bf16 v[48:51], v[88:91], v[208:211], v[48:51]
    v_mfma_f32_16x16x32_bf16 v[52:55], v[92:95], v[208:211], v[52:55]
    buffer_load_dwordx4 v[176:179], v2, s[4:7], s0 offen offset:3072 sc1
    v_mfma_f32_16x16x32_bf16 v[56:59], v[96:99], v[208:211], v[56:59]
    v_mfma_f32_16x16x32_bf16 v[60:63], v[100:103], v[208:211], v[60:63]
    buffer_load_dwordx4 v[208:211], v2, s[12:15], s31 offen offset:2048 sc1
    v_mfma_f32_16x16x32_bf16 v[64:67], v[84:87], v[212:215], v[64:67]
    v_mfma_f32_16x16x32_bf16 v[68:71], v[88:91], v[212:215], v[68:71]
    v_mfma_f32_16x16x32_bf16 v[72:75], v[92:95], v[212:215], v[72:75]
    buffer_load_dwordx4 v[180:183], v255, s[4:7], s0 offen sc1
    v_mfma_f32_16x16x32_bf16 v[76:79], v[96:99], v[212:215], v[76:79]
    v_mfma_f32_16x16x32_bf16 v[80:83], v[100:103], v[212:215], v[80:83]
    buffer_load_dwordx4 v[212:215], v2, s[12:15], s31 offen offset:3072 sc1
    s_waitcnt vmcnt(27)
    s_add_u32 s31, s71, 131072
    s_add_u32 s0, s70, 147456
    v_mfma_f32_16x16x16_bf16 v[4:7], v[104:105], v[216:217], v[4:7]
    v_mfma_f32_16x16x16_bf16 v[4:7], v[106:107], v[224:225], v[4:7]
    buffer_load_dwordx4 v[84:87], v2, s[4:7], s0 offen offset:0 sc1
    v_mfma_f32_16x16x16_bf16 v[8:11], v[108:109], v[216:217], v[8:11]
    v_mfma_f32_16x16x16_bf16 v[8:11], v[110:111], v[224:225], v[8:11]
    v_mfma_f32_16x16x16_bf16 v[12:15], v[112:113], v[216:217], v[12:15]
    v_mfma_f32_16x16x16_bf16 v[12:15], v[114:115], v[224:225], v[12:15]
    buffer_load_dwordx4 v[88:91], v2, s[4:7], s0 offen offset:1024 sc1
    v_mfma_f32_16x16x16_bf16 v[16:19], v[116:117], v[216:217], v[16:19]
    v_mfma_f32_16x16x16_bf16 v[16:19], v[118:119], v[224:225], v[16:19]
    v_mfma_f32_16x16x16_bf16 v[20:23], v[120:121], v[216:217], v[20:23]
    v_mfma_f32_16x16x16_bf16 v[20:23], v[122:123], v[224:225], v[20:23]
    v_mfma_f32_16x16x16_bf16 v[24:27], v[104:105], v[218:219], v[24:27]
    v_mfma_f32_16x16x16_bf16 v[24:27], v[106:107], v[226:227], v[24:27]
    v_mfma_f32_16x16x16_bf16 v[28:31], v[108:109], v[218:219], v[28:31]
    v_mfma_f32_16x16x16_bf16 v[28:31], v[110:111], v[226:227], v[28:31]
    v_mfma_f32_16x16x16_bf16 v[32:35], v[112:113], v[218:219], v[32:35]
    v_mfma_f32_16x16x16_bf16 v[32:35], v[114:115], v[226:227], v[32:35]
    buffer_load_dwordx4 v[92:95], v2, s[4:7], s0 offen offset:2048 sc1
    v_mfma_f32_16x16x16_bf16 v[36:39], v[116:117], v[218:219], v[36:39]
    v_mfma_f32_16x16x16_bf16 v[36:39], v[118:119], v[226:227], v[36:39]
    v_mfma_f32_16x16x16_bf16 v[40:43], v[120:121], v[218:219], v[40:43]
    v_mfma_f32_16x16x16_bf16 v[40:43], v[122:123], v[226:227], v[40:43]
    buffer_load_dwordx4 v[216:219], v2, s[12:15], s31 offen offset:0 sc1
    buffer_load_dwordx4 v[224:227], v2, s[12:15], s31 offen offset:2048 sc1
    v_mfma_f32_16x16x16_bf16 v[44:47], v[104:105], v[220:221], v[44:47]
    v_mfma_f32_16x16x16_bf16 v[44:47], v[106:107], v[228:229], v[44:47]
    v_mfma_f32_16x16x16_bf16 v[48:51], v[108:109], v[220:221], v[48:51]
    v_mfma_f32_16x16x16_bf16 v[48:51], v[110:111], v[228:229], v[48:51]
    v_mfma_f32_16x16x16_bf16 v[52:55], v[112:113], v[220:221], v[52:55]
    v_mfma_f32_16x16x16_bf16 v[52:55], v[114:115], v[228:229], v[52:55]
    buffer_load_dwordx4 v[96:99], v2, s[4:7], s0 offen offset:3072 sc1
    v_mfma_f32_16x16x16_bf16 v[56:59], v[116:117], v[220:221], v[56:59]
    v_mfma_f32_16x16x16_bf16 v[56:59], v[118:119], v[228:229], v[56:59]
    v_mfma_f32_16x16x16_bf16 v[60:63], v[120:121], v[220:221], v[60:63]
    v_mfma_f32_16x16x16_bf16 v[60:63], v[122:123], v[228:229], v[60:63]
    v_mfma_f32_16x16x16_bf16 v[64:67], v[104:105], v[222:223], v[64:67]
    v_mfma_f32_16x16x16_bf16 v[64:67], v[106:107], v[230:231], v[64:67]
    v_mfma_f32_16x16x16_bf16 v[68:71], v[108:109], v[222:223], v[68:71]
    v_mfma_f32_16x16x16_bf16 v[68:71], v[110:111], v[230:231], v[68:71]
    v_mfma_f32_16x16x16_bf16 v[72:75], v[112:113], v[222:223], v[72:75]
    v_mfma_f32_16x16x16_bf16 v[72:75], v[114:115], v[230:231], v[72:75]
    buffer_load_dwordx4 v[100:103], v255, s[4:7], s0 offen sc1
    v_mfma_f32_16x16x16_bf16 v[76:79], v[116:117], v[222:223], v[76:79]
    v_mfma_f32_16x16x16_bf16 v[76:79], v[118:119], v[230:231], v[76:79]
    v_mfma_f32_16x16x16_bf16 v[80:83], v[120:121], v[222:223], v[80:83]
    v_mfma_f32_16x16x16_bf16 v[80:83], v[122:123], v[230:231], v[80:83]
    buffer_load_dwordx4 v[220:223], v2, s[12:15], s31 offen offset:1024 sc1
    buffer_load_dwordx4 v[228:231], v2, s[12:15], s31 offen offset:3072 sc1
    s_waitcnt vmcnt(27)
    s_add_u32 s31, s71, 147456
    s_add_u32 s0, s70, 165888
    v_mfma_f32_16x16x16_bf16 v[4:7], v[124:125], v[232:233], v[4:7]
    v_mfma_f32_16x16x16_bf16 v[4:7], v[126:127], v[240:241], v[4:7]
    buffer_load_dwordx4 v[104:107], v2, s[4:7], s0 offen offset:0 sc1
    v_mfma_f32_16x16x16_bf16 v[8:11], v[128:129], v[232:233], v[8:11]
    v_mfma_f32_16x16x16_bf16 v[8:11], v[130:131], v[240:241], v[8:11]
    v_mfma_f32_16x16x16_bf16 v[12:15], v[132:133], v[232:233], v[12:15]
    v_mfma_f32_16x16x16_bf16 v[12:15], v[134:135], v[240:241], v[12:15]
    buffer_load_dwordx4 v[108:111], v2, s[4:7], s0 offen offset:1024 sc1
    v_mfma_f32_16x16x16_bf16 v[16:19], v[136:137], v[232:233], v[16:19]
    v_mfma_f32_16x16x16_bf16 v[16:19], v[138:139], v[240:241], v[16:19]
    v_mfma_f32_16x16x16_bf16 v[20:23], v[140:141], v[232:233], v[20:23]
    v_mfma_f32_16x16x16_bf16 v[20:23], v[142:143], v[240:241], v[20:23]
    v_mfma_f32_16x16x16_bf16 v[24:27], v[124:125], v[234:235], v[24:27]
    v_mfma_f32_16x16x16_bf16 v[24:27], v[126:127], v[242:243], v[24:27]
    v_mfma_f32_16x16x16_bf16 v[28:31], v[128:129], v[234:235], v[28:31]
    v_mfma_f32_16x16x16_bf16 v[28:31], v[130:131], v[242:243], v[28:31]
    v_mfma_f32_16x16x16_bf16 v[32:35], v[132:133], v[234:235], v[32:35]
    v_mfma_f32_16x16x16_bf16 v[32:35], v[134:135], v[242:243], v[32:35]
    buffer_load_dwordx4 v[112:115], v2, s[4:7], s0 offen offset:2048 sc1
    v_mfma_f32_16x16x16_bf16 v[36:39], v[136:137], v[234:235], v[36:39]
    v_mfma_f32_16x16x16_bf16 v[36:39], v[138:139], v[242:243], v[36:39]
    v_mfma_f32_16x16x16_bf16 v[40:43], v[140:141], v[234:235], v[40:43]
    v_mfma_f32_16x16x16_bf16 v[40:43], v[142:143], v[242:243], v[40:43]
    buffer_load_dwordx4 v[232:235], v2, s[12:15], s31 offen offset:0 sc1
    buffer_load_dwordx4 v[240:243], v2, s[12:15], s31 offen offset:2048 sc1
    v_mfma_f32_16x16x16_bf16 v[44:47], v[124:125], v[236:237], v[44:47]
    v_mfma_f32_16x16x16_bf16 v[44:47], v[126:127], v[244:245], v[44:47]
    v_mfma_f32_16x16x16_bf16 v[48:51], v[128:129], v[236:237], v[48:51]
    v_mfma_f32_16x16x16_bf16 v[48:51], v[130:131], v[244:245], v[48:51]
    v_mfma_f32_16x16x16_bf16 v[52:55], v[132:133], v[236:237], v[52:55]
    v_mfma_f32_16x16x16_bf16 v[52:55], v[134:135], v[244:245], v[52:55]
    buffer_load_dwordx4 v[116:119], v2, s[4:7], s0 offen offset:3072 sc1
    v_mfma_f32_16x16x16_bf16 v[56:59], v[136:137], v[236:237], v[56:59]
    v_mfma_f32_16x16x16_bf16 v[56:59], v[138:139], v[244:245], v[56:59]
    v_mfma_f32_16x16x16_bf16 v[60:63], v[140:141], v[236:237], v[60:63]
    v_mfma_f32_16x16x16_bf16 v[60:63], v[142:143], v[244:245], v[60:63]
    v_mfma_f32_16x16x16_bf16 v[64:67], v[124:125], v[238:239], v[64:67]
    v_mfma_f32_16x16x16_bf16 v[64:67], v[126:127], v[246:247], v[64:67]
    v_mfma_f32_16x16x16_bf16 v[68:71], v[128:129], v[238:239], v[68:71]
    v_mfma_f32_16x16x16_bf16 v[68:71], v[130:131], v[246:247], v[68:71]
    v_mfma_f32_16x16x16_bf16 v[72:75], v[132:133], v[238:239], v[72:75]
    v_mfma_f32_16x16x16_bf16 v[72:75], v[134:135], v[246:247], v[72:75]
    buffer_load_dwordx4 v[120:123], v255, s[4:7], s0 offen sc1
    v_mfma_f32_16x16x16_bf16 v[76:79], v[136:137], v[238:239], v[76:79]
    v_mfma_f32_16x16x16_bf16 v[76:79], v[138:139], v[246:247], v[76:79]
    v_mfma_f32_16x16x16_bf16 v[80:83], v[140:141], v[238:239], v[80:83]
    v_mfma_f32_16x16x16_bf16 v[80:83], v[142:143], v[246:247], v[80:83]
    buffer_load_dwordx4 v[236:239], v2, s[12:15], s31 offen offset:1024 sc1
    buffer_load_dwordx4 v[244:247], v2, s[12:15], s31 offen offset:3072 sc1
    s_waitcnt vmcnt(27)
    s_add_u32 s31, s71, 163840
    s_add_u32 s0, s70, 184320
    v_mfma_f32_16x16x32_bf16 v[4:7], v[144:147], v[184:187], v[4:7]
    buffer_load_dwordx4 v[124:127], v2, s[4:7], s0 offen offset:0 sc1
    v_mfma_f32_16x16x32_bf16 v[8:11], v[148:151], v[184:187], v[8:11]
    v_mfma_f32_16x16x32_bf16 v[12:15], v[152:155], v[184:187], v[12:15]
    buffer_load_dwordx4 v[128:131], v2, s[4:7], s0 offen offset:1024 sc1
    v_mfma_f32_16x16x32_bf16 v[16:19], v[156:159], v[184:187], v[16:19]
    v_mfma_f32_16x16x32_bf16 v[20:23], v[160:163], v[184:187], v[20:23]
    buffer_load_dwordx4 v[184:187], v2, s[12:15], s31 offen offset:0 sc1
    v_mfma_f32_16x16x32_bf16 v[24:27], v[144:147], v[188:191], v[24:27]
    v_mfma_f32_16x16x32_bf16 v[28:31], v[148:151], v[188:191], v[28:31]
    v_mfma_f32_16x16x32_bf16 v[32:35], v[152:155], v[188:191], v[32:35]
    buffer_load_dwordx4 v[132:135], v2, s[4:7], s0 offen offset:2048 sc1
    v_mfma_f32_16x16x32_bf16 v[36:39], v[156:159], v[188:191], v[36:39]
    v_mfma_f32_16x16x32_bf16 v[40:43], v[160:163], v[188:191], v[40:43]
    buffer_load_dwordx4 v[188:191], v2, s[12:15], s31 offen offset:1024 sc1
    v_mfma_f32_16x16x32_bf16 v[44:47], v[144:147], v[192:195], v[44:47]
    v_mfma_f32_16x16x32_bf16 v[48:51], v[148:151], v[192:195], v[48:51]
    v_mfma_f32_16x16x32_bf16 v[52:55], v[152:155], v[192:195], v[52:55]
    buffer_load_dwordx4 v[136:139], v2, s[4:7], s0 offen offset:3072 sc1
    v_mfma_f32_16x16x32_bf16 v[56:59], v[156:159], v[192:195], v[56:59]
    v_mfma_f32_16x16x32_bf16 v[60:63], v[160:163], v[192:195], v[60:63]
    buffer_load_dwordx4 v[192:195], v2, s[12:15], s31 offen offset:2048 sc1
    v_mfma_f32_16x16x32_bf16 v[64:67], v[144:147], v[196:199], v[64:67]
    v_mfma_f32_16x16x32_bf16 v[68:71], v[148:151], v[196:199], v[68:71]
    v_mfma_f32_16x16x32_bf16 v[72:75], v[152:155], v[196:199], v[72:75]
    buffer_load_dwordx4 v[140:143], v255, s[4:7], s0 offen sc1
    v_mfma_f32_16x16x32_bf16 v[76:79], v[156:159], v[196:199], v[76:79]
    v_mfma_f32_16x16x32_bf16 v[80:83], v[160:163], v[196:199], v[80:83]
    buffer_load_dwordx4 v[196:199], v2, s[12:15], s31 offen offset:3072 sc1
    v_mov_b32 v248, 163608
    ds_write_b32 v248, v248
    s_waitcnt vmcnt(27)
    s_add_u32 s31, s71, 180224
    s_add_u32 s0, s70, 202752
    v_mfma_f32_16x16x32_bf16 v[4:7], v[164:167], v[200:203], v[4:7]
    buffer_load_dwordx4 v[144:147], v2, s[4:7], s0 offen offset:0 sc1
    v_mfma_f32_16x16x32_bf16 v[8:11], v[168:171], v[200:203], v[8:11]
    v_mfma_f32_16x16x32_bf16 v[12:15], v[172:175], v[200:203], v[12:15]
    buffer_load_dwordx4 v[148:151], v2, s[4:7], s0 offen offset:1024 sc1
    v_mfma_f32_16x16x32_bf16 v[16:19], v[176:179], v[200:203], v[16:19]
    v_mfma_f32_16x16x32_bf16 v[20:23], v[180:183], v[200:203], v[20:23]
    buffer_load_dwordx4 v[200:203], v2, s[12:15], s31 offen offset:0 sc1
    v_mfma_f32_16x16x32_bf16 v[24:27], v[164:167], v[204:207], v[24:27]
    v_mfma_f32_16x16x32_bf16 v[28:31], v[168:171], v[204:207], v[28:31]
    v_mfma_f32_16x16x32_bf16 v[32:35], v[172:175], v[204:207], v[32:35]
    buffer_load_dwordx4 v[152:155], v2, s[4:7], s0 offen offset:2048 sc1
    v_mfma_f32_16x16x32_bf16 v[36:39], v[176:179], v[204:207], v[36:39]
    v_mfma_f32_16x16x32_bf16 v[40:43], v[180:183], v[204:207], v[40:43]
    buffer_load_dwordx4 v[204:207], v2, s[12:15], s31 offen offset:1024 sc1
    v_mfma_f32_16x16x32_bf16 v[44:47], v[164:167], v[208:211], v[44:47]
    v_mfma_f32_16x16x32_bf16 v[48:51], v[168:171], v[208:211], v[48:51]
    v_mfma_f32_16x16x32_bf16 v[52:55], v[172:175], v[208:211], v[52:55]
    buffer_load_dwordx4 v[156:159], v2, s[4:7], s0 offen offset:3072 sc1
    v_mfma_f32_16x16x32_bf16 v[56:59], v[176:179], v[208:211], v[56:59]
    v_mfma_f32_16x16x32_bf16 v[60:63], v[180:183], v[208:211], v[60:63]
    buffer_load_dwordx4 v[208:211], v2, s[12:15], s31 offen offset:2048 sc1
    v_mfma_f32_16x16x32_bf16 v[64:67], v[164:167], v[212:215], v[64:67]
    v_mfma_f32_16x16x32_bf16 v[68:71], v[168:171], v[212:215], v[68:71]
    v_mfma_f32_16x16x32_bf16 v[72:75], v[172:175], v[212:215], v[72:75]
    buffer_load_dwordx4 v[160:163], v255, s[4:7], s0 offen sc1
    v_mfma_f32_16x16x32_bf16 v[76:79], v[176:179], v[212:215], v[76:79]
    v_mfma_f32_16x16x32_bf16 v[80:83], v[180:183], v[212:215], v[80:83]
    buffer_load_dwordx4 v[212:215], v2, s[12:15], s31 offen offset:3072 sc1
    s_waitcnt vmcnt(27)
    s_add_u32 s31, s71, 196608
    s_add_u32 s0, s70, 221184
    v_mfma_f32_16x16x32_bf16 v[4:7], v[84:87], v[216:219], v[4:7]
    ds_read_b128 v[164:167], v1 offset:0
    v_mfma_f32_16x16x32_bf16 v[8:11], v[88:91], v[216:219], v[8:11]
    v_mfma_f32_16x16x32_bf16 v[12:15], v[92:95], v[216:219], v[12:15]
    ds_read_b128 v[168:171], v1 offset:1024
    v_mfma_f32_16x16x32_bf16 v[16:19], v[96:99], v[216:219], v[16:19]
    v_mfma_f32_16x16x32_bf16 v[20:23], v[100:103], v[216:219], v[20:23]
    buffer_load_dwordx4 v[216:219], v2, s[12:15], s31 offen offset:0 sc1
    v_mfma_f32_16x16x32_bf16 v[24:27], v[84:87], v[220:223], v[24:27]
    v_mfma_f32_16x16x32_bf16 v[28:31], v[88:91], v[220:223], v[28:31]
    v_mfma_f32_16x16x32_bf16 v[32:35], v[92:95], v[220:223], v[32:35]
    ds_read_b128 v[172:175], v1 offset:2048
    v_mfma_f32_16x16x32_bf16 v[36:39], v[96:99], v[220:223], v[36:39]
    v_mfma_f32_16x16x32_bf16 v[40:43], v[100:103], v[220:223], v[40:43]
    buffer_load_dwordx4 v[220:223], v2, s[12:15], s31 offen offset:1024 sc1
    v_mfma_f32_16x16x32_bf16 v[44:47], v[84:87], v[224:227], v[44:47]
    v_mfma_f32_16x16x32_bf16 v[48:51], v[88:91], v[224:227], v[48:51]
    v_mfma_f32_16x16x32_bf16 v[52:55], v[92:95], v[224:227], v[52:55]
    ds_read_b128 v[176:179], v1 offset:3072
    v_mfma_f32_16x16x32_bf16 v[56:59], v[96:99], v[224:227], v[56:59]
    v_mfma_f32_16x16x32_bf16 v[60:63], v[100:103], v[224:227], v[60:63]
    buffer_load_dwordx4 v[224:227], v2, s[12:15], s31 offen offset:2048 sc1
    v_mfma_f32_16x16x32_bf16 v[64:67], v[84:87], v[228:231], v[64:67]
    v_mfma_f32_16x16x32_bf16 v[68:71], v[88:91], v[228:231], v[68:71]
    v_mfma_f32_16x16x32_bf16 v[72:75], v[92:95], v[228:231], v[72:75]
    ds_read_b128 v[180:183], v3 offset:0
    v_mfma_f32_16x16x32_bf16 v[76:79], v[96:99], v[228:231], v[76:79]
    v_mfma_f32_16x16x32_bf16 v[80:83], v[100:103], v[228:231], v[80:83]
    buffer_load_dwordx4 v[228:231], v2, s[12:15], s31 offen offset:3072 sc1
    s_waitcnt vmcnt(22)
    s_add_u32 s31, s71, 212992
    s_add_u32 s0, s70, 239616
    v_mfma_f32_16x16x32_bf16 v[4:7], v[104:107], v[232:235], v[4:7]
    ds_read_b128 v[84:87], v1 offset:4608
    v_mfma_f32_16x16x32_bf16 v[8:11], v[108:111], v[232:235], v[8:11]
    v_mfma_f32_16x16x32_bf16 v[12:15], v[112:115], v[232:235], v[12:15]
    ds_read_b128 v[88:91], v1 offset:5632
    v_mfma_f32_16x16x32_bf16 v[16:19], v[116:119], v[232:235], v[16:19]
    v_mfma_f32_16x16x32_bf16 v[20:23], v[120:123], v[232:235], v[20:23]
    buffer_load_dwordx4 v[232:235], v2, s[12:15], s31 offen offset:0 sc1
    v_mfma_f32_16x16x32_bf16 v[24:27], v[104:107], v[236:239], v[24:27]
    v_mfma_f32_16x16x32_bf16 v[28:31], v[108:111], v[236:239], v[28:31]
    v_mfma_f32_16x16x32_bf16 v[32:35], v[112:115], v[236:239], v[32:35]
    ds_read_b128 v[92:95], v1 offset:6656
    v_mfma_f32_16x16x32_bf16 v[36:39], v[116:119], v[236:239], v[36:39]
    v_mfma_f32_16x16x32_bf16 v[40:43], v[120:123], v[236:239], v[40:43]
    buffer_load_dwordx4 v[236:239], v2, s[12:15], s31 offen offset:1024 sc1
    v_mfma_f32_16x16x32_bf16 v[44:47], v[104:107], v[240:243], v[44:47]
    v_mfma_f32_16x16x32_bf16 v[48:51], v[108:111], v[240:243], v[48:51]
    v_mfma_f32_16x16x32_bf16 v[52:55], v[112:115], v[240:243], v[52:55]
    ds_read_b128 v[96:99], v1 offset:7680
    v_mfma_f32_16x16x32_bf16 v[56:59], v[116:119], v[240:243], v[56:59]
    v_mfma_f32_16x16x32_bf16 v[60:63], v[120:123], v[240:243], v[60:63]
    buffer_load_dwordx4 v[240:243], v2, s[12:15], s31 offen offset:2048 sc1
    v_mfma_f32_16x16x32_bf16 v[64:67], v[104:107], v[244:247], v[64:67]
    v_mfma_f32_16x16x32_bf16 v[68:71], v[108:111], v[244:247], v[68:71]
    v_mfma_f32_16x16x32_bf16 v[72:75], v[112:115], v[244:247], v[72:75]
    ds_read_b128 v[100:103], v3 offset:4608
    v_mfma_f32_16x16x32_bf16 v[76:79], v[116:119], v[244:247], v[76:79]
    v_mfma_f32_16x16x32_bf16 v[80:83], v[120:123], v[244:247], v[80:83]
    buffer_load_dwordx4 v[244:247], v2, s[12:15], s31 offen offset:3072 sc1
    s_waitcnt vmcnt(17)
    s_add_u32 s31, s71, 229376
    s_add_u32 s0, s70, 258048
    v_mfma_f32_16x16x32_bf16 v[4:7], v[124:127], v[184:187], v[4:7]
    ds_read_b128 v[104:107], v1 offset:9216
    v_mfma_f32_16x16x32_bf16 v[8:11], v[128:131], v[184:187], v[8:11]
    v_mfma_f32_16x16x32_bf16 v[12:15], v[132:135], v[184:187], v[12:15]
    ds_read_b128 v[108:111], v1 offset:10240
    v_mfma_f32_16x16x32_bf16 v[16:19], v[136:139], v[184:187], v[16:19]
    v_mfma_f32_16x16x32_bf16 v[20:23], v[140:143], v[184:187], v[20:23]
    buffer_load_dwordx4 v[184:187], v2, s[12:15], s31 offen offset:0 sc1
    v_mfma_f32_16x16x32_bf16 v[24:27], v[124:127], v[188:191], v[24:27]
    v_mfma_f32_16x16x32_bf16 v[28:31], v[128:131], v[188:191], v[28:31]
    v_mfma_f32_16x16x32_bf16 v[32:35], v[132:135], v[188:191], v[32:35]
    ds_read_b128 v[112:115], v1 offset:11264
    v_mfma_f32_16x16x32_bf16 v[36:39], v[136:139], v[188:191], v[36:39]
    v_mfma_f32_16x16x32_bf16 v[40:43], v[140:143], v[188:191], v[40:43]
    buffer_load_dwordx4 v[188:191], v2, s[12:15], s31 offen offset:1024 sc1
    v_mfma_f32_16x16x32_bf16 v[44:47], v[124:127], v[192:195], v[44:47]
    v_mfma_f32_16x16x32_bf16 v[48:51], v[128:131], v[192:195], v[48:51]
    v_mfma_f32_16x16x32_bf16 v[52:55], v[132:135], v[192:195], v[52:55]
    ds_read_b128 v[116:119], v1 offset:12288
    v_mfma_f32_16x16x32_bf16 v[56:59], v[136:139], v[192:195], v[56:59]
    v_mfma_f32_16x16x32_bf16 v[60:63], v[140:143], v[192:195], v[60:63]
    buffer_load_dwordx4 v[192:195], v2, s[12:15], s31 offen offset:2048 sc1
    v_mfma_f32_16x16x32_bf16 v[64:67], v[124:127], v[196:199], v[64:67]
    v_mfma_f32_16x16x32_bf16 v[68:71], v[128:131], v[196:199], v[68:71]
    v_mfma_f32_16x16x32_bf16 v[72:75], v[132:135], v[196:199], v[72:75]
    ds_read_b128 v[120:123], v3 offset:9216
    v_mfma_f32_16x16x32_bf16 v[76:79], v[136:139], v[196:199], v[76:79]
    v_mfma_f32_16x16x32_bf16 v[80:83], v[140:143], v[196:199], v[80:83]
    buffer_load_dwordx4 v[196:199], v2, s[12:15], s31 offen offset:3072 sc1
    s_waitcnt vmcnt(12)
    s_add_u32 s31, s71, 245760
    s_add_u32 s0, s70, 276480
    v_mfma_f32_16x16x32_bf16 v[4:7], v[144:147], v[200:203], v[4:7]
    ds_read_b128 v[124:127], v1 offset:13824
    v_mfma_f32_16x16x32_bf16 v[8:11], v[148:151], v[200:203], v[8:11]
    v_mfma_f32_16x16x32_bf16 v[12:15], v[152:155], v[200:203], v[12:15]
    ds_read_b128 v[128:131], v1 offset:14848
    v_mfma_f32_16x16x32_bf16 v[16:19], v[156:159], v[200:203], v[16:19]
    v_mfma_f32_16x16x32_bf16 v[20:23], v[160:163], v[200:203], v[20:23]
    buffer_load_dwordx4 v[200:203], v2, s[12:15], s31 offen offset:0 sc1
    v_mfma_f32_16x16x32_bf16 v[24:27], v[144:147], v[204:207], v[24:27]
    v_mfma_f32_16x16x32_bf16 v[28:31], v[148:151], v[204:207], v[28:31]
    v_mfma_f32_16x16x32_bf16 v[32:35], v[152:155], v[204:207], v[32:35]
    ds_read_b128 v[132:135], v1 offset:15872
    v_mfma_f32_16x16x32_bf16 v[36:39], v[156:159], v[204:207], v[36:39]
    v_mfma_f32_16x16x32_bf16 v[40:43], v[160:163], v[204:207], v[40:43]
    buffer_load_dwordx4 v[204:207], v2, s[12:15], s31 offen offset:1024 sc1
    v_mfma_f32_16x16x32_bf16 v[44:47], v[144:147], v[208:211], v[44:47]
    v_mfma_f32_16x16x32_bf16 v[48:51], v[148:151], v[208:211], v[48:51]
    v_mfma_f32_16x16x32_bf16 v[52:55], v[152:155], v[208:211], v[52:55]
    ds_read_b128 v[136:139], v1 offset:16896
    v_mfma_f32_16x16x32_bf16 v[56:59], v[156:159], v[208:211], v[56:59]
    v_mfma_f32_16x16x32_bf16 v[60:63], v[160:163], v[208:211], v[60:63]
    buffer_load_dwordx4 v[208:211], v2, s[12:15], s31 offen offset:2048 sc1
    v_mfma_f32_16x16x32_bf16 v[64:67], v[144:147], v[212:215], v[64:67]
    v_mfma_f32_16x16x32_bf16 v[68:71], v[148:151], v[212:215], v[68:71]
    v_mfma_f32_16x16x32_bf16 v[72:75], v[152:155], v[212:215], v[72:75]
    ds_read_b128 v[140:143], v3 offset:13824
    v_mfma_f32_16x16x32_bf16 v[76:79], v[156:159], v[212:215], v[76:79]
    v_mfma_f32_16x16x32_bf16 v[80:83], v[160:163], v[212:215], v[80:83]
    buffer_load_dwordx4 v[212:215], v2, s[12:15], s31 offen offset:3072 sc1
    s_waitcnt vmcnt(12) lgkmcnt(0)
    v_mfma_f32_16x16x32_bf16 v[4:7], v[164:167], v[216:219], v[4:7]
    v_mfma_f32_16x16x32_bf16 v[8:11], v[168:171], v[216:219], v[8:11]
    v_mfma_f32_16x16x32_bf16 v[12:15], v[172:175], v[216:219], v[12:15]
    v_mfma_f32_16x16x32_bf16 v[16:19], v[176:179], v[216:219], v[16:19]
    v_mfma_f32_16x16x32_bf16 v[20:23], v[180:183], v[216:219], v[20:23]
    v_mfma_f32_16x16x32_bf16 v[24:27], v[164:167], v[220:223], v[24:27]
    v_mfma_f32_16x16x32_bf16 v[28:31], v[168:171], v[220:223], v[28:31]
    v_mfma_f32_16x16x32_bf16 v[32:35], v[172:175], v[220:223], v[32:35]
    v_mfma_f32_16x16x32_bf16 v[36:39], v[176:179], v[220:223], v[36:39]
    v_mfma_f32_16x16x32_bf16 v[40:43], v[180:183], v[220:223], v[40:43]
    v_mfma_f32_16x16x32_bf16 v[44:47], v[164:167], v[224:227], v[44:47]
    v_mfma_f32_16x16x32_bf16 v[48:51], v[168:171], v[224:227], v[48:51]
    v_mfma_f32_16x16x32_bf16 v[52:55], v[172:175], v[224:227], v[52:55]
    v_mfma_f32_16x16x32_bf16 v[56:59], v[176:179], v[224:227], v[56:59]
    v_mfma_f32_16x16x32_bf16 v[60:63], v[180:183], v[224:227], v[60:63]
    v_mfma_f32_16x16x32_bf16 v[64:67], v[164:167], v[228:231], v[64:67]
    v_mfma_f32_16x16x32_bf16 v[68:71], v[168:171], v[228:231], v[68:71]
    v_mfma_f32_16x16x32_bf16 v[72:75], v[172:175], v[228:231], v[72:75]
    v_mfma_f32_16x16x32_bf16 v[76:79], v[176:179], v[228:231], v[76:79]
    v_mfma_f32_16x16x32_bf16 v[80:83], v[180:183], v[228:231], v[80:83]
    s_waitcnt vmcnt(8) lgkmcnt(0)
    v_mfma_f32_16x16x32_bf16 v[4:7], v[84:87], v[232:235], v[4:7]
    v_mfma_f32_16x16x32_bf16 v[8:11], v[88:91], v[232:235], v[8:11]
    v_mfma_f32_16x16x32_bf16 v[12:15], v[92:95], v[232:235], v[12:15]
    v_mfma_f32_16x16x32_bf16 v[16:19], v[96:99], v[232:235], v[16:19]
    v_mfma_f32_16x16x32_bf16 v[20:23], v[100:103], v[232:235], v[20:23]
    v_mfma_f32_16x16x32_bf16 v[24:27], v[84:87], v[236:239], v[24:27]
    v_mfma_f32_16x16x32_bf16 v[28:31], v[88:91], v[236:239], v[28:31]
    v_mfma_f32_16x16x32_bf16 v[32:35], v[92:95], v[236:239], v[32:35]
    v_mfma_f32_16x16x32_bf16 v[36:39], v[96:99], v[236:239], v[36:39]
    v_mfma_f32_16x16x32_bf16 v[40:43], v[100:103], v[236:239], v[40:43]
    v_mfma_f32_16x16x32_bf16 v[44:47], v[84:87], v[240:243], v[44:47]
    v_mfma_f32_16x16x32_bf16 v[48:51], v[88:91], v[240:243], v[48:51]
    v_mfma_f32_16x16x32_bf16 v[52:55], v[92:95], v[240:243], v[52:55]
    v_mfma_f32_16x16x32_bf16 v[56:59], v[96:99], v[240:243], v[56:59]
    v_mfma_f32_16x16x32_bf16 v[60:63], v[100:103], v[240:243], v[60:63]
    v_mfma_f32_16x16x32_bf16 v[64:67], v[84:87], v[244:247], v[64:67]
    v_mfma_f32_16x16x32_bf16 v[68:71], v[88:91], v[244:247], v[68:71]
    v_mfma_f32_16x16x32_bf16 v[72:75], v[92:95], v[244:247], v[72:75]
    v_mfma_f32_16x16x32_bf16 v[76:79], v[96:99], v[244:247], v[76:79]
    v_mfma_f32_16x16x32_bf16 v[80:83], v[100:103], v[244:247], v[80:83]
    s_waitcnt vmcnt(4) lgkmcnt(0)
    v_mfma_f32_16x16x32_bf16 v[4:7], v[104:107], v[184:187], v[4:7]
    v_mfma_f32_16x16x32_bf16 v[8:11], v[108:111], v[184:187], v[8:11]
    v_mfma_f32_16x16x32_bf16 v[12:15], v[112:115], v[184:187], v[12:15]
    v_mfma_f32_16x16x32_bf16 v[16:19], v[116:119], v[184:187], v[16:19]
    v_mfma_f32_16x16x32_bf16 v[20:23], v[120:123], v[184:187], v[20:23]
    v_mfma_f32_16x16x32_bf16 v[24:27], v[104:107], v[188:191], v[24:27]
    v_mfma_f32_16x16x32_bf16 v[28:31], v[108:111], v[188:191], v[28:31]
    v_mfma_f32_16x16x32_bf16 v[32:35], v[112:115], v[188:191], v[32:35]
    v_mfma_f32_16x16x32_bf16 v[36:39], v[116:119], v[188:191], v[36:39]
    v_mfma_f32_16x16x32_bf16 v[40:43], v[120:123], v[188:191], v[40:43]
    v_mfma_f32_16x16x32_bf16 v[44:47], v[104:107], v[192:195], v[44:47]
    v_mfma_f32_16x16x32_bf16 v[48:51], v[108:111], v[192:195], v[48:51]
    v_mfma_f32_16x16x32_bf16 v[52:55], v[112:115], v[192:195], v[52:55]
    v_mfma_f32_16x16x32_bf16 v[56:59], v[116:119], v[192:195], v[56:59]
    v_mfma_f32_16x16x32_bf16 v[60:63], v[120:123], v[192:195], v[60:63]
    v_mfma_f32_16x16x32_bf16 v[64:67], v[104:107], v[196:199], v[64:67]
    v_mfma_f32_16x16x32_bf16 v[68:71], v[108:111], v[196:199], v[68:71]
    v_mfma_f32_16x16x32_bf16 v[72:75], v[112:115], v[196:199], v[72:75]
    v_mfma_f32_16x16x32_bf16 v[76:79], v[116:119], v[196:199], v[76:79]
    v_mfma_f32_16x16x32_bf16 v[80:83], v[120:123], v[196:199], v[80:83]
    s_waitcnt vmcnt(0) lgkmcnt(0)
    v_mfma_f32_16x16x32_bf16 v[4:7], v[124:127], v[200:203], v[4:7]
    v_mfma_f32_16x16x32_bf16 v[8:11], v[128:131], v[200:203], v[8:11]
    v_mfma_f32_16x16x32_bf16 v[12:15], v[132:135], v[200:203], v[12:15]
    v_mfma_f32_16x16x32_bf16 v[16:19], v[136:139], v[200:203], v[16:19]
    v_mfma_f32_16x16x32_bf16 v[20:23], v[140:143], v[200:203], v[20:23]
    v_mfma_f32_16x16x32_bf16 v[24:27], v[124:127], v[204:207], v[24:27]
    v_mfma_f32_16x16x32_bf16 v[28:31], v[128:131], v[204:207], v[28:31]
    v_mfma_f32_16x16x32_bf16 v[32:35], v[132:135], v[204:207], v[32:35]
    v_mfma_f32_16x16x32_bf16 v[36:39], v[136:139], v[204:207], v[36:39]
    ds_write_b128 v1, v[4:7] offset:0
    v_mfma_f32_16x16x32_bf16 v[40:43], v[140:143], v[204:207], v[40:43]
    ds_write_b128 v1, v[8:11] offset:1024
    v_mfma_f32_16x16x32_bf16 v[44:47], v[124:127], v[208:211], v[44:47]
    ds_write_b128 v1, v[12:15] offset:2048
    v_mfma_f32_16x16x32_bf16 v[48:51], v[128:131], v[208:211], v[48:51]
    ds_write_b128 v1, v[16:19] offset:3072
    v_mfma_f32_16x16x32_bf16 v[52:55], v[132:135], v[208:211], v[52:55]
    ds_write_b128 v1, v[20:23] offset:4096
    v_mfma_f32_16x16x32_bf16 v[56:59], v[136:139], v[208:211], v[56:59]
    ds_write_b128 v1, v[24:27] offset:5120
    v_mfma_f32_16x16x32_bf16 v[60:63], v[140:143], v[208:211], v[60:63]
    ds_write_b128 v1, v[28:31] offset:6144
    v_mfma_f32_16x16x32_bf16 v[64:67], v[124:127], v[212:215], v[64:67]
    ds_write_b128 v1, v[32:35] offset:7168
    v_mfma_f32_16x16x32_bf16 v[68:71], v[128:131], v[212:215], v[68:71]
    ds_write_b128 v1, v[36:39] offset:8192
    v_mfma_f32_16x16x32_bf16 v[72:75], v[132:135], v[212:215], v[72:75]
    ds_write_b128 v1, v[40:43] offset:9216
    v_mfma_f32_16x16x32_bf16 v[76:79], v[136:139], v[212:215], v[76:79]
    ds_write_b128 v1, v[44:47] offset:10240
    v_mfma_f32_16x16x32_bf16 v[80:83], v[140:143], v[212:215], v[80:83]
    ds_write_b128 v1, v[48:51] offset:11264
    ds_write_b128 v1, v[52:55] offset:12288
    ds_write_b128 v1, v[56:59] offset:13312
    ds_write_b128 v1, v[60:63] offset:14336
    ds_write_b128 v1, v[64:67] offset:15360
    ds_write_b128 v1, v[68:71] offset:16384
    s_nop 5
    ds_write_b128 v1, v[72:75] offset:17408
    ds_write_b128 v1, v[76:79] offset:18432
    ds_write_b128 v1, v[80:83] offset:19456
    s_waitcnt lgkmcnt(0)
    s_barrier
    s_endpgm
gated_mix__ssm_conv_s4d__mixer_gmlp__prompt_kernel_Lutf:
    v_xor_b32 v205, 0, v203
    ds_read_b64_tr_b16 v[160:161], v205 offset:0
    ds_read_b64_tr_b16 v[162:163], v205 offset:2048
    v_xor_b32 v205, 16, v203
    ds_read_b64_tr_b16 v[164:165], v205 offset:0
    ds_read_b64_tr_b16 v[166:167], v205 offset:2048
    v_xor_b32 v205, 32, v203
    ds_read_b64_tr_b16 v[168:169], v205 offset:0
    ds_read_b64_tr_b16 v[170:171], v205 offset:2048
    v_xor_b32 v205, 48, v203
    ds_read_b64_tr_b16 v[172:173], v205 offset:0
    ds_read_b64_tr_b16 v[174:175], v205 offset:2048
    s_waitcnt lgkmcnt(0)
    s_setpc_b64 s[70:71]
gated_mix__ssm_conv_s4d__mixer_gmlp__prompt_kernel_C:
    s_setprio 2
    s_add_u32 s20, s62, 35127296
    s_addc_u32 s21, s63, 0
    s_mov_b32 s22, 262144
    s_mov_b32 s23, 0x20000
    s_mul_i32 s1, s25, 4800
    s_add_u32 s1, s1, 140288
    s_add_u32 s0, s1, 640
    s_waitcnt vmcnt(0)
    s_cmp_lg_u32 s25, 0
    s_cbranch_scc1 gated_mix__ssm_conv_s4d__mixer_gmlp__prompt_kernel_Cnia
    v_lshrrev_b32 v186, 4, v0
    v_and_b32 v187, 15, v0
    v_lshlrev_b32 v187, 4, v187
    v_lshl_add_u32 v187, v186, 16, v187
    v_mov_b32 v188, s75
    v_mov_b32 v189, s3
    v_cmp_eq_u32 vcc, 0, v186
    s_nop 1
    v_cndmask_b32 v188, v188, v189, vcc
    v_lshl_add_u32 v187, v188, 8, v187
    v_mov_b32 v188, 0
    v_mov_b32 v189, 0
    v_mov_b32 v190, 0
    v_mov_b32 v191, 0
    buffer_store_dwordx4 v[188:191], v187, s[20:23], 0 offen sc1
    v_mov_b32 v186, 163584
    ds_write_b128 v186, v[188:191]
    ds_write_b128 v186, v[188:191] offset:16
    s_lshl_b32 s64, s3, 10
    s_add_u32 s64, s64, 34603008
    s_add_u32 s4, s62, s64
    s_addc_u32 s5, s63, 0
    s_mov_b32 s6, 1024
    s_mov_b32 s7, 0x20000
    v_mov_b32 v192, -1
    v_mov_b32 v193, -1
    v_mov_b32 v194, -1
    v_mov_b32 v195, -1
    v_lshlrev_b32 v185, 4, v0
    buffer_store_dwordx4 v[192:195], v185, s[4:7], 0 offen sc1
gated_mix__ssm_conv_s4d__mixer_gmlp__prompt_kernel_Cnia:
    s_cmp_ge_u32 s26, 9
    s_cbranch_scc1 gated_mix__ssm_conv_s4d__mixer_gmlp__prompt_kernel_Cnp
    s_mul_i32 s1, s25, 8448
    s_add_u32 s1, s1, 104448
    v_lshlrev_b32 v20, 16, v8
    v_lshlrev_b32 v12, 16, v4
    v_and_b32 v13, 0xffff0000, v4
    v_lshlrev_b32 v14, 16, v5
    v_and_b32 v15, 0xffff0000, v5
    v_lshlrev_b32 v16, 16, v6
    v_and_b32 v18, 0xffff0000, v6
    v_lshlrev_b32 v17, 16, v7
    v_and_b32 v19, 0xffff0000, v7
    v_mov_b32 v23, 0x3fb8aa3b
    v_mov_b32 v24, 0x32a57060
    v_max_f32 v25, abs(v16), abs(v17)
    v_mul_f32 v48, v20, v23
    v_mul_f32 v51, v12, v23
    v_mul_f32 v54, v13, v23
    v_max3_f32 v25, v25, abs(v18), abs(v19)
    v_fma_f32 v49, v20, v23, -v48
    v_fma_f32 v52, v12, v23, -v51
    v_fma_f32 v55, v13, v23, -v54
    v_max_f32_dpp v25, v25, v25 row_ror:8 row_mask:0xf bank_mask:0xf
    v_fmac_f32 v49, v20, v24
    v_fmac_f32 v52, v12, v24
    v_fmac_f32 v55, v13, v24
    v_max_f32_dpp v25, v25, v25 row_ror:4 row_mask:0xf bank_mask:0xf
    v_rndne_f32 v50, v48
    v_rndne_f32 v53, v51
    v_rndne_f32 v56, v54
    v_max_f32_dpp v25, v25, v25 row_ror:2 row_mask:0xf bank_mask:0xf
    v_sub_f32 v48, v48, v50
    v_sub_f32 v51, v51, v53
    v_sub_f32 v54, v54, v56
    v_max_f32_dpp v25, v25, v25 row_ror:1 row_mask:0xf bank_mask:0xf
    v_add_f32 v48, v48, v49
    v_add_f32 v51, v51, v52
    v_add_f32 v54, v54, v55
    v_mov_b32 v26, v25
    v_exp_f32 v48, v48
    v_exp_f32 v51, v51
    v_exp_f32 v54, v54
    v_permlane16_swap_b32 v25, v26
    v_cvt_i32_f32 v50, v50
    v_cvt_i32_f32 v53, v53
    v_cvt_i32_f32 v56, v56
    v_max_f32 v25, v25, v26
    v_ldexp_f32 v20, v48, v50
    v_ldexp_f32 v12, v51, v53
    v_ldexp_f32 v13, v54, v56
    v_mov_b32 v26, v25
    v_cvt_pk_bf16_f32 v20, v20, v20
    v_cvt_pk_bf16_f32 v12, v12, v12
    v_cvt_pk_bf16_f32 v13, v13, v13
    v_permlane32_swap_b32 v25, v26
    v_and_b32 v20, 0xffff0000, v20
    v_and_b32 v12, 0xffff0000, v12
    v_and_b32 v13, 0xffff0000, v13
    v_max_f32 v25, v25, v26
    v_mul_f32 v12, v12, v20
    v_mul_f32 v14, v14, v20
    v_mul_f32 v12, 0xbfb8aa3b, v12
    v_mul_f32 v13, v13, v20
    v_mul_f32 v15, v15, v20
    v_mul_f32 v13, 0xbfb8aa3b, v13
    v_and_b32 v25, 0x7f800000, v25
    v_max_u32 v25, 0x00800000, v25
    v_min_u32 v25, 0x7e800000, v25
    v_sub_u32 v26, 0x7f000000, v25
    v_mul_f32 v16, v16, v26
    v_mul_f32 v17, v17, v26
    v_mul_f32 v18, v18, v26
    v_mul_f32 v19, v19, v26
    v_mul_f32 v22, v25, v20
    v_add_f32 v22, v22, v22
    v_mov_b32 v23, 0x3e22f983
    v_mov_b32 v24, 0x31dc9c88
    v_mul_f32 v48, 0x3f800000, v12
    v_mul_f32 v52, 0x3f800000, v13
    v_mul_f32 v49, 0x3f800000, v14
    v_mul_f32 v53, 0x3f800000, v15
    v_exp_f32 v48, v48
    v_exp_f32 v52, v52
    v_mul_f32 v50, v49, v23
    v_mul_f32 v54, v53, v23
    v_fma_f32 v51, v49, v23, -v50
    v_fma_f32 v55, v53, v23, -v54
    v_fmac_f32 v51, v49, v24
    v_fmac_f32 v55, v53, v24
    v_fract_f32 v50, v50
    v_fract_f32 v54, v54
    v_add_f32 v50, v50, v51
    v_add_f32 v54, v54, v55
    v_cos_f32 v49, v50
    v_cos_f32 v53, v54
    v_sin_f32 v51, v50
    v_sin_f32 v55, v54
    v_mul_f32 v28, v48, v49
    v_mul_f32 v30, v52, v53
    v_mul_f32 v29, v48, v51
    v_mul_f32 v31, v52, v55
    v_mul_f32 v48, 0x41000000, v12
    v_mul_f32 v52, 0x41000000, v13
    v_mul_f32 v49, 0xc1000000, v14
    v_mul_f32 v53, 0xc1000000, v15
    v_exp_f32 v48, v48
    v_exp_f32 v52, v52
    v_mul_f32 v50, v49, v23
    v_mul_f32 v54, v53, v23
    v_fma_f32 v51, v49, v23, -v50
    v_fma_f32 v55, v53, v23, -v54
    v_fmac_f32 v51, v49, v24
    v_fmac_f32 v55, v53, v24
    v_fract_f32 v50, v50
    v_fract_f32 v54, v54
    v_add_f32 v50, v50, v51
    v_add_f32 v54, v54, v55
    v_cos_f32 v49, v50
    v_cos_f32 v53, v54
    v_sin_f32 v51, v50
    v_sin_f32 v55, v54
    v_mul_f32 v32, v48, v49
    v_mul_f32 v34, v52, v53
    v_mul_f32 v33, v48, v51
    v_mul_f32 v35, v52, v55
    v_mul_f32 v48, 0x43000000, v12
    v_mul_f32 v52, 0x43000000, v13
    v_mul_f32 v49, 0x43000000, v14
    v_mul_f32 v53, 0x43000000, v15
    v_exp_f32 v48, v48
    v_exp_f32 v52, v52
    v_mul_f32 v50, v49, v23
    v_mul_f32 v54, v53, v23
    v_fma_f32 v51, v49, v23, -v50
    v_fma_f32 v55, v53, v23, -v54
    v_fmac_f32 v51, v49, v24
    v_fmac_f32 v55, v53, v24
    v_fract_f32 v50, v50
    v_fract_f32 v54, v54
    v_add_f32 v50, v50, v51
    v_add_f32 v54, v54, v55
    v_cos_f32 v49, v50
    v_cos_f32 v53, v54
    v_sin_f32 v51, v50
    v_sin_f32 v55, v54
    v_mul_f32 v36, v48, v49
    v_mul_f32 v38, v52, v53
    v_mul_f32 v37, v48, v51
    v_mul_f32 v39, v52, v55
    v_lshlrev_b32 v2, 3, v0
    v_add_u32 v2, s1, v2
    v_and_b32 v4, 15, v0
    v_lshrrev_b32 v5, 4, v0
    v_and_b32 v3, 15, v0
    v_mul_u32_u24 v3, 528, v3
    v_lshl_add_u32 v3, v5, 4, v3
    v_add_u32 v3, s1, v3
    v_mov_b32 v160, 0
    v_mov_b32 v161, 0
    v_mov_b32 v162, 0
    v_mov_b32 v163, 0
    v_mov_b32 v164, 0
    v_mov_b32 v165, 0
    v_mov_b32 v166, 0
    v_mov_b32 v167, 0
    v_mov_b32 v168, 0
    v_mov_b32 v169, 0
    v_mov_b32 v170, 0
    v_mov_b32 v171, 0
    v_mov_b32 v48, 1.0
    v_mov_b32 v49, 0
    v_mov_b32 v50, 1.0
    v_mov_b32 v51, 0
    v_cvt_pk_f16_f32 v56, v48, v49
    v_cvt_pk_f16_f32 v57, v50, v51
    v_pk_mul_f32 v[52:53], v[48:49], v[32:33] op_sel:[0,0] op_sel_hi:[0,1]
    v_pk_mul_f32 v[54:55], v[50:51], v[34:35] op_sel:[0,0] op_sel_hi:[0,1]
    v_pk_fma_f32 v[48:49], v[48:49], v[32:33], v[52:53] op_sel:[1,1,0] op_sel_hi:[1,0,1] neg_lo:[0,1,0]
    v_pk_fma_f32 v[50:51], v[50:51], v[34:35], v[54:55] op_sel:[1,1,0] op_sel_hi:[1,0,1] neg_lo:[0,1,0]
    ds_write_b64 v2, v[56:57] offset:0
    v_cvt_pk_f16_f32 v58, v48, v49
    v_cvt_pk_f16_f32 v59, v50, v51
    v_pk_mul_f32 v[52:53], v[48:49], v[32:33] op_sel:[0,0] op_sel_hi:[0,1]
    v_pk_mul_f32 v[54:55], v[50:51], v[34:35] op_sel:[0,0] op_sel_hi:[0,1]
    v_pk_fma_f32 v[48:49], v[48:49], v[32:33], v[52:53] op_sel:[1,1,0] op_sel_hi:[1,0,1] neg_lo:[0,1,0]
    v_pk_fma_f32 v[50:51], v[50:51], v[34:35], v[54:55] op_sel:[1,1,0] op_sel_hi:[1,0,1] neg_lo:[0,1,0]
    ds_write_b64 v2, v[58:59] offset:528
    v_cvt_pk_f16_f32 v56, v48, v49
    v_cvt_pk_f16_f32 v57, v50, v51
    v_pk_mul_f32 v[52:53], v[48:49], v[32:33] op_sel:[0,0] op_sel_hi:[0,1]
    v_pk_mul_f32 v[54:55], v[50:51], v[34:35] op_sel:[0,0] op_sel_hi:[0,1]
    v_pk_fma_f32 v[48:49], v[48:49], v[32:33], v[52:53] op_sel:[1,1,0] op_sel_hi:[1,0,1] neg_lo:[0,1,0]
    v_pk_fma_f32 v[50:51], v[50:51], v[34:35], v[54:55] op_sel:[1,1,0] op_sel_hi:[1,0,1] neg_lo:[0,1,0]
    ds_write_b64 v2, v[56:57] offset:1056
    v_cvt_pk_f16_f32 v58, v48, v49
    v_cvt_pk_f16_f32 v59, v50, v51
    v_pk_mul_f32 v[52:53], v[48:49], v[32:33] op_sel:[0,0] op_sel_hi:[0,1]
    v_pk_mul_f32 v[54:55], v[50:51], v[34:35] op_sel:[0,0] op_sel_hi:[0,1]
    v_pk_fma_f32 v[48:49], v[48:49], v[32:33], v[52:53] op_sel:[1,1,0] op_sel_hi:[1,0,1] neg_lo:[0,1,0]
    v_pk_fma_f32 v[50:51], v[50:51], v[34:35], v[54:55] op_sel:[1,1,0] op_sel_hi:[1,0,1] neg_lo:[0,1,0]
    ds_write_b64 v2, v[58:59] offset:1584
    v_cvt_pk_f16_f32 v56, v48, v49
    v_cvt_pk_f16_f32 v57, v50, v51
    v_pk_mul_f32 v[52:53], v[48:49], v[32:33] op_sel:[0,0] op_sel_hi:[0,1]
    v_pk_mul_f32 v[54:55], v[50:51], v[34:35] op_sel:[0,0] op_sel_hi:[0,1]
    v_pk_fma_f32 v[48:49], v[48:49], v[32:33], v[52:53] op_sel:[1,1,0] op_sel_hi:[1,0,1] neg_lo:[0,1,0]
    v_pk_fma_f32 v[50:51], v[50:51], v[34:35], v[54:55] op_sel:[1,1,0] op_sel_hi:[1,0,1] neg_lo:[0,1,0]
    ds_write_b64 v2, v[56:57] offset:2112
    v_cvt_pk_f16_f32 v58, v48, v49
    v_cvt_pk_f16_f32 v59, v50, v51
    v_pk_mul_f32 v[52:53], v[48:49], v[32:33] op_sel:[0,0] op_sel_hi:[0,1]
    v_pk_mul_f32 v[54:55], v[50:51], v[34:35] op_sel:[0,0] op_sel_hi:[0,1]
    v_pk_fma_f32 v[48:49], v[48:49], v[32:33], v[52:53] op_sel:[1,1,0] op_sel_hi:[1,0,1] neg_lo:[0,1,0]
    v_pk_fma_f32 v[50:51], v[50:51], v[34:35], v[54:55] op_sel:[1,1,0] op_sel_hi:[1,0,1] neg_lo:[0,1,0]
    ds_write_b64 v2, v[58:59] offset:2640
    v_cvt_pk_f16_f32 v56, v48, v49
    v_cvt_pk_f16_f32 v57, v50, v51
    v_pk_mul_f32 v[52:53], v[48:49], v[32:33] op_sel:[0,0] op_sel_hi:[0,1]
    v_pk_mul_f32 v[54:55], v[50:51], v[34:35] op_sel:[0,0] op_sel_hi:[0,1]
    v_pk_fma_f32 v[48:49], v[48:49], v[32:33], v[52:53] op_sel:[1,1,0] op_sel_hi:[1,0,1] neg_lo:[0,1,0]
    v_pk_fma_f32 v[50:51], v[50:51], v[34:35], v[54:55] op_sel:[1,1,0] op_sel_hi:[1,0,1] neg_lo:[0,1,0]
    ds_write_b64 v2, v[56:57] offset:3168
    v_cvt_pk_f16_f32 v58, v48, v49
    v_cvt_pk_f16_f32 v59, v50, v51
    v_pk_mul_f32 v[52:53], v[48:49], v[32:33] op_sel:[0,0] op_sel_hi:[0,1]
    v_pk_mul_f32 v[54:55], v[50:51], v[34:35] op_sel:[0,0] op_sel_hi:[0,1]
    v_pk_fma_f32 v[48:49], v[48:49], v[32:33], v[52:53] op_sel:[1,1,0] op_sel_hi:[1,0,1] neg_lo:[0,1,0]
    v_pk_fma_f32 v[50:51], v[50:51], v[34:35], v[54:55] op_sel:[1,1,0] op_sel_hi:[1,0,1] neg_lo:[0,1,0]
    ds_write_b64 v2, v[58:59] offset:3696
    v_cvt_pk_f16_f32 v56, v48, v49
    v_cvt_pk_f16_f32 v57, v50, v51
    v_pk_mul_f32 v[52:53], v[48:49], v[32:33] op_sel:[0,0] op_sel_hi:[0,1]
    v_pk_mul_f32 v[54:55], v[50:51], v[34:35] op_sel:[0,0] op_sel_hi:[0,1]
    v_pk_fma_f32 v[48:49], v[48:49], v[32:33], v[52:53] op_sel:[1,1,0] op_sel_hi:[1,0,1] neg_lo:[0,1,0]
    v_pk_fma_f32 v[50:51], v[50:51], v[34:35], v[54:55] op_sel:[1,1,0] op_sel_hi:[1,0,1] neg_lo:[0,1,0]
    ds_write_b64 v2, v[56:57] offset:4224
    v_cvt_pk_f16_f32 v58, v48, v49
    v_cvt_pk_f16_f32 v59, v50, v51
    v_pk_mul_f32 v[52:53], v[48:49], v[32:33] op_sel:[0,0] op_sel_hi:[0,1]
    v_pk_mul_f32 v[54:55], v[50:51], v[34:35] op_sel:[0,0] op_sel_hi:[0,1]
    v_pk_fma_f32 v[48:49], v[48:49], v[32:33], v[52:53] op_sel:[1,1,0] op_sel_hi:[1,0,1] neg_lo:[0,1,0]
    v_pk_fma_f32 v[50:51], v[50:51], v[34:35], v[54:55] op_sel:[1,1,0] op_sel_hi:[1,0,1] neg_lo:[0,1,0]
    ds_write_b64 v2, v[58:59] offset:4752
    v_cvt_pk_f16_f32 v56, v48, v49
    v_cvt_pk_f16_f32 v57, v50, v51
    v_pk_mul_f32 v[52:53], v[48:49], v[32:33] op_sel:[0,0] op_sel_hi:[0,1]
    v_pk_mul_f32 v[54:55], v[50:51], v[34:35] op_sel:[0,0] op_sel_hi:[0,1]
    v_pk_fma_f32 v[48:49], v[48:49], v[32:33], v[52:53] op_sel:[1,1,0] op_sel_hi:[1,0,1] neg_lo:[0,1,0]
    v_pk_fma_f32 v[50:51], v[50:51], v[34:35], v[54:55] op_sel:[1,1,0] op_sel_hi:[1,0,1] neg_lo:[0,1,0]
    ds_write_b64 v2, v[56:57] offset:5280
    v_cvt_pk_f16_f32 v58, v48, v49
    v_cvt_pk_f16_f32 v59, v50, v51
    v_pk_mul_f32 v[52:53], v[48:49], v[32:33] op_sel:[0,0] op_sel_hi:[0,1]
    v_pk_mul_f32 v[54:55], v[50:51], v[34:35] op_sel:[0,0] op_sel_hi:[0,1]
    v_pk_fma_f32 v[48:49], v[48:49], v[32:33], v[52:53] op_sel:[1,1,0] op_sel_hi:[1,0,1] neg_lo:[0,1,0]
    v_pk_fma_f32 v[50:51], v[50:51], v[34:35], v[54:55] op_sel:[1,1,0] op_sel_hi:[1,0,1] neg_lo:[0,1,0]
    ds_write_b64 v2, v[58:59] offset:5808
    v_cvt_pk_f16_f32 v56, v48, v49
    v_cvt_pk_f16_f32 v57, v50, v51
    v_pk_mul_f32 v[52:53], v[48:49], v[32:33] op_sel:[0,0] op_sel_hi:[0,1]
    v_pk_mul_f32 v[54:55], v[50:51], v[34:35] op_sel:[0,0] op_sel_hi:[0,1]
    v_pk_fma_f32 v[48:49], v[48:49], v[32:33], v[52:53] op_sel:[1,1,0] op_sel_hi:[1,0,1] neg_lo:[0,1,0]
    v_pk_fma_f32 v[50:51], v[50:51], v[34:35], v[54:55] op_sel:[1,1,0] op_sel_hi:[1,0,1] neg_lo:[0,1,0]
    ds_write_b64 v2, v[56:57] offset:6336
    v_cvt_pk_f16_f32 v58, v48, v49
    v_cvt_pk_f16_f32 v59, v50, v51
    v_pk_mul_f32 v[52:53], v[48:49], v[32:33] op_sel:[0,0] op_sel_hi:[0,1]
    v_pk_mul_f32 v[54:55], v[50:51], v[34:35] op_sel:[0,0] op_sel_hi:[0,1]
    v_pk_fma_f32 v[48:49], v[48:49], v[32:33], v[52:53] op_sel:[1,1,0] op_sel_hi:[1,0,1] neg_lo:[0,1,0]
    v_pk_fma_f32 v[50:51], v[50:51], v[34:35], v[54:55] op_sel:[1,1,0] op_sel_hi:[1,0,1] neg_lo:[0,1,0]
    ds_write_b64 v2, v[58:59] offset:6864
    v_cvt_pk_f16_f32 v56, v48, v49
    v_cvt_pk_f16_f32 v57, v50, v51
    v_pk_mul_f32 v[52:53], v[48:49], v[32:33] op_sel:[0,0] op_sel_hi:[0,1]
    v_pk_mul_f32 v[54:55], v[50:51], v[34:35] op_sel:[0,0] op_sel_hi:[0,1]
    v_pk_fma_f32 v[48:49], v[48:49], v[32:33], v[52:53] op_sel:[1,1,0] op_sel_hi:[1,0,1] neg_lo:[0,1,0]
    v_pk_fma_f32 v[50:51], v[50:51], v[34:35], v[54:55] op_sel:[1,1,0] op_sel_hi:[1,0,1] neg_lo:[0,1,0]
    ds_write_b64 v2, v[56:57] offset:7392
    v_cvt_pk_f16_f32 v58, v48, v49
    v_cvt_pk_f16_f32 v59, v50, v51
    ds_write_b64 v2, v[58:59] offset:7920
    ds_read_b128 v[64:67], v3 offset:0
    ds_read_b128 v[68:71], v3 offset:64
    ds_read_b128 v[72:75], v3 offset:128
    ds_read_b128 v[76:79], v3 offset:192
    ds_read_b128 v[80:83], v3 offset:256
    ds_read_b128 v[84:87], v3 offset:320
    ds_read_b128 v[88:91], v3 offset:384
    ds_read_b128 v[92:95], v3 offset:448
    v_cvt_pk_f16_f32 v56, v16, v17
    v_cvt_pk_f16_f32 v57, v18, v19
    v_pk_mul_f32 v[52:53], v[16:17], v[28:29] op_sel:[0,0] op_sel_hi:[0,1]
    v_pk_mul_f32 v[54:55], v[18:19], v[30:31] op_sel:[0,0] op_sel_hi:[0,1]
    v_pk_fma_f32 v[48:49], v[16:17], v[28:29], v[52:53] op_sel:[1,1,0] op_sel_hi:[1,0,1] neg_lo:[0,1,0]
    v_pk_fma_f32 v[50:51], v[18:19], v[30:31], v[54:55] op_sel:[1,1,0] op_sel_hi:[1,0,1] neg_lo:[0,1,0]
    ds_write_b64 v2, v[56:57] offset:0
    v_cvt_pk_f16_f32 v58, v48, v49
    v_cvt_pk_f16_f32 v59, v50, v51
    v_pk_mul_f32 v[52:53], v[48:49], v[28:29] op_sel:[0,0] op_sel_hi:[0,1]
    v_pk_mul_f32 v[54:55], v[50:51], v[30:31] op_sel:[0,0] op_sel_hi:[0,1]
    v_pk_fma_f32 v[48:49], v[48:49], v[28:29], v[52:53] op_sel:[1,1,0] op_sel_hi:[1,0,1] neg_lo:[0,1,0]
    v_pk_fma_f32 v[50:51], v[50:51], v[30:31], v[54:55] op_sel:[1,1,0] op_sel_hi:[1,0,1] neg_lo:[0,1,0]
    ds_write_b64 v2, v[58:59] offset:528
    v_cvt_pk_f16_f32 v56, v48, v49
    v_cvt_pk_f16_f32 v57, v50, v51
    v_pk_mul_f32 v[52:53], v[48:49], v[28:29] op_sel:[0,0] op_sel_hi:[0,1]
    v_pk_mul_f32 v[54:55], v[50:51], v[30:31] op_sel:[0,0] op_sel_hi:[0,1]
    v_pk_fma_f32 v[48:49], v[48:49], v[28:29], v[52:53] op_sel:[1,1,0] op_sel_hi:[1,0,1] neg_lo:[0,1,0]
    v_pk_fma_f32 v[50:51], v[50:51], v[30:31], v[54:55] op_sel:[1,1,0] op_sel_hi:[1,0,1] neg_lo:[0,1,0]
    ds_write_b64 v2, v[56:57] offset:1056
    v_cvt_pk_f16_f32 v58, v48, v49
    v_cvt_pk_f16_f32 v59, v50, v51
    v_pk_mul_f32 v[52:53], v[48:49], v[28:29] op_sel:[0,0] op_sel_hi:[0,1]
    v_pk_mul_f32 v[54:55], v[50:51], v[30:31] op_sel:[0,0] op_sel_hi:[0,1]
    v_pk_fma_f32 v[48:49], v[48:49], v[28:29], v[52:53] op_sel:[1,1,0] op_sel_hi:[1,0,1] neg_lo:[0,1,0]
    v_pk_fma_f32 v[50:51], v[50:51], v[30:31], v[54:55] op_sel:[1,1,0] op_sel_hi:[1,0,1] neg_lo:[0,1,0]
    ds_write_b64 v2, v[58:59] offset:1584
    v_cvt_pk_f16_f32 v56, v48, v49
    v_cvt_pk_f16_f32 v57, v50, v51
    v_pk_mul_f32 v[52:53], v[48:49], v[28:29] op_sel:[0,0] op_sel_hi:[0,1]
    v_pk_mul_f32 v[54:55], v[50:51], v[30:31] op_sel:[0,0] op_sel_hi:[0,1]
    v_pk_fma_f32 v[48:49], v[48:49], v[28:29], v[52:53] op_sel:[1,1,0] op_sel_hi:[1,0,1] neg_lo:[0,1,0]
    v_pk_fma_f32 v[50:51], v[50:51], v[30:31], v[54:55] op_sel:[1,1,0] op_sel_hi:[1,0,1] neg_lo:[0,1,0]
    ds_write_b64 v2, v[56:57] offset:2112
    v_cvt_pk_f16_f32 v58, v48, v49
    v_cvt_pk_f16_f32 v59, v50, v51
    v_pk_mul_f32 v[52:53], v[48:49], v[28:29] op_sel:[0,0] op_sel_hi:[0,1]
    v_pk_mul_f32 v[54:55], v[50:51], v[30:31] op_sel:[0,0] op_sel_hi:[0,1]
    v_pk_fma_f32 v[48:49], v[48:49], v[28:29], v[52:53] op_sel:[1,1,0] op_sel_hi:[1,0,1] neg_lo:[0,1,0]
    v_pk_fma_f32 v[50:51], v[50:51], v[30:31], v[54:55] op_sel:[1,1,0] op_sel_hi:[1,0,1] neg_lo:[0,1,0]
    ds_write_b64 v2, v[58:59] offset:2640
    v_cvt_pk_f16_f32 v56, v48, v49
    v_cvt_pk_f16_f32 v57, v50, v51
    v_pk_mul_f32 v[52:53], v[48:49], v[28:29] op_sel:[0,0] op_sel_hi:[0,1]
    v_pk_mul_f32 v[54:55], v[50:51], v[30:31] op_sel:[0,0] op_sel_hi:[0,1]
    v_pk_fma_f32 v[48:49], v[48:49], v[28:29], v[52:53] op_sel:[1,1,0] op_sel_hi:[1,0,1] neg_lo:[0,1,0]
    v_pk_fma_f32 v[50:51], v[50:51], v[30:31], v[54:55] op_sel:[1,1,0] op_sel_hi:[1,0,1] neg_lo:[0,1,0]
    ds_write_b64 v2, v[56:57] offset:3168
    v_cvt_pk_f16_f32 v58, v48, v49
    v_cvt_pk_f16_f32 v59, v50, v51
    v_pk_mul_f32 v[52:53], v[16:17], v[36:37] op_sel:[0,0] op_sel_hi:[0,1]
    v_pk_mul_f32 v[54:55], v[18:19], v[38:39] op_sel:[0,0] op_sel_hi:[0,1]
    v_pk_fma_f32 v[16:17], v[16:17], v[36:37], v[52:53] op_sel:[1,1,0] op_sel_hi:[1,0,1] neg_lo:[0,1,0]
    v_pk_fma_f32 v[18:19], v[18:19], v[38:39], v[54:55] op_sel:[1,1,0] op_sel_hi:[1,0,1] neg_lo:[0,1,0]
    ds_write_b64 v2, v[58:59] offset:3696
    v_cvt_pk_f16_f32 v56, v16, v17
    v_cvt_pk_f16_f32 v57, v18, v19
    v_pk_mul_f32 v[52:53], v[16:17], v[28:29] op_sel:[0,0] op_sel_hi:[0,1]
    v_pk_mul_f32 v[54:55], v[18:19], v[30:31] op_sel:[0,0] op_sel_hi:[0,1]
    v_pk_fma_f32 v[48:49], v[16:17], v[28:29], v[52:53] op_sel:[1,1,0] op_sel_hi:[1,0,1] neg_lo:[0,1,0]
    v_pk_fma_f32 v[50:51], v[18:19], v[30:31], v[54:55] op_sel:[1,1,0] op_sel_hi:[1,0,1] neg_lo:[0,1,0]
    ds_write_b64 v2, v[56:57] offset:4224
    v_cvt_pk_f16_f32 v58, v48, v49
    v_cvt_pk_f16_f32 v59, v50, v51
    v_pk_mul_f32 v[52:53], v[48:49], v[28:29] op_sel:[0,0] op_sel_hi:[0,1]
    v_pk_mul_f32 v[54:55], v[50:51], v[30:31] op_sel:[0,0] op_sel_hi:[0,1]
    v_pk_fma_f32 v[48:49], v[48:49], v[28:29], v[52:53] op_sel:[1,1,0] op_sel_hi:[1,0,1] neg_lo:[0,1,0]
    v_pk_fma_f32 v[50:51], v[50:51], v[30:31], v[54:55] op_sel:[1,1,0] op_sel_hi:[1,0,1] neg_lo:[0,1,0]
    ds_write_b64 v2, v[58:59] offset:4752
    v_cvt_pk_f16_f32 v56, v48, v49
    v_cvt_pk_f16_f32 v57, v50, v51
    v_pk_mul_f32 v[52:53], v[48:49], v[28:29] op_sel:[0,0] op_sel_hi:[0,1]
    v_pk_mul_f32 v[54:55], v[50:51], v[30:31] op_sel:[0,0] op_sel_hi:[0,1]
    v_pk_fma_f32 v[48:49], v[48:49], v[28:29], v[52:53] op_sel:[1,1,0] op_sel_hi:[1,0,1] neg_lo:[0,1,0]
    v_pk_fma_f32 v[50:51], v[50:51], v[30:31], v[54:55] op_sel:[1,1,0] op_sel_hi:[1,0,1] neg_lo:[0,1,0]
    ds_write_b64 v2, v[56:57] offset:5280
    v_cvt_pk_f16_f32 v58, v48, v49
    v_cvt_pk_f16_f32 v59, v50, v51
    v_pk_mul_f32 v[52:53], v[48:49], v[28:29] op_sel:[0,0] op_sel_hi:[0,1]
    v_pk_mul_f32 v[54:55], v[50:51], v[30:31] op_sel:[0,0] op_sel_hi:[0,1]
    v_pk_fma_f32 v[48:49], v[48:49], v[28:29], v[52:53] op_sel:[1,1,0] op_sel_hi:[1,0,1] neg_lo:[0,1,0]
    v_pk_fma_f32 v[50:51], v[50:51], v[30:31], v[54:55] op_sel:[1,1,0] op_sel_hi:[1,0,1] neg_lo:[0,1,0]
    ds_write_b64 v2, v[58:59] offset:5808
    v_cvt_pk_f16_f32 v56, v48, v49
    v_cvt_pk_f16_f32 v57, v50, v51
    v_pk_mul_f32 v[52:53], v[48:49], v[28:29] op_sel:[0,0] op_sel_hi:[0,1]
    v_pk_mul_f32 v[54:55], v[50:51], v[30:31] op_sel:[0,0] op_sel_hi:[0,1]
    v_pk_fma_f32 v[48:49], v[48:49], v[28:29], v[52:53] op_sel:[1,1,0] op_sel_hi:[1,0,1] neg_lo:[0,1,0]
    v_pk_fma_f32 v[50:51], v[50:51], v[30:31], v[54:55] op_sel:[1,1,0] op_sel_hi:[1,0,1] neg_lo:[0,1,0]
    ds_write_b64 v2, v[56:57] offset:6336
    v_cvt_pk_f16_f32 v58, v48, v49
    v_cvt_pk_f16_f32 v59, v50, v51
    v_pk_mul_f32 v[52:53], v[48:49], v[28:29] op_sel:[0,0] op_sel_hi:[0,1]
    v_pk_mul_f32 v[54:55], v[50:51], v[30:31] op_sel:[0,0] op_sel_hi:[0,1]
    v_pk_fma_f32 v[48:49], v[48:49], v[28:29], v[52:53] op_sel:[1,1,0] op_sel_hi:[1,0,1] neg_lo:[0,1,0]
    v_pk_fma_f32 v[50:51], v[50:51], v[30:31], v[54:55] op_sel:[1,1,0] op_sel_hi:[1,0,1] neg_lo:[0,1,0]
    ds_write_b64 v2, v[58:59] offset:6864
    v_cvt_pk_f16_f32 v56, v48, v49
    v_cvt_pk_f16_f32 v57, v50, v51
    v_pk_mul_f32 v[52:53], v[48:49], v[28:29] op_sel:[0,0] op_sel_hi:[0,1]
    v_pk_mul_f32 v[54:55], v[50:51], v[30:31] op_sel:[0,0] op_sel_hi:[0,1]
    v_pk_fma_f32 v[48:49], v[48:49], v[28:29], v[52:53] op_sel:[1,1,0] op_sel_hi:[1,0,1] neg_lo:[0,1,0]
    v_pk_fma_f32 v[50:51], v[50:51], v[30:31], v[54:55] op_sel:[1,1,0] op_sel_hi:[1,0,1] neg_lo:[0,1,0]
    ds_write_b64 v2, v[56:57] offset:7392
    v_cvt_pk_f16_f32 v58, v48, v49
    v_cvt_pk_f16_f32 v59, v50, v51
    ds_write_b64 v2, v[58:59] offset:7920
    ds_read_b128 v[96:99], v3 offset:0
    ds_read_b128 v[100:103], v3 offset:64
    ds_read_b128 v[104:107], v3 offset:128
    ds_read_b128 v[108:111], v3 offset:192
    ds_read_b128 v[112:115], v3 offset:256
    ds_read_b128 v[116:119], v3 offset:320
    ds_read_b128 v[120:123], v3 offset:384
    ds_read_b128 v[124:127], v3 offset:448
    s_waitcnt lgkmcnt(0)
    v_mfma_f32_16x16x32_f16 v[160:163], v[96:99], v[64:67], v[160:163]
    v_mfma_f32_16x16x32_f16 v[160:163], v[100:103], v[68:71], v[160:163]
    v_mfma_f32_16x16x32_f16 v[160:163], v[104:107], v[72:75], v[160:163]
    v_mfma_f32_16x16x32_f16 v[160:163], v[108:111], v[76:79], v[160:163]
    v_mfma_f32_16x16x32_f16 v[160:163], v[112:115], v[80:83], v[160:163]
    v_mfma_f32_16x16x32_f16 v[160:163], v[116:119], v[84:87], v[160:163]
    v_mfma_f32_16x16x32_f16 v[160:163], v[120:123], v[88:91], v[160:163]
    v_mfma_f32_16x16x32_f16 v[160:163], v[124:127], v[92:95], v[160:163]
    v_lshlrev_b32 v8, 4, v4
    v_sub_u32 v8, s0, v8
    v_lshlrev_b32 v9, 10, v5
    v_sub_u32 v9, v8, v9
    v_lshlrev_b32 v10, 9, v5
    v_sub_u32 v10, v8, v10
    v_lshlrev_b32 v11, 8, v5
    v_sub_u32 v11, v8, v11
    v_lshrrev_b32 v6, 1, v5
    v_lshlrev_b32 v6, 8, v6
    v_and_b32 v7, 1, v5
    v_lshl_add_u32 v6, v7, 3, v6
    v_sub_u32 v8, v8, v6
    v_mul_f32 v160, v160, v22
    v_mul_f32 v161, v161, v22
    v_mul_f32 v162, v162, v22
    v_mul_f32 v163, v163, v22
    v_mov_b32 v6, 0
    v_lshlrev_b32 v7, 2, v0
    v_add_u32 v7, s0, v7
    s_mov_b64 exec, 0x3ff
    ds_write_b32 v7, v6 offset:4120
    s_mov_b64 exec, -1
    v_cvt_pk_bf16_f32 v84, v163, v162
    v_cvt_pk_bf16_f32 v85, v161, v160
    ds_write_b64 v8, v[84:85] offset:4112
    s_branch gated_mix__ssm_conv_s4d__mixer_gmlp__prompt_kernel_Cnk
gated_mix__ssm_conv_s4d__mixer_gmlp__prompt_kernel_Cnp:
    s_getpc_b64 s[64:65]
gated_mix__ssm_conv_s4d__mixer_gmlp__prompt_kernel_Chpa:
    s_add_u32 s64, s64, gated_mix__ssm_conv_s4d__mixer_gmlp__prompt_kernel_Chelp-gated_mix__ssm_conv_s4d__mixer_gmlp__prompt_kernel_Chpa
    s_addc_u32 s65, s65, 0
    s_swappc_b64 s[70:71], s[64:65]
gated_mix__ssm_conv_s4d__mixer_gmlp__prompt_kernel_Cnk:
    v_and_b32 v5, 15, v0
    v_lshrrev_b32 v6, 4, v0
    v_lshrrev_b32 v7, 1, v5
    v_xor_b32 v7, v7, v6
    v_lshlrev_b32 v7, 4, v7
    v_lshl_add_u32 v7, v5, 7, v7
    s_lshl_b32 s64, s25, 12
    s_add_u32 s64, s64, 18432
    v_add_u32 v212, s64, v7
    v_xor_b32 v213, 64, v212
    v_mov_b32 v14, v212
    v_and_b32 v2, 1, v6
    v_lshrrev_b32 v3, 2, v5
    v_lshl_add_u32 v2, v2, 2, v3
    v_lshrrev_b32 v3, 1, v6
    v_lshl_add_u32 v3, v3, 4, v2
    v_and_b32 v4, 3, v5
    v_lshlrev_b32 v4, 3, v4
    v_lshl_add_u32 v7, v3, 8, v4
    v_lshl_add_u32 v7, v2, 5, v7
    v_xor_b32 v214, 0, v7
    v_xor_b32 v215, 32, v7
    v_xor_b32 v216, 64, v7
    v_xor_b32 v217, 96, v7
    v_xor_b32 v218, 128, v7
    v_xor_b32 v219, 160, v7
    v_xor_b32 v220, 192, v7
    v_xor_b32 v221, 224, v7
    v_lshl_add_u32 v7, v3, 5, v4
    v_add_u32 v222, 16384, v7
    v_mov_b32 v15, 0xbdd2d3e8
    v_mov_b32 v16, 0
    v_mov_b32 v17, 0
    v_mov_b32 v18, 0
    v_mov_b32 v19, 0
    v_mov_b32 v20, 0
    v_mov_b32 v21, 0
    v_mov_b32 v22, 0
    v_mov_b32 v23, 0
    v_mov_b32 v24, 0
    v_mov_b32 v25, 0
    v_mov_b32 v26, 0
    v_mov_b32 v27, 0
    v_mov_b32 v28, 0
    v_mov_b32 v29, 0
    v_mov_b32 v30, 0
    v_mov_b32 v31, 0
    v_mov_b32 v32, 0
    v_mov_b32 v33, 0
    v_mov_b32 v34, 0
    v_mov_b32 v35, 0
    v_mov_b32 v36, 0
    v_mov_b32 v37, 0
    v_mov_b32 v38, 0
    v_mov_b32 v39, 0
    v_mov_b32 v40, 0
    v_mov_b32 v41, 0
    v_mov_b32 v42, 0
    v_mov_b32 v43, 0
    v_mov_b32 v44, 0
    v_mov_b32 v45, 0
    v_mov_b32 v46, 0
    v_mov_b32 v47, 0
    v_mov_b32 v48, 0
    v_mov_b32 v49, 0
    v_mov_b32 v50, 0
    v_mov_b32 v51, 0
    v_mov_b32 v52, 0
    v_mov_b32 v53, 0
    v_mov_b32 v54, 0
    v_mov_b32 v55, 0
    v_mov_b32 v56, 0
    v_mov_b32 v57, 0
    v_mov_b32 v58, 0
    v_mov_b32 v59, 0
    v_mov_b32 v60, 0
    v_mov_b32 v61, 0
    v_mov_b32 v62, 0
    v_mov_b32 v63, 0
    v_mov_b32 v64, 0
    v_mov_b32 v65, 0
    v_mov_b32 v66, 0
    v_mov_b32 v67, 0
    v_mov_b32 v68, 0
    v_mov_b32 v69, 0
    v_mov_b32 v70, 0
    v_mov_b32 v71, 0
    v_mov_b32 v72, 0
    v_mov_b32 v73, 0
    v_mov_b32 v74, 0
    v_mov_b32 v75, 0
    v_mov_b32 v76, 0
    v_mov_b32 v77, 0
    v_mov_b32 v78, 0
    v_mov_b32 v79, 0
    v_mov_b32 v80, 0
    v_mov_b32 v81, 0
    v_mov_b32 v82, 0
    v_mov_b32 v83, 0
    v_mov_b32 v84, 0
    v_mov_b32 v85, 0
    v_mov_b32 v86, 0
    v_mov_b32 v87, 0
    s_mov_b32 s68, 0
    s_mov_b32 s69, 34816
    s_waitcnt vmcnt(3)
    s_cmp_ge_u32 s26, 9
    s_cbranch_scc1 gated_mix__ssm_conv_s4d__mixer_gmlp__prompt_kernel_Cnw0
    s_waitcnt vmcnt(0)
gated_mix__ssm_conv_s4d__mixer_gmlp__prompt_kernel_Cnw0:
    s_barrier
    ds_read_b128 v[124:127], v212 offset:0
    ds_read_b64_tr_b16 v[132:133], v214 offset:0
    ds_read_b64_tr_b16 v[134:135], v214 offset:2048
    ds_read_b128 v[128:131], v212 offset:2048
    ds_read_b64_tr_b16 v[136:137], v215 offset:0
    ds_read_b64_tr_b16 v[138:139], v215 offset:2048
    ds_read_b64_tr_b16 v[140:141], v216 offset:0
    ds_read_b64_tr_b16 v[142:143], v216 offset:2048
    ds_read_b64_tr_b16 v[144:145], v217 offset:0
    ds_read_b64_tr_b16 v[146:147], v217 offset:2048
    ds_read_b64_tr_b16 v[148:149], v218 offset:0
    ds_read_b64_tr_b16 v[150:151], v218 offset:2048
    ds_read_b64_tr_b16 v[152:153], v219 offset:0
    ds_read_b64_tr_b16 v[154:155], v219 offset:2048
    ds_read_b64_tr_b16 v[156:157], v220 offset:0
    ds_read_b64_tr_b16 v[158:159], v220 offset:2048
    ds_read_b64_tr_b16 v[160:161], v221 offset:0
    ds_read_b64_tr_b16 v[162:163], v221 offset:2048
    ds_read_b64_tr_b16 v[164:165], v222 offset:0
    ds_read_b64_tr_b16 v[166:167], v222 offset:256
    s_mov_b32 s71, 3
.p2align 6
gated_mix__ssm_conv_s4d__mixer_gmlp__prompt_kernel_g10:
    s_waitcnt lgkmcnt(0)
    v_mfma_f32_16x16x32_bf16 v[16:19], v[124:127], v[132:135], v[16:19]
    ds_read_b128 v[168:171], v213 offset:0
    ds_read_b64_tr_b16 v[176:177], v214 offset:8192
    v_mfma_f32_16x16x32_bf16 v[20:23], v[128:131], v[132:135], v[20:23]
    ds_read_b64_tr_b16 v[178:179], v214 offset:10240
    ds_read_b128 v[172:175], v213 offset:2048
    v_mfma_f32_16x16x32_bf16 v[24:27], v[124:127], v[136:139], v[24:27]
    ds_read_b64_tr_b16 v[180:181], v215 offset:8192
    ds_read_b64_tr_b16 v[182:183], v215 offset:10240
    v_mfma_f32_16x16x32_bf16 v[28:31], v[128:131], v[136:139], v[28:31]
    ds_read_b64_tr_b16 v[184:185], v216 offset:8192
    ds_read_b64_tr_b16 v[186:187], v216 offset:10240
    v_mfma_f32_16x16x32_bf16 v[32:35], v[124:127], v[140:143], v[32:35]
    ds_read_b64_tr_b16 v[188:189], v217 offset:8192
    ds_read_b64_tr_b16 v[190:191], v217 offset:10240
    v_mfma_f32_16x16x32_bf16 v[36:39], v[128:131], v[140:143], v[36:39]
    ds_read_b64_tr_b16 v[192:193], v218 offset:8192
    ds_read_b64_tr_b16 v[194:195], v218 offset:10240
    v_mfma_f32_16x16x32_bf16 v[40:43], v[124:127], v[144:147], v[40:43]
    ds_read_b64_tr_b16 v[196:197], v219 offset:8192
    ds_read_b64_tr_b16 v[198:199], v219 offset:10240
    v_mfma_f32_16x16x32_bf16 v[44:47], v[128:131], v[144:147], v[44:47]
    ds_read_b64_tr_b16 v[200:201], v220 offset:8192
    ds_read_b64_tr_b16 v[202:203], v220 offset:10240
    v_mfma_f32_16x16x32_bf16 v[48:51], v[124:127], v[148:151], v[48:51]
    ds_read_b64_tr_b16 v[204:205], v221 offset:8192
    ds_read_b64_tr_b16 v[206:207], v221 offset:10240
    v_mfma_f32_16x16x32_bf16 v[52:55], v[128:131], v[148:151], v[52:55]
    ds_read_b64_tr_b16 v[208:209], v222 offset:1024
    ds_read_b64_tr_b16 v[210:211], v222 offset:1280
    v_mfma_f32_16x16x32_bf16 v[56:59], v[124:127], v[152:155], v[56:59]
    s_add_u32 s68, s68, 1
    s_and_b32 s68, s68, 3
    s_cselect_b32 s70, s69, -104448
    v_mfma_f32_16x16x32_bf16 v[60:63], v[128:131], v[152:155], v[60:63]
    v_add_u32 v212, s70, v212
    v_add_u32 v213, s70, v213
    v_mfma_f32_16x16x32_bf16 v[64:67], v[124:127], v[156:159], v[64:67]
    v_add_u32 v214, s70, v214
    v_add_u32 v215, s70, v215
    v_mfma_f32_16x16x32_bf16 v[68:71], v[128:131], v[156:159], v[68:71]
    v_add_u32 v216, s70, v216
    v_add_u32 v217, s70, v217
    v_mfma_f32_16x16x32_bf16 v[72:75], v[124:127], v[160:163], v[72:75]
    v_add_u32 v218, s70, v218
    v_add_u32 v219, s70, v219
    v_mfma_f32_16x16x32_bf16 v[76:79], v[128:131], v[160:163], v[76:79]
    v_add_u32 v220, s70, v220
    v_add_u32 v221, s70, v221
    v_mfma_f32_16x16x32_bf16 v[80:83], v[124:127], v[164:167], v[80:83]
    v_add_u32 v222, s70, v222
    v_mfma_f32_16x16x32_bf16 v[84:87], v[128:131], v[164:167], v[84:87]
    s_waitcnt lgkmcnt(0)
    s_barrier
    v_mfma_f32_16x16x32_bf16 v[16:19], v[168:171], v[176:179], v[16:19]
    ds_read_b128 v[124:127], v212 offset:0
    ds_read_b64_tr_b16 v[132:133], v214 offset:0
    v_mfma_f32_16x16x32_bf16 v[20:23], v[172:175], v[176:179], v[20:23]
    ds_read_b64_tr_b16 v[134:135], v214 offset:2048
    ds_read_b128 v[128:131], v212 offset:2048
    v_mfma_f32_16x16x32_bf16 v[24:27], v[168:171], v[180:183], v[24:27]
    ds_read_b64_tr_b16 v[136:137], v215 offset:0
    ds_read_b64_tr_b16 v[138:139], v215 offset:2048
    v_mfma_f32_16x16x32_bf16 v[28:31], v[172:175], v[180:183], v[28:31]
    ds_read_b64_tr_b16 v[140:141], v216 offset:0
    ds_read_b64_tr_b16 v[142:143], v216 offset:2048
    v_mfma_f32_16x16x32_bf16 v[32:35], v[168:171], v[184:187], v[32:35]
    ds_read_b64_tr_b16 v[144:145], v217 offset:0
    ds_read_b64_tr_b16 v[146:147], v217 offset:2048
    v_mfma_f32_16x16x32_bf16 v[36:39], v[172:175], v[184:187], v[36:39]
    ds_read_b64_tr_b16 v[148:149], v218 offset:0
    ds_read_b64_tr_b16 v[150:151], v218 offset:2048
    v_mfma_f32_16x16x32_bf16 v[40:43], v[168:171], v[188:191], v[40:43]
    ds_read_b64_tr_b16 v[152:153], v219 offset:0
    ds_read_b64_tr_b16 v[154:155], v219 offset:2048
    v_mfma_f32_16x16x32_bf16 v[44:47], v[172:175], v[188:191], v[44:47]
    ds_read_b64_tr_b16 v[156:157], v220 offset:0
    ds_read_b64_tr_b16 v[158:159], v220 offset:2048
    v_mfma_f32_16x16x32_bf16 v[48:51], v[168:171], v[192:195], v[48:51]
    ds_read_b64_tr_b16 v[160:161], v221 offset:0
    ds_read_b64_tr_b16 v[162:163], v221 offset:2048
    v_mfma_f32_16x16x32_bf16 v[52:55], v[172:175], v[192:195], v[52:55]
    ds_read_b64_tr_b16 v[164:165], v222 offset:0
    ds_read_b64_tr_b16 v[166:167], v222 offset:256
    v_mfma_f32_16x16x32_bf16 v[56:59], v[168:171], v[196:199], v[56:59]
    v_mfma_f32_16x16x32_bf16 v[60:63], v[172:175], v[196:199], v[60:63]
    v_mfma_f32_16x16x32_bf16 v[64:67], v[168:171], v[200:203], v[64:67]
    v_mfma_f32_16x16x32_bf16 v[68:71], v[172:175], v[200:203], v[68:71]
    v_mfma_f32_16x16x32_bf16 v[72:75], v[168:171], v[204:207], v[72:75]
    v_mfma_f32_16x16x32_bf16 v[76:79], v[172:175], v[204:207], v[76:79]
    v_mfma_f32_16x16x32_bf16 v[80:83], v[168:171], v[208:211], v[80:83]
    v_mfma_f32_16x16x32_bf16 v[84:87], v[172:175], v[208:211], v[84:87]
    s_waitcnt lgkmcnt(0)
    v_mfma_f32_16x16x32_bf16 v[16:19], v[124:127], v[132:135], v[16:19]
    ds_read_b128 v[168:171], v213 offset:0
    ds_read_b64_tr_b16 v[176:177], v214 offset:8192
    v_mfma_f32_16x16x32_bf16 v[20:23], v[128:131], v[132:135], v[20:23]
    ds_read_b64_tr_b16 v[178:179], v214 offset:10240
    ds_read_b128 v[172:175], v213 offset:2048
    v_mfma_f32_16x16x32_bf16 v[24:27], v[124:127], v[136:139], v[24:27]
    ds_read_b64_tr_b16 v[180:181], v215 offset:8192
    ds_read_b64_tr_b16 v[182:183], v215 offset:10240
    v_mfma_f32_16x16x32_bf16 v[28:31], v[128:131], v[136:139], v[28:31]
    ds_read_b64_tr_b16 v[184:185], v216 offset:8192
    ds_read_b64_tr_b16 v[186:187], v216 offset:10240
    v_mfma_f32_16x16x32_bf16 v[32:35], v[124:127], v[140:143], v[32:35]
    ds_read_b64_tr_b16 v[188:189], v217 offset:8192
    ds_read_b64_tr_b16 v[190:191], v217 offset:10240
    v_mfma_f32_16x16x32_bf16 v[36:39], v[128:131], v[140:143], v[36:39]
    ds_read_b64_tr_b16 v[192:193], v218 offset:8192
    ds_read_b64_tr_b16 v[194:195], v218 offset:10240
    v_mfma_f32_16x16x32_bf16 v[40:43], v[124:127], v[144:147], v[40:43]
    ds_read_b64_tr_b16 v[196:197], v219 offset:8192
    ds_read_b64_tr_b16 v[198:199], v219 offset:10240
    v_mfma_f32_16x16x32_bf16 v[44:47], v[128:131], v[144:147], v[44:47]
    ds_read_b64_tr_b16 v[200:201], v220 offset:8192
    ds_read_b64_tr_b16 v[202:203], v220 offset:10240
    v_mfma_f32_16x16x32_bf16 v[48:51], v[124:127], v[148:151], v[48:51]
    ds_read_b64_tr_b16 v[204:205], v221 offset:8192
    ds_read_b64_tr_b16 v[206:207], v221 offset:10240
    v_mfma_f32_16x16x32_bf16 v[52:55], v[128:131], v[148:151], v[52:55]
    ds_read_b64_tr_b16 v[208:209], v222 offset:1024
    ds_read_b64_tr_b16 v[210:211], v222 offset:1280
    v_mfma_f32_16x16x32_bf16 v[56:59], v[124:127], v[152:155], v[56:59]
    s_add_u32 s68, s68, 1
    s_and_b32 s68, s68, 3
    s_cselect_b32 s70, s69, -104448
    v_mfma_f32_16x16x32_bf16 v[60:63], v[128:131], v[152:155], v[60:63]
    v_add_u32 v212, s70, v212
    v_add_u32 v213, s70, v213
    v_mfma_f32_16x16x32_bf16 v[64:67], v[124:127], v[156:159], v[64:67]
    v_add_u32 v214, s70, v214
    v_add_u32 v215, s70, v215
    v_mfma_f32_16x16x32_bf16 v[68:71], v[128:131], v[156:159], v[68:71]
    v_add_u32 v216, s70, v216
    v_add_u32 v217, s70, v217
    v_mfma_f32_16x16x32_bf16 v[72:75], v[124:127], v[160:163], v[72:75]
    v_add_u32 v218, s70, v218
    v_add_u32 v219, s70, v219
    v_mfma_f32_16x16x32_bf16 v[76:79], v[128:131], v[160:163], v[76:79]
    v_add_u32 v220, s70, v220
    v_add_u32 v221, s70, v221
    v_mfma_f32_16x16x32_bf16 v[80:83], v[124:127], v[164:167], v[80:83]
    v_add_u32 v222, s70, v222
    v_mfma_f32_16x16x32_bf16 v[84:87], v[128:131], v[164:167], v[84:87]
    s_waitcnt lgkmcnt(0)
    s_barrier
    v_mfma_f32_16x16x32_bf16 v[16:19], v[168:171], v[176:179], v[16:19]
    ds_read_b128 v[124:127], v212 offset:0
    ds_read_b64_tr_b16 v[132:133], v214 offset:0
    v_mfma_f32_16x16x32_bf16 v[20:23], v[172:175], v[176:179], v[20:23]
    ds_read_b64_tr_b16 v[134:135], v214 offset:2048
    ds_read_b128 v[128:131], v212 offset:2048
    v_mfma_f32_16x16x32_bf16 v[24:27], v[168:171], v[180:183], v[24:27]
    ds_read_b64_tr_b16 v[136:137], v215 offset:0
    ds_read_b64_tr_b16 v[138:139], v215 offset:2048
    v_mfma_f32_16x16x32_bf16 v[28:31], v[172:175], v[180:183], v[28:31]
    ds_read_b64_tr_b16 v[140:141], v216 offset:0
    ds_read_b64_tr_b16 v[142:143], v216 offset:2048
    v_mfma_f32_16x16x32_bf16 v[32:35], v[168:171], v[184:187], v[32:35]
    ds_read_b64_tr_b16 v[144:145], v217 offset:0
    ds_read_b64_tr_b16 v[146:147], v217 offset:2048
    v_mfma_f32_16x16x32_bf16 v[36:39], v[172:175], v[184:187], v[36:39]
    ds_read_b64_tr_b16 v[148:149], v218 offset:0
    ds_read_b64_tr_b16 v[150:151], v218 offset:2048
    v_mfma_f32_16x16x32_bf16 v[40:43], v[168:171], v[188:191], v[40:43]
    ds_read_b64_tr_b16 v[152:153], v219 offset:0
    ds_read_b64_tr_b16 v[154:155], v219 offset:2048
    v_mfma_f32_16x16x32_bf16 v[44:47], v[172:175], v[188:191], v[44:47]
    ds_read_b64_tr_b16 v[156:157], v220 offset:0
    ds_read_b64_tr_b16 v[158:159], v220 offset:2048
    v_mfma_f32_16x16x32_bf16 v[48:51], v[168:171], v[192:195], v[48:51]
    ds_read_b64_tr_b16 v[160:161], v221 offset:0
    ds_read_b64_tr_b16 v[162:163], v221 offset:2048
    v_mfma_f32_16x16x32_bf16 v[52:55], v[172:175], v[192:195], v[52:55]
    ds_read_b64_tr_b16 v[164:165], v222 offset:0
    ds_read_b64_tr_b16 v[166:167], v222 offset:256
    v_mfma_f32_16x16x32_bf16 v[56:59], v[168:171], v[196:199], v[56:59]
    v_mfma_f32_16x16x32_bf16 v[60:63], v[172:175], v[196:199], v[60:63]
    v_mfma_f32_16x16x32_bf16 v[64:67], v[168:171], v[200:203], v[64:67]
    v_mfma_f32_16x16x32_bf16 v[68:71], v[172:175], v[200:203], v[68:71]
    v_mfma_f32_16x16x32_bf16 v[72:75], v[168:171], v[204:207], v[72:75]
    v_mfma_f32_16x16x32_bf16 v[76:79], v[172:175], v[204:207], v[76:79]
    v_mfma_f32_16x16x32_bf16 v[80:83], v[168:171], v[208:211], v[80:83]
    v_mfma_f32_16x16x32_bf16 v[84:87], v[172:175], v[208:211], v[84:87]
    s_waitcnt lgkmcnt(0)
    v_mfma_f32_16x16x32_bf16 v[16:19], v[124:127], v[132:135], v[16:19]
    ds_read_b128 v[168:171], v213 offset:0
    ds_read_b64_tr_b16 v[176:177], v214 offset:8192
    v_mfma_f32_16x16x32_bf16 v[20:23], v[128:131], v[132:135], v[20:23]
    ds_read_b64_tr_b16 v[178:179], v214 offset:10240
    ds_read_b128 v[172:175], v213 offset:2048
    v_mfma_f32_16x16x32_bf16 v[24:27], v[124:127], v[136:139], v[24:27]
    ds_read_b64_tr_b16 v[180:181], v215 offset:8192
    ds_read_b64_tr_b16 v[182:183], v215 offset:10240
    v_mfma_f32_16x16x32_bf16 v[28:31], v[128:131], v[136:139], v[28:31]
    ds_read_b64_tr_b16 v[184:185], v216 offset:8192
    ds_read_b64_tr_b16 v[186:187], v216 offset:10240
    v_mfma_f32_16x16x32_bf16 v[32:35], v[124:127], v[140:143], v[32:35]
    ds_read_b64_tr_b16 v[188:189], v217 offset:8192
    ds_read_b64_tr_b16 v[190:191], v217 offset:10240
    v_mfma_f32_16x16x32_bf16 v[36:39], v[128:131], v[140:143], v[36:39]
    ds_read_b64_tr_b16 v[192:193], v218 offset:8192
    ds_read_b64_tr_b16 v[194:195], v218 offset:10240
    v_mfma_f32_16x16x32_bf16 v[40:43], v[124:127], v[144:147], v[40:43]
    ds_read_b64_tr_b16 v[196:197], v219 offset:8192
    ds_read_b64_tr_b16 v[198:199], v219 offset:10240
    v_mfma_f32_16x16x32_bf16 v[44:47], v[128:131], v[144:147], v[44:47]
    ds_read_b64_tr_b16 v[200:201], v220 offset:8192
    ds_read_b64_tr_b16 v[202:203], v220 offset:10240
    v_mfma_f32_16x16x32_bf16 v[48:51], v[124:127], v[148:151], v[48:51]
    ds_read_b64_tr_b16 v[204:205], v221 offset:8192
    ds_read_b64_tr_b16 v[206:207], v221 offset:10240
    v_mfma_f32_16x16x32_bf16 v[52:55], v[128:131], v[148:151], v[52:55]
    ds_read_b64_tr_b16 v[208:209], v222 offset:1024
    ds_read_b64_tr_b16 v[210:211], v222 offset:1280
    v_mfma_f32_16x16x32_bf16 v[56:59], v[124:127], v[152:155], v[56:59]
    s_add_u32 s68, s68, 1
    s_and_b32 s68, s68, 3
    s_cselect_b32 s70, s69, -104448
    v_mfma_f32_16x16x32_bf16 v[60:63], v[128:131], v[152:155], v[60:63]
    v_add_u32 v212, s70, v212
    v_add_u32 v213, s70, v213
    v_mfma_f32_16x16x32_bf16 v[64:67], v[124:127], v[156:159], v[64:67]
    v_add_u32 v214, s70, v214
    v_add_u32 v215, s70, v215
    v_mfma_f32_16x16x32_bf16 v[68:71], v[128:131], v[156:159], v[68:71]
    v_add_u32 v216, s70, v216
    v_add_u32 v217, s70, v217
    v_mfma_f32_16x16x32_bf16 v[72:75], v[124:127], v[160:163], v[72:75]
    v_add_u32 v218, s70, v218
    v_add_u32 v219, s70, v219
    v_mfma_f32_16x16x32_bf16 v[76:79], v[128:131], v[160:163], v[76:79]
    v_add_u32 v220, s70, v220
    v_add_u32 v221, s70, v221
    v_mfma_f32_16x16x32_bf16 v[80:83], v[124:127], v[164:167], v[80:83]
    v_add_u32 v222, s70, v222
    v_mfma_f32_16x16x32_bf16 v[84:87], v[128:131], v[164:167], v[84:87]
    s_waitcnt lgkmcnt(0)
    s_barrier
    v_mfma_f32_16x16x32_bf16 v[16:19], v[168:171], v[176:179], v[16:19]
    ds_read_b128 v[124:127], v212 offset:0
    ds_read_b64_tr_b16 v[132:133], v214 offset:0
    v_mfma_f32_16x16x32_bf16 v[20:23], v[172:175], v[176:179], v[20:23]
    ds_read_b64_tr_b16 v[134:135], v214 offset:2048
    ds_read_b128 v[128:131], v212 offset:2048
    v_mfma_f32_16x16x32_bf16 v[24:27], v[168:171], v[180:183], v[24:27]
    ds_read_b64_tr_b16 v[136:137], v215 offset:0
    ds_read_b64_tr_b16 v[138:139], v215 offset:2048
    v_mfma_f32_16x16x32_bf16 v[28:31], v[172:175], v[180:183], v[28:31]
    ds_read_b64_tr_b16 v[140:141], v216 offset:0
    ds_read_b64_tr_b16 v[142:143], v216 offset:2048
    v_mfma_f32_16x16x32_bf16 v[32:35], v[168:171], v[184:187], v[32:35]
    ds_read_b64_tr_b16 v[144:145], v217 offset:0
    ds_read_b64_tr_b16 v[146:147], v217 offset:2048
    v_mfma_f32_16x16x32_bf16 v[36:39], v[172:175], v[184:187], v[36:39]
    ds_read_b64_tr_b16 v[148:149], v218 offset:0
    ds_read_b64_tr_b16 v[150:151], v218 offset:2048
    v_mfma_f32_16x16x32_bf16 v[40:43], v[168:171], v[188:191], v[40:43]
    ds_read_b64_tr_b16 v[152:153], v219 offset:0
    ds_read_b64_tr_b16 v[154:155], v219 offset:2048
    v_mfma_f32_16x16x32_bf16 v[44:47], v[172:175], v[188:191], v[44:47]
    ds_read_b64_tr_b16 v[156:157], v220 offset:0
    ds_read_b64_tr_b16 v[158:159], v220 offset:2048
    v_mfma_f32_16x16x32_bf16 v[48:51], v[168:171], v[192:195], v[48:51]
    ds_read_b64_tr_b16 v[160:161], v221 offset:0
    ds_read_b64_tr_b16 v[162:163], v221 offset:2048
    v_mfma_f32_16x16x32_bf16 v[52:55], v[172:175], v[192:195], v[52:55]
    ds_read_b64_tr_b16 v[164:165], v222 offset:0
    ds_read_b64_tr_b16 v[166:167], v222 offset:256
    v_mfma_f32_16x16x32_bf16 v[56:59], v[168:171], v[196:199], v[56:59]
    v_mfma_f32_16x16x32_bf16 v[60:63], v[172:175], v[196:199], v[60:63]
    v_mfma_f32_16x16x32_bf16 v[64:67], v[168:171], v[200:203], v[64:67]
    v_mfma_f32_16x16x32_bf16 v[68:71], v[172:175], v[200:203], v[68:71]
    v_mfma_f32_16x16x32_bf16 v[72:75], v[168:171], v[204:207], v[72:75]
    v_mfma_f32_16x16x32_bf16 v[76:79], v[172:175], v[204:207], v[76:79]
    v_mfma_f32_16x16x32_bf16 v[80:83], v[168:171], v[208:211], v[80:83]
    v_mfma_f32_16x16x32_bf16 v[84:87], v[172:175], v[208:211], v[84:87]
    s_sub_u32 s71, s71, 1
    s_cmp_lg_u32 s71, 0
    s_cbranch_scc1 gated_mix__ssm_conv_s4d__mixer_gmlp__prompt_kernel_g10
    v_lshlrev_b32 v1, 4, v0
    s_lshl_b32 s64, s25, 10
    v_add_u32 v1, s64, v1
    v_add_u32 v2, 159488, v1
    v_mov_b32 v224, 0
    v_mov_b32 v225, 0
    v_mov_b32 v226, 0
    v_mov_b32 v227, 0
    v_mov_b32 v228, 0
    v_mov_b32 v229, 0
    v_mov_b32 v230, 0
    v_mov_b32 v231, 0
    v_mov_b32 v232, 0
    v_mov_b32 v233, 0
    v_mov_b32 v234, 0
    v_mov_b32 v235, 0
    v_mov_b32 v236, 0
    v_mov_b32 v237, 0
    v_mov_b32 v238, 0
    v_mov_b32 v239, 0
    v_mov_b32 v4, 0xbdd2d3e8
    v_mov_b32 v5, 0xbdd2d3e8
    v_mov_b32 v6, 0xc0135761
    v_mov_b32 v7, 0xc0135761
    v_mov_b32 v8, 0x3f800000
    v_mov_b32 v9, 0x3f800000
    v_pk_mul_f32 v[168:169], v[16:17], v[16:17]
    v_pk_mul_f32 v[170:171], v[18:19], v[18:19]
    v_pk_mul_f32 v[172:173], v[20:21], v[20:21]
    v_pk_mul_f32 v[174:175], v[22:23], v[22:23]
    v_pk_fma_f32 v[168:169], v[168:169], v[4:5], v[6:7]
    v_pk_fma_f32 v[170:171], v[170:171], v[4:5], v[6:7]
    v_pk_fma_f32 v[172:173], v[172:173], v[4:5], v[6:7]
    v_pk_fma_f32 v[174:175], v[174:175], v[4:5], v[6:7]
    v_pk_mul_f32 v[168:169], v[16:17], v[168:169]
    v_pk_mul_f32 v[170:171], v[18:19], v[170:171]
    v_pk_mul_f32 v[172:173], v[20:21], v[172:173]
    v_pk_mul_f32 v[174:175], v[22:23], v[174:175]
    v_exp_f32 v168, v168
    v_exp_f32 v169, v169
    v_exp_f32 v170, v170
    v_exp_f32 v171, v171
    v_exp_f32 v172, v172
    v_exp_f32 v173, v173
    v_exp_f32 v174, v174
    v_exp_f32 v175, v175
    v_pk_add_f32 v[168:169], v[168:169], v[8:9]
    v_pk_add_f32 v[170:171], v[170:171], v[8:9]
    v_pk_add_f32 v[172:173], v[172:173], v[8:9]
    v_pk_add_f32 v[174:175], v[174:175], v[8:9]
    v_rcp_f32 v168, v168
    v_rcp_f32 v169, v169
    v_rcp_f32 v170, v170
    v_rcp_f32 v171, v171
    v_rcp_f32 v172, v172
    v_rcp_f32 v173, v173
    v_rcp_f32 v174, v174
    v_rcp_f32 v175, v175
    v_pk_mul_f32 v[16:17], v[16:17], v[168:169]
    v_pk_mul_f32 v[18:19], v[18:19], v[170:171]
    v_pk_mul_f32 v[20:21], v[20:21], v[172:173]
    v_pk_mul_f32 v[22:23], v[22:23], v[174:175]
    v_pk_add_f32 v[224:225], v[224:225], v[16:17]
    v_pk_add_f32 v[226:227], v[226:227], v[18:19]
    v_pk_add_f32 v[228:229], v[228:229], v[20:21]
    v_pk_add_f32 v[230:231], v[230:231], v[22:23]
    v_pk_fma_f32 v[232:233], v[16:17], v[16:17], v[232:233]
    v_pk_fma_f32 v[234:235], v[18:19], v[18:19], v[234:235]
    v_pk_fma_f32 v[236:237], v[20:21], v[20:21], v[236:237]
    v_pk_fma_f32 v[238:239], v[22:23], v[22:23], v[238:239]
    v_cvt_pk_bf16_f32 v16, v16, v17
    v_cvt_pk_bf16_f32 v17, v18, v19
    v_cvt_pk_bf16_f32 v18, v20, v21
    v_cvt_pk_bf16_f32 v19, v22, v23
    v_pk_mul_f32 v[168:169], v[24:25], v[24:25]
    v_pk_mul_f32 v[170:171], v[26:27], v[26:27]
    v_pk_mul_f32 v[172:173], v[28:29], v[28:29]
    v_pk_mul_f32 v[174:175], v[30:31], v[30:31]
    v_pk_fma_f32 v[168:169], v[168:169], v[4:5], v[6:7]
    v_pk_fma_f32 v[170:171], v[170:171], v[4:5], v[6:7]
    v_pk_fma_f32 v[172:173], v[172:173], v[4:5], v[6:7]
    v_pk_fma_f32 v[174:175], v[174:175], v[4:5], v[6:7]
    v_pk_mul_f32 v[168:169], v[24:25], v[168:169]
    v_pk_mul_f32 v[170:171], v[26:27], v[170:171]
    v_pk_mul_f32 v[172:173], v[28:29], v[172:173]
    v_pk_mul_f32 v[174:175], v[30:31], v[174:175]
    v_exp_f32 v168, v168
    v_exp_f32 v169, v169
    v_exp_f32 v170, v170
    v_exp_f32 v171, v171
    v_exp_f32 v172, v172
    v_exp_f32 v173, v173
    v_exp_f32 v174, v174
    v_exp_f32 v175, v175
    v_pk_add_f32 v[168:169], v[168:169], v[8:9]
    v_pk_add_f32 v[170:171], v[170:171], v[8:9]
    v_pk_add_f32 v[172:173], v[172:173], v[8:9]
    v_pk_add_f32 v[174:175], v[174:175], v[8:9]
    v_rcp_f32 v168, v168
    v_rcp_f32 v169, v169
    v_rcp_f32 v170, v170
    v_rcp_f32 v171, v171
    v_rcp_f32 v172, v172
    v_rcp_f32 v173, v173
    v_rcp_f32 v174, v174
    v_rcp_f32 v175, v175
    v_pk_mul_f32 v[24:25], v[24:25], v[168:169]
    v_pk_mul_f32 v[26:27], v[26:27], v[170:171]
    v_pk_mul_f32 v[28:29], v[28:29], v[172:173]
    v_pk_mul_f32 v[30:31], v[30:31], v[174:175]
    v_pk_add_f32 v[224:225], v[224:225], v[24:25]
    v_pk_add_f32 v[226:227], v[226:227], v[26:27]
    v_pk_add_f32 v[228:229], v[228:229], v[28:29]
    v_pk_add_f32 v[230:231], v[230:231], v[30:31]
    v_pk_fma_f32 v[232:233], v[24:25], v[24:25], v[232:233]
    v_pk_fma_f32 v[234:235], v[26:27], v[26:27], v[234:235]
    v_pk_fma_f32 v[236:237], v[28:29], v[28:29], v[236:237]
    v_pk_fma_f32 v[238:239], v[30:31], v[30:31], v[238:239]
    v_cvt_pk_bf16_f32 v20, v24, v25
    v_cvt_pk_bf16_f32 v21, v26, v27
    v_cvt_pk_bf16_f32 v22, v28, v29
    v_cvt_pk_bf16_f32 v23, v30, v31
    v_pk_mul_f32 v[168:169], v[32:33], v[32:33]
    v_pk_mul_f32 v[170:171], v[34:35], v[34:35]
    v_pk_mul_f32 v[172:173], v[36:37], v[36:37]
    v_pk_mul_f32 v[174:175], v[38:39], v[38:39]
    v_pk_fma_f32 v[168:169], v[168:169], v[4:5], v[6:7]
    v_pk_fma_f32 v[170:171], v[170:171], v[4:5], v[6:7]
    v_pk_fma_f32 v[172:173], v[172:173], v[4:5], v[6:7]
    v_pk_fma_f32 v[174:175], v[174:175], v[4:5], v[6:7]
    v_pk_mul_f32 v[168:169], v[32:33], v[168:169]
    v_pk_mul_f32 v[170:171], v[34:35], v[170:171]
    v_pk_mul_f32 v[172:173], v[36:37], v[172:173]
    v_pk_mul_f32 v[174:175], v[38:39], v[174:175]
    v_exp_f32 v168, v168
    v_exp_f32 v169, v169
    v_exp_f32 v170, v170
    v_exp_f32 v171, v171
    v_exp_f32 v172, v172
    v_exp_f32 v173, v173
    v_exp_f32 v174, v174
    v_exp_f32 v175, v175
    v_pk_add_f32 v[168:169], v[168:169], v[8:9]
    v_pk_add_f32 v[170:171], v[170:171], v[8:9]
    v_pk_add_f32 v[172:173], v[172:173], v[8:9]
    v_pk_add_f32 v[174:175], v[174:175], v[8:9]
    v_rcp_f32 v168, v168
    v_rcp_f32 v169, v169
    v_rcp_f32 v170, v170
    v_rcp_f32 v171, v171
    v_rcp_f32 v172, v172
    v_rcp_f32 v173, v173
    v_rcp_f32 v174, v174
    v_rcp_f32 v175, v175
    v_pk_mul_f32 v[32:33], v[32:33], v[168:169]
    v_pk_mul_f32 v[34:35], v[34:35], v[170:171]
    v_pk_mul_f32 v[36:37], v[36:37], v[172:173]
    v_pk_mul_f32 v[38:39], v[38:39], v[174:175]
    v_pk_add_f32 v[224:225], v[224:225], v[32:33]
    v_pk_add_f32 v[226:227], v[226:227], v[34:35]
    v_pk_add_f32 v[228:229], v[228:229], v[36:37]
    v_pk_add_f32 v[230:231], v[230:231], v[38:39]
    v_pk_fma_f32 v[232:233], v[32:33], v[32:33], v[232:233]
    v_pk_fma_f32 v[234:235], v[34:35], v[34:35], v[234:235]
    v_pk_fma_f32 v[236:237], v[36:37], v[36:37], v[236:237]
    v_pk_fma_f32 v[238:239], v[38:39], v[38:39], v[238:239]
    v_cvt_pk_bf16_f32 v24, v32, v33
    v_cvt_pk_bf16_f32 v25, v34, v35
    v_cvt_pk_bf16_f32 v26, v36, v37
    v_cvt_pk_bf16_f32 v27, v38, v39
    v_pk_mul_f32 v[168:169], v[40:41], v[40:41]
    v_pk_mul_f32 v[170:171], v[42:43], v[42:43]
    v_pk_mul_f32 v[172:173], v[44:45], v[44:45]
    v_pk_mul_f32 v[174:175], v[46:47], v[46:47]
    v_pk_fma_f32 v[168:169], v[168:169], v[4:5], v[6:7]
    v_pk_fma_f32 v[170:171], v[170:171], v[4:5], v[6:7]
    v_pk_fma_f32 v[172:173], v[172:173], v[4:5], v[6:7]
    v_pk_fma_f32 v[174:175], v[174:175], v[4:5], v[6:7]
    v_pk_mul_f32 v[168:169], v[40:41], v[168:169]
    v_pk_mul_f32 v[170:171], v[42:43], v[170:171]
    v_pk_mul_f32 v[172:173], v[44:45], v[172:173]
    v_pk_mul_f32 v[174:175], v[46:47], v[174:175]
    v_exp_f32 v168, v168
    v_exp_f32 v169, v169
    v_exp_f32 v170, v170
    v_exp_f32 v171, v171
    v_exp_f32 v172, v172
    v_exp_f32 v173, v173
    v_exp_f32 v174, v174
    v_exp_f32 v175, v175
    v_pk_add_f32 v[168:169], v[168:169], v[8:9]
    v_pk_add_f32 v[170:171], v[170:171], v[8:9]
    v_pk_add_f32 v[172:173], v[172:173], v[8:9]
    v_pk_add_f32 v[174:175], v[174:175], v[8:9]
    v_rcp_f32 v168, v168
    v_rcp_f32 v169, v169
    v_rcp_f32 v170, v170
    v_rcp_f32 v171, v171
    v_rcp_f32 v172, v172
    v_rcp_f32 v173, v173
    v_rcp_f32 v174, v174
    v_rcp_f32 v175, v175
    v_pk_mul_f32 v[40:41], v[40:41], v[168:169]
    v_pk_mul_f32 v[42:43], v[42:43], v[170:171]
    v_pk_mul_f32 v[44:45], v[44:45], v[172:173]
    v_pk_mul_f32 v[46:47], v[46:47], v[174:175]
    v_pk_add_f32 v[224:225], v[224:225], v[40:41]
    v_pk_add_f32 v[226:227], v[226:227], v[42:43]
    v_pk_add_f32 v[228:229], v[228:229], v[44:45]
    v_pk_add_f32 v[230:231], v[230:231], v[46:47]
    v_pk_fma_f32 v[232:233], v[40:41], v[40:41], v[232:233]
    v_pk_fma_f32 v[234:235], v[42:43], v[42:43], v[234:235]
    v_pk_fma_f32 v[236:237], v[44:45], v[44:45], v[236:237]
    v_pk_fma_f32 v[238:239], v[46:47], v[46:47], v[238:239]
    v_cvt_pk_bf16_f32 v28, v40, v41
    v_cvt_pk_bf16_f32 v29, v42, v43
    v_cvt_pk_bf16_f32 v30, v44, v45
    v_cvt_pk_bf16_f32 v31, v46, v47
    v_pk_mul_f32 v[168:169], v[48:49], v[48:49]
    v_pk_mul_f32 v[170:171], v[50:51], v[50:51]
    v_pk_mul_f32 v[172:173], v[52:53], v[52:53]
    v_pk_mul_f32 v[174:175], v[54:55], v[54:55]
    v_pk_fma_f32 v[168:169], v[168:169], v[4:5], v[6:7]
    v_pk_fma_f32 v[170:171], v[170:171], v[4:5], v[6:7]
    v_pk_fma_f32 v[172:173], v[172:173], v[4:5], v[6:7]
    v_pk_fma_f32 v[174:175], v[174:175], v[4:5], v[6:7]
    v_pk_mul_f32 v[168:169], v[48:49], v[168:169]
    v_pk_mul_f32 v[170:171], v[50:51], v[170:171]
    v_pk_mul_f32 v[172:173], v[52:53], v[172:173]
    v_pk_mul_f32 v[174:175], v[54:55], v[174:175]
    v_exp_f32 v168, v168
    v_exp_f32 v169, v169
    v_exp_f32 v170, v170
    v_exp_f32 v171, v171
    v_exp_f32 v172, v172
    v_exp_f32 v173, v173
    v_exp_f32 v174, v174
    v_exp_f32 v175, v175
    v_pk_add_f32 v[168:169], v[168:169], v[8:9]
    v_pk_add_f32 v[170:171], v[170:171], v[8:9]
    v_pk_add_f32 v[172:173], v[172:173], v[8:9]
    v_pk_add_f32 v[174:175], v[174:175], v[8:9]
    v_rcp_f32 v168, v168
    v_rcp_f32 v169, v169
    v_rcp_f32 v170, v170
    v_rcp_f32 v171, v171
    v_rcp_f32 v172, v172
    v_rcp_f32 v173, v173
    v_rcp_f32 v174, v174
    v_rcp_f32 v175, v175
    v_pk_mul_f32 v[48:49], v[48:49], v[168:169]
    v_pk_mul_f32 v[50:51], v[50:51], v[170:171]
    v_pk_mul_f32 v[52:53], v[52:53], v[172:173]
    v_pk_mul_f32 v[54:55], v[54:55], v[174:175]
    v_pk_add_f32 v[224:225], v[224:225], v[48:49]
    v_pk_add_f32 v[226:227], v[226:227], v[50:51]
    v_pk_add_f32 v[228:229], v[228:229], v[52:53]
    v_pk_add_f32 v[230:231], v[230:231], v[54:55]
    v_pk_fma_f32 v[232:233], v[48:49], v[48:49], v[232:233]
    v_pk_fma_f32 v[234:235], v[50:51], v[50:51], v[234:235]
    v_pk_fma_f32 v[236:237], v[52:53], v[52:53], v[236:237]
    v_pk_fma_f32 v[238:239], v[54:55], v[54:55], v[238:239]
    v_cvt_pk_bf16_f32 v32, v48, v49
    v_cvt_pk_bf16_f32 v33, v50, v51
    v_cvt_pk_bf16_f32 v34, v52, v53
    v_cvt_pk_bf16_f32 v35, v54, v55
    v_pk_mul_f32 v[168:169], v[56:57], v[56:57]
    v_pk_mul_f32 v[170:171], v[58:59], v[58:59]
    v_pk_mul_f32 v[172:173], v[60:61], v[60:61]
    v_pk_mul_f32 v[174:175], v[62:63], v[62:63]
    v_pk_fma_f32 v[168:169], v[168:169], v[4:5], v[6:7]
    v_pk_fma_f32 v[170:171], v[170:171], v[4:5], v[6:7]
    v_pk_fma_f32 v[172:173], v[172:173], v[4:5], v[6:7]
    v_pk_fma_f32 v[174:175], v[174:175], v[4:5], v[6:7]
    v_pk_mul_f32 v[168:169], v[56:57], v[168:169]
    v_pk_mul_f32 v[170:171], v[58:59], v[170:171]
    v_pk_mul_f32 v[172:173], v[60:61], v[172:173]
    v_pk_mul_f32 v[174:175], v[62:63], v[174:175]
    v_exp_f32 v168, v168
    v_exp_f32 v169, v169
    v_exp_f32 v170, v170
    v_exp_f32 v171, v171
    v_exp_f32 v172, v172
    v_exp_f32 v173, v173
    v_exp_f32 v174, v174
    v_exp_f32 v175, v175
    v_pk_add_f32 v[168:169], v[168:169], v[8:9]
    v_pk_add_f32 v[170:171], v[170:171], v[8:9]
    v_pk_add_f32 v[172:173], v[172:173], v[8:9]
    v_pk_add_f32 v[174:175], v[174:175], v[8:9]
    v_rcp_f32 v168, v168
    v_rcp_f32 v169, v169
    v_rcp_f32 v170, v170
    v_rcp_f32 v171, v171
    v_rcp_f32 v172, v172
    v_rcp_f32 v173, v173
    v_rcp_f32 v174, v174
    v_rcp_f32 v175, v175
    v_pk_mul_f32 v[56:57], v[56:57], v[168:169]
    v_pk_mul_f32 v[58:59], v[58:59], v[170:171]
    v_pk_mul_f32 v[60:61], v[60:61], v[172:173]
    v_pk_mul_f32 v[62:63], v[62:63], v[174:175]
    v_pk_add_f32 v[224:225], v[224:225], v[56:57]
    v_pk_add_f32 v[226:227], v[226:227], v[58:59]
    v_pk_add_f32 v[228:229], v[228:229], v[60:61]
    v_pk_add_f32 v[230:231], v[230:231], v[62:63]
    v_pk_fma_f32 v[232:233], v[56:57], v[56:57], v[232:233]
    v_pk_fma_f32 v[234:235], v[58:59], v[58:59], v[234:235]
    v_pk_fma_f32 v[236:237], v[60:61], v[60:61], v[236:237]
    v_pk_fma_f32 v[238:239], v[62:63], v[62:63], v[238:239]
    v_cvt_pk_bf16_f32 v36, v56, v57
    v_cvt_pk_bf16_f32 v37, v58, v59
    v_cvt_pk_bf16_f32 v38, v60, v61
    v_cvt_pk_bf16_f32 v39, v62, v63
    v_pk_mul_f32 v[168:169], v[64:65], v[64:65]
    v_pk_mul_f32 v[170:171], v[66:67], v[66:67]
    v_pk_mul_f32 v[172:173], v[68:69], v[68:69]
    v_pk_mul_f32 v[174:175], v[70:71], v[70:71]
    v_pk_fma_f32 v[168:169], v[168:169], v[4:5], v[6:7]
    v_pk_fma_f32 v[170:171], v[170:171], v[4:5], v[6:7]
    v_pk_fma_f32 v[172:173], v[172:173], v[4:5], v[6:7]
    v_pk_fma_f32 v[174:175], v[174:175], v[4:5], v[6:7]
    v_pk_mul_f32 v[168:169], v[64:65], v[168:169]
    v_pk_mul_f32 v[170:171], v[66:67], v[170:171]
    v_pk_mul_f32 v[172:173], v[68:69], v[172:173]
    v_pk_mul_f32 v[174:175], v[70:71], v[174:175]
    v_exp_f32 v168, v168
    v_exp_f32 v169, v169
    v_exp_f32 v170, v170
    v_exp_f32 v171, v171
    v_exp_f32 v172, v172
    v_exp_f32 v173, v173
    v_exp_f32 v174, v174
    v_exp_f32 v175, v175
    v_pk_add_f32 v[168:169], v[168:169], v[8:9]
    v_pk_add_f32 v[170:171], v[170:171], v[8:9]
    v_pk_add_f32 v[172:173], v[172:173], v[8:9]
    v_pk_add_f32 v[174:175], v[174:175], v[8:9]
    v_rcp_f32 v168, v168
    v_rcp_f32 v169, v169
    v_rcp_f32 v170, v170
    v_rcp_f32 v171, v171
    v_rcp_f32 v172, v172
    v_rcp_f32 v173, v173
    v_rcp_f32 v174, v174
    v_rcp_f32 v175, v175
    v_pk_mul_f32 v[64:65], v[64:65], v[168:169]
    v_pk_mul_f32 v[66:67], v[66:67], v[170:171]
    v_pk_mul_f32 v[68:69], v[68:69], v[172:173]
    v_pk_mul_f32 v[70:71], v[70:71], v[174:175]
    v_pk_add_f32 v[224:225], v[224:225], v[64:65]
    v_pk_add_f32 v[226:227], v[226:227], v[66:67]
    v_pk_add_f32 v[228:229], v[228:229], v[68:69]
    v_pk_add_f32 v[230:231], v[230:231], v[70:71]
    v_pk_fma_f32 v[232:233], v[64:65], v[64:65], v[232:233]
    v_pk_fma_f32 v[234:235], v[66:67], v[66:67], v[234:235]
    v_pk_fma_f32 v[236:237], v[68:69], v[68:69], v[236:237]
    v_pk_fma_f32 v[238:239], v[70:71], v[70:71], v[238:239]
    v_cvt_pk_bf16_f32 v40, v64, v65
    v_cvt_pk_bf16_f32 v41, v66, v67
    v_cvt_pk_bf16_f32 v42, v68, v69
    v_cvt_pk_bf16_f32 v43, v70, v71
    v_pk_mul_f32 v[168:169], v[72:73], v[72:73]
    v_pk_mul_f32 v[170:171], v[74:75], v[74:75]
    v_pk_mul_f32 v[172:173], v[76:77], v[76:77]
    v_pk_mul_f32 v[174:175], v[78:79], v[78:79]
    v_pk_fma_f32 v[168:169], v[168:169], v[4:5], v[6:7]
    v_pk_fma_f32 v[170:171], v[170:171], v[4:5], v[6:7]
    v_pk_fma_f32 v[172:173], v[172:173], v[4:5], v[6:7]
    v_pk_fma_f32 v[174:175], v[174:175], v[4:5], v[6:7]
    v_pk_mul_f32 v[168:169], v[72:73], v[168:169]
    v_pk_mul_f32 v[170:171], v[74:75], v[170:171]
    v_pk_mul_f32 v[172:173], v[76:77], v[172:173]
    v_pk_mul_f32 v[174:175], v[78:79], v[174:175]
    v_exp_f32 v168, v168
    v_exp_f32 v169, v169
    v_exp_f32 v170, v170
    v_exp_f32 v171, v171
    v_exp_f32 v172, v172
    v_exp_f32 v173, v173
    v_exp_f32 v174, v174
    v_exp_f32 v175, v175
    v_pk_add_f32 v[168:169], v[168:169], v[8:9]
    v_pk_add_f32 v[170:171], v[170:171], v[8:9]
    v_pk_add_f32 v[172:173], v[172:173], v[8:9]
    v_pk_add_f32 v[174:175], v[174:175], v[8:9]
    v_rcp_f32 v168, v168
    v_rcp_f32 v169, v169
    v_rcp_f32 v170, v170
    v_rcp_f32 v171, v171
    v_rcp_f32 v172, v172
    v_rcp_f32 v173, v173
    v_rcp_f32 v174, v174
    v_rcp_f32 v175, v175
    v_pk_mul_f32 v[72:73], v[72:73], v[168:169]
    v_pk_mul_f32 v[74:75], v[74:75], v[170:171]
    v_pk_mul_f32 v[76:77], v[76:77], v[172:173]
    v_pk_mul_f32 v[78:79], v[78:79], v[174:175]
    v_pk_add_f32 v[224:225], v[224:225], v[72:73]
    v_pk_add_f32 v[226:227], v[226:227], v[74:75]
    v_pk_add_f32 v[228:229], v[228:229], v[76:77]
    v_pk_add_f32 v[230:231], v[230:231], v[78:79]
    v_pk_fma_f32 v[232:233], v[72:73], v[72:73], v[232:233]
    v_pk_fma_f32 v[234:235], v[74:75], v[74:75], v[234:235]
    v_pk_fma_f32 v[236:237], v[76:77], v[76:77], v[236:237]
    v_pk_fma_f32 v[238:239], v[78:79], v[78:79], v[238:239]
    v_cvt_pk_bf16_f32 v44, v72, v73
    v_cvt_pk_bf16_f32 v45, v74, v75
    v_cvt_pk_bf16_f32 v46, v76, v77
    v_cvt_pk_bf16_f32 v47, v78, v79
    v_pk_mul_f32 v[168:169], v[80:81], v[80:81]
    v_pk_mul_f32 v[170:171], v[82:83], v[82:83]
    v_pk_mul_f32 v[172:173], v[84:85], v[84:85]
    v_pk_mul_f32 v[174:175], v[86:87], v[86:87]
    v_pk_fma_f32 v[168:169], v[168:169], v[4:5], v[6:7]
    v_pk_fma_f32 v[170:171], v[170:171], v[4:5], v[6:7]
    v_pk_fma_f32 v[172:173], v[172:173], v[4:5], v[6:7]
    v_pk_fma_f32 v[174:175], v[174:175], v[4:5], v[6:7]
    v_pk_mul_f32 v[168:169], v[80:81], v[168:169]
    v_pk_mul_f32 v[170:171], v[82:83], v[170:171]
    v_pk_mul_f32 v[172:173], v[84:85], v[172:173]
    v_pk_mul_f32 v[174:175], v[86:87], v[174:175]
    v_exp_f32 v168, v168
    v_exp_f32 v169, v169
    v_exp_f32 v170, v170
    v_exp_f32 v171, v171
    v_exp_f32 v172, v172
    v_exp_f32 v173, v173
    v_exp_f32 v174, v174
    v_exp_f32 v175, v175
    v_pk_add_f32 v[168:169], v[168:169], v[8:9]
    v_pk_add_f32 v[170:171], v[170:171], v[8:9]
    v_pk_add_f32 v[172:173], v[172:173], v[8:9]
    v_pk_add_f32 v[174:175], v[174:175], v[8:9]
    v_rcp_f32 v168, v168
    v_rcp_f32 v169, v169
    v_rcp_f32 v170, v170
    v_rcp_f32 v171, v171
    v_rcp_f32 v172, v172
    v_rcp_f32 v173, v173
    v_rcp_f32 v174, v174
    v_rcp_f32 v175, v175
    v_pk_mul_f32 v[80:81], v[80:81], v[168:169]
    v_pk_mul_f32 v[82:83], v[82:83], v[170:171]
    v_pk_mul_f32 v[84:85], v[84:85], v[172:173]
    v_pk_mul_f32 v[86:87], v[86:87], v[174:175]
    v_pk_add_f32 v[224:225], v[224:225], v[80:81]
    v_pk_add_f32 v[226:227], v[226:227], v[82:83]
    v_pk_add_f32 v[228:229], v[228:229], v[84:85]
    v_pk_add_f32 v[230:231], v[230:231], v[86:87]
    v_pk_fma_f32 v[232:233], v[80:81], v[80:81], v[232:233]
    v_pk_fma_f32 v[234:235], v[82:83], v[82:83], v[234:235]
    v_pk_fma_f32 v[236:237], v[84:85], v[84:85], v[236:237]
    v_pk_fma_f32 v[238:239], v[86:87], v[86:87], v[238:239]
    v_cvt_pk_bf16_f32 v48, v80, v81
    v_cvt_pk_bf16_f32 v49, v82, v83
    v_cvt_pk_bf16_f32 v50, v84, v85
    v_cvt_pk_bf16_f32 v51, v86, v87
    v_add_f32_dpp v224, v224, v224 row_ror:8 row_mask:0xf bank_mask:0xf
    v_add_f32_dpp v225, v225, v225 row_ror:8 row_mask:0xf bank_mask:0xf
    v_add_f32_dpp v226, v226, v226 row_ror:8 row_mask:0xf bank_mask:0xf
    v_add_f32_dpp v227, v227, v227 row_ror:8 row_mask:0xf bank_mask:0xf
    v_add_f32_dpp v228, v228, v228 row_ror:8 row_mask:0xf bank_mask:0xf
    v_add_f32_dpp v229, v229, v229 row_ror:8 row_mask:0xf bank_mask:0xf
    v_add_f32_dpp v230, v230, v230 row_ror:8 row_mask:0xf bank_mask:0xf
    v_add_f32_dpp v231, v231, v231 row_ror:8 row_mask:0xf bank_mask:0xf
    v_add_f32_dpp v232, v232, v232 row_ror:8 row_mask:0xf bank_mask:0xf
    v_add_f32_dpp v233, v233, v233 row_ror:8 row_mask:0xf bank_mask:0xf
    v_add_f32_dpp v234, v234, v234 row_ror:8 row_mask:0xf bank_mask:0xf
    v_add_f32_dpp v235, v235, v235 row_ror:8 row_mask:0xf bank_mask:0xf
    v_add_f32_dpp v236, v236, v236 row_ror:8 row_mask:0xf bank_mask:0xf
    v_add_f32_dpp v237, v237, v237 row_ror:8 row_mask:0xf bank_mask:0xf
    v_add_f32_dpp v238, v238, v238 row_ror:8 row_mask:0xf bank_mask:0xf
    v_add_f32_dpp v239, v239, v239 row_ror:8 row_mask:0xf bank_mask:0xf
    v_add_f32_dpp v224, v224, v224 row_ror:4 row_mask:0xf bank_mask:0xf
    v_add_f32_dpp v225, v225, v225 row_ror:4 row_mask:0xf bank_mask:0xf
    v_add_f32_dpp v226, v226, v226 row_ror:4 row_mask:0xf bank_mask:0xf
    v_add_f32_dpp v227, v227, v227 row_ror:4 row_mask:0xf bank_mask:0xf
    v_add_f32_dpp v228, v228, v228 row_ror:4 row_mask:0xf bank_mask:0xf
    v_add_f32_dpp v229, v229, v229 row_ror:4 row_mask:0xf bank_mask:0xf
    v_add_f32_dpp v230, v230, v230 row_ror:4 row_mask:0xf bank_mask:0xf
    v_add_f32_dpp v231, v231, v231 row_ror:4 row_mask:0xf bank_mask:0xf
    v_add_f32_dpp v232, v232, v232 row_ror:4 row_mask:0xf bank_mask:0xf
    v_add_f32_dpp v233, v233, v233 row_ror:4 row_mask:0xf bank_mask:0xf
    v_add_f32_dpp v234, v234, v234 row_ror:4 row_mask:0xf bank_mask:0xf
    v_add_f32_dpp v235, v235, v235 row_ror:4 row_mask:0xf bank_mask:0xf
    v_add_f32_dpp v236, v236, v236 row_ror:4 row_mask:0xf bank_mask:0xf
    v_add_f32_dpp v237, v237, v237 row_ror:4 row_mask:0xf bank_mask:0xf
    v_add_f32_dpp v238, v238, v238 row_ror:4 row_mask:0xf bank_mask:0xf
    v_add_f32_dpp v239, v239, v239 row_ror:4 row_mask:0xf bank_mask:0xf
    v_add_f32_dpp v224, v224, v224 row_ror:2 row_mask:0xf bank_mask:0xf
    v_add_f32_dpp v225, v225, v225 row_ror:2 row_mask:0xf bank_mask:0xf
    v_add_f32_dpp v226, v226, v226 row_ror:2 row_mask:0xf bank_mask:0xf
    v_add_f32_dpp v227, v227, v227 row_ror:2 row_mask:0xf bank_mask:0xf
    v_add_f32_dpp v228, v228, v228 row_ror:2 row_mask:0xf bank_mask:0xf
    v_add_f32_dpp v229, v229, v229 row_ror:2 row_mask:0xf bank_mask:0xf
    v_add_f32_dpp v230, v230, v230 row_ror:2 row_mask:0xf bank_mask:0xf
    v_add_f32_dpp v231, v231, v231 row_ror:2 row_mask:0xf bank_mask:0xf
    v_add_f32_dpp v232, v232, v232 row_ror:2 row_mask:0xf bank_mask:0xf
    v_add_f32_dpp v233, v233, v233 row_ror:2 row_mask:0xf bank_mask:0xf
    v_add_f32_dpp v234, v234, v234 row_ror:2 row_mask:0xf bank_mask:0xf
    v_add_f32_dpp v235, v235, v235 row_ror:2 row_mask:0xf bank_mask:0xf
    v_add_f32_dpp v236, v236, v236 row_ror:2 row_mask:0xf bank_mask:0xf
    v_add_f32_dpp v237, v237, v237 row_ror:2 row_mask:0xf bank_mask:0xf
    v_add_f32_dpp v238, v238, v238 row_ror:2 row_mask:0xf bank_mask:0xf
    v_add_f32_dpp v239, v239, v239 row_ror:2 row_mask:0xf bank_mask:0xf
    v_add_f32_dpp v168, v224, v224 row_ror:1 row_mask:0xf bank_mask:0xf
    v_add_f32_dpp v170, v225, v225 row_ror:1 row_mask:0xf bank_mask:0xf
    v_add_f32_dpp v172, v226, v226 row_ror:1 row_mask:0xf bank_mask:0xf
    v_add_f32_dpp v174, v227, v227 row_ror:1 row_mask:0xf bank_mask:0xf
    v_add_f32_dpp v176, v228, v228 row_ror:1 row_mask:0xf bank_mask:0xf
    v_add_f32_dpp v178, v229, v229 row_ror:1 row_mask:0xf bank_mask:0xf
    v_add_f32_dpp v180, v230, v230 row_ror:1 row_mask:0xf bank_mask:0xf
    v_add_f32_dpp v182, v231, v231 row_ror:1 row_mask:0xf bank_mask:0xf
    v_add_f32_dpp v169, v232, v232 row_ror:1 row_mask:0xf bank_mask:0xf
    v_add_f32_dpp v171, v233, v233 row_ror:1 row_mask:0xf bank_mask:0xf
    v_add_f32_dpp v173, v234, v234 row_ror:1 row_mask:0xf bank_mask:0xf
    v_add_f32_dpp v175, v235, v235 row_ror:1 row_mask:0xf bank_mask:0xf
    v_add_f32_dpp v177, v236, v236 row_ror:1 row_mask:0xf bank_mask:0xf
    v_add_f32_dpp v179, v237, v237 row_ror:1 row_mask:0xf bank_mask:0xf
    v_add_f32_dpp v181, v238, v238 row_ror:1 row_mask:0xf bank_mask:0xf
    v_add_f32_dpp v183, v239, v239 row_ror:1 row_mask:0xf bank_mask:0xf
    s_lshl_b32 s64, s3, 10
    s_add_u32 s64, s64, 34603008
    s_add_u32 s4, s62, s64
    s_addc_u32 s5, s63, 0
    s_mov_b32 s6, 1024
    s_mov_b32 s7, 0x20000
    v_lshrrev_b32 v6, 4, v0
    v_lshlrev_b32 v6, 6, v6
    s_lshl_b32 s65, s25, 8
    v_add_u32 v6, s65, v6
    v_and_b32 v7, 3, v0
    v_lshl_add_u32 v6, v7, 4, v6
    s_mov_b32 exec_lo, 0x20002
    s_mov_b32 exec_hi, 0x20002
    v_mov_b32 v168, v172
    v_mov_b32 v169, v173
    v_mov_b32 v170, v174
    v_mov_b32 v171, v175
    s_mov_b32 exec_lo, 0x40004
    s_mov_b32 exec_hi, 0x40004
    v_mov_b32 v168, v176
    v_mov_b32 v169, v177
    v_mov_b32 v170, v178
    v_mov_b32 v171, v179
    s_mov_b32 exec_lo, 0x80008
    s_mov_b32 exec_hi, 0x80008
    v_mov_b32 v168, v180
    v_mov_b32 v169, v181
    v_mov_b32 v170, v182
    v_mov_b32 v171, v183
    s_mov_b32 exec_lo, 983055
    s_mov_b32 exec_hi, 983055
    buffer_store_dwordx4 v[168:171], v6, s[4:7], 0 offen sc1
    s_mov_b64 exec, -1
    v_and_b32 v5, 15, v0
    v_lshrrev_b32 v8, 2, v5
    v_lshlrev_b32 v8, 3, v8
    v_and_b32 v9, 3, v5
    v_add_u32 v8, v8, v9
    s_lshl_b32 s64, s25, 5
    v_add_u32 v8, s64, v8
    v_lshlrev_b32 v11, 1, v8
    s_lshl_b32 s64, s27, 8
    s_add_u32 s4, s52, s64
    s_addc_u32 s5, s53, 0
    s_mov_b32 s6, 256
    s_mov_b32 s7, 0x20000
    buffer_load_ushort v12, v11, s[4:7], 0 offen
    buffer_load_ushort v13, v11, s[4:7], 0 offen offset:8
    s_lshl_b32 s65, s30, 1
    v_mov_b32 v3, s65
    s_mov_b32 s4, s44
    s_mov_b32 s5, s45
    s_mov_b32 s6, 1152
    s_mov_b32 s7, 0x20000
    buffer_load_ushort v11, v3, s[4:7], 0 offen
    s_sub_u32 s67, s30, 416
    s_min_u32 s67, s67, 575
    s_cmp_lt_u32 s26, 9
    s_cselect_b32 s67, s30, s67
    s_lshl_b32 s64, s67, 8
    v_lshlrev_b32 v224, 2, v0
    s_lshl_b32 s65, s67, 1
    v_mov_b32 v225, s65
    s_mov_b32 s4, s34
    s_mov_b32 s5, s35
    s_mov_b32 s6, 147456
    s_mov_b32 s7, 0x20000
    buffer_load_dword v226, v224, s[4:7], s64 offen
    s_mov_b32 s4, s36
    s_mov_b32 s5, s37
    s_mov_b32 s6, 147456
    s_mov_b32 s7, 0x20000
    buffer_load_dword v227, v224, s[4:7], s64 offen
    s_mov_b32 s4, s38
    s_mov_b32 s5, s39
    s_mov_b32 s6, 147456
    s_mov_b32 s7, 0x20000
    buffer_load_dword v228, v224, s[4:7], s64 offen
    s_mov_b32 s4, s40
    s_mov_b32 s5, s41
    s_mov_b32 s6, 147456
    s_mov_b32 s7, 0x20000
    buffer_load_dword v229, v224, s[4:7], s64 offen
    s_mov_b32 s4, s42
    s_mov_b32 s5, s43
    s_mov_b32 s6, 1152
    s_mov_b32 s7, 0x20000
    buffer_load_ushort v230, v225, s[4:7], 0 offen
    v_mov_b32 v52, 0
    v_mov_b32 v53, 0
    v_mov_b32 v54, 0
    v_mov_b32 v55, 0
    v_mov_b32 v56, 0
    v_mov_b32 v57, 0
    v_mov_b32 v58, 0
    v_mov_b32 v59, 0
    v_mov_b32 v60, 0
    v_mov_b32 v61, 0
    v_mov_b32 v62, 0
    v_mov_b32 v63, 0
    v_mov_b32 v64, 0
    v_mov_b32 v65, 0
    v_mov_b32 v66, 0
    v_mov_b32 v67, 0
    v_mov_b32 v68, 0
    v_mov_b32 v69, 0
    v_mov_b32 v70, 0
    v_mov_b32 v71, 0
    v_mov_b32 v72, 0
    v_mov_b32 v73, 0
    v_mov_b32 v74, 0
    v_mov_b32 v75, 0
    v_mov_b32 v76, 0
    v_mov_b32 v77, 0
    v_mov_b32 v78, 0
    v_mov_b32 v79, 0
    v_mov_b32 v80, 0
    v_mov_b32 v81, 0
    v_mov_b32 v82, 0
    v_mov_b32 v83, 0
    v_mov_b32 v84, 0
    v_mov_b32 v85, 0
    v_mov_b32 v86, 0
    v_mov_b32 v87, 0
    v_mov_b32 v88, 0
    v_mov_b32 v89, 0
    v_mov_b32 v90, 0
    v_mov_b32 v91, 0
    v_mov_b32 v92, 0
    v_mov_b32 v93, 0
    v_mov_b32 v94, 0
    v_mov_b32 v95, 0
    v_mov_b32 v96, 0
    v_mov_b32 v97, 0
    v_mov_b32 v98, 0
    v_mov_b32 v99, 0
    v_mov_b32 v100, 0
    v_mov_b32 v101, 0
    v_mov_b32 v102, 0
    v_mov_b32 v103, 0
    v_mov_b32 v104, 0
    v_mov_b32 v105, 0
    v_mov_b32 v106, 0
    v_mov_b32 v107, 0
    v_mov_b32 v108, 0
    v_mov_b32 v109, 0
    v_mov_b32 v110, 0
    v_mov_b32 v111, 0
    v_mov_b32 v112, 0
    v_mov_b32 v113, 0
    v_mov_b32 v114, 0
    v_mov_b32 v115, 0
    v_mov_b32 v116, 0
    v_mov_b32 v117, 0
    v_mov_b32 v118, 0
    v_mov_b32 v119, 0
    v_mov_b32 v120, 0
    v_mov_b32 v121, 0
    v_mov_b32 v122, 0
    v_mov_b32 v123, 0
    s_mov_b32 s71, 2
.p2align 6
gated_mix__ssm_conv_s4d__mixer_gmlp__prompt_kernel_g11:
    s_waitcnt lgkmcnt(0)
    v_mfma_f32_16x16x32_bf16 v[52:55], v[132:135], v[124:127], v[52:55]
    ds_read_b128 v[168:171], v213 offset:0
    ds_read_b64_tr_b16 v[176:177], v214 offset:8192
    v_mfma_f32_16x16x32_bf16 v[56:59], v[132:135], v[128:131], v[56:59]
    ds_read_b64_tr_b16 v[178:179], v214 offset:10240
    ds_read_b128 v[172:175], v213 offset:2048
    v_mfma_f32_16x16x32_bf16 v[60:63], v[136:139], v[124:127], v[60:63]
    ds_read_b64_tr_b16 v[180:181], v215 offset:8192
    ds_read_b64_tr_b16 v[182:183], v215 offset:10240
    v_mfma_f32_16x16x32_bf16 v[64:67], v[136:139], v[128:131], v[64:67]
    ds_read_b64_tr_b16 v[184:185], v216 offset:8192
    ds_read_b64_tr_b16 v[186:187], v216 offset:10240
    v_mfma_f32_16x16x32_bf16 v[68:71], v[140:143], v[124:127], v[68:71]
    ds_read_b64_tr_b16 v[188:189], v217 offset:8192
    ds_read_b64_tr_b16 v[190:191], v217 offset:10240
    v_mfma_f32_16x16x32_bf16 v[72:75], v[140:143], v[128:131], v[72:75]
    ds_read_b64_tr_b16 v[192:193], v218 offset:8192
    ds_read_b64_tr_b16 v[194:195], v218 offset:10240
    v_mfma_f32_16x16x32_bf16 v[76:79], v[144:147], v[124:127], v[76:79]
    ds_read_b64_tr_b16 v[196:197], v219 offset:8192
    ds_read_b64_tr_b16 v[198:199], v219 offset:10240
    v_mfma_f32_16x16x32_bf16 v[80:83], v[144:147], v[128:131], v[80:83]
    ds_read_b64_tr_b16 v[200:201], v220 offset:8192
    ds_read_b64_tr_b16 v[202:203], v220 offset:10240
    v_mfma_f32_16x16x32_bf16 v[84:87], v[148:151], v[124:127], v[84:87]
    ds_read_b64_tr_b16 v[204:205], v221 offset:8192
    ds_read_b64_tr_b16 v[206:207], v221 offset:10240
    v_mfma_f32_16x16x32_bf16 v[88:91], v[148:151], v[128:131], v[88:91]
    ds_read_b64_tr_b16 v[208:209], v222 offset:1024
    ds_read_b64_tr_b16 v[210:211], v222 offset:1280
    v_mfma_f32_16x16x32_bf16 v[92:95], v[152:155], v[124:127], v[92:95]
    s_add_u32 s68, s68, 1
    s_and_b32 s68, s68, 3
    s_cselect_b32 s70, s69, -104448
    v_mfma_f32_16x16x32_bf16 v[96:99], v[152:155], v[128:131], v[96:99]
    v_add_u32 v212, s70, v212
    v_add_u32 v213, s70, v213
    v_mfma_f32_16x16x32_bf16 v[100:103], v[156:159], v[124:127], v[100:103]
    v_add_u32 v214, s70, v214
    v_add_u32 v215, s70, v215
    v_mfma_f32_16x16x32_bf16 v[104:107], v[156:159], v[128:131], v[104:107]
    v_add_u32 v216, s70, v216
    v_add_u32 v217, s70, v217
    v_mfma_f32_16x16x32_bf16 v[108:111], v[160:163], v[124:127], v[108:111]
    v_add_u32 v218, s70, v218
    v_add_u32 v219, s70, v219
    v_mfma_f32_16x16x32_bf16 v[112:115], v[160:163], v[128:131], v[112:115]
    v_add_u32 v220, s70, v220
    v_add_u32 v221, s70, v221
    v_mfma_f32_16x16x32_bf16 v[116:119], v[164:167], v[124:127], v[116:119]
    v_add_u32 v222, s70, v222
    v_mfma_f32_16x16x32_bf16 v[120:123], v[164:167], v[128:131], v[120:123]
    s_waitcnt lgkmcnt(0)
    s_barrier
    v_mfma_f32_16x16x32_bf16 v[52:55], v[176:179], v[168:171], v[52:55]
    ds_read_b128 v[124:127], v212 offset:0
    ds_read_b64_tr_b16 v[132:133], v214 offset:0
    v_mfma_f32_16x16x32_bf16 v[56:59], v[176:179], v[172:175], v[56:59]
    ds_read_b64_tr_b16 v[134:135], v214 offset:2048
    ds_read_b128 v[128:131], v212 offset:2048
    v_mfma_f32_16x16x32_bf16 v[60:63], v[180:183], v[168:171], v[60:63]
    ds_read_b64_tr_b16 v[136:137], v215 offset:0
    ds_read_b64_tr_b16 v[138:139], v215 offset:2048
    v_mfma_f32_16x16x32_bf16 v[64:67], v[180:183], v[172:175], v[64:67]
    ds_read_b64_tr_b16 v[140:141], v216 offset:0
    ds_read_b64_tr_b16 v[142:143], v216 offset:2048
    v_mfma_f32_16x16x32_bf16 v[68:71], v[184:187], v[168:171], v[68:71]
    ds_read_b64_tr_b16 v[144:145], v217 offset:0
    ds_read_b64_tr_b16 v[146:147], v217 offset:2048
    v_mfma_f32_16x16x32_bf16 v[72:75], v[184:187], v[172:175], v[72:75]
    ds_read_b64_tr_b16 v[148:149], v218 offset:0
    ds_read_b64_tr_b16 v[150:151], v218 offset:2048
    v_mfma_f32_16x16x32_bf16 v[76:79], v[188:191], v[168:171], v[76:79]
    ds_read_b64_tr_b16 v[152:153], v219 offset:0
    ds_read_b64_tr_b16 v[154:155], v219 offset:2048
    v_mfma_f32_16x16x32_bf16 v[80:83], v[188:191], v[172:175], v[80:83]
    ds_read_b64_tr_b16 v[156:157], v220 offset:0
    ds_read_b64_tr_b16 v[158:159], v220 offset:2048
    v_mfma_f32_16x16x32_bf16 v[84:87], v[192:195], v[168:171], v[84:87]
    ds_read_b64_tr_b16 v[160:161], v221 offset:0
    ds_read_b64_tr_b16 v[162:163], v221 offset:2048
    v_mfma_f32_16x16x32_bf16 v[88:91], v[192:195], v[172:175], v[88:91]
    ds_read_b64_tr_b16 v[164:165], v222 offset:0
    ds_read_b64_tr_b16 v[166:167], v222 offset:256
    v_mfma_f32_16x16x32_bf16 v[92:95], v[196:199], v[168:171], v[92:95]
    v_mfma_f32_16x16x32_bf16 v[96:99], v[196:199], v[172:175], v[96:99]
    v_mfma_f32_16x16x32_bf16 v[100:103], v[200:203], v[168:171], v[100:103]
    v_mfma_f32_16x16x32_bf16 v[104:107], v[200:203], v[172:175], v[104:107]
    v_mfma_f32_16x16x32_bf16 v[108:111], v[204:207], v[168:171], v[108:111]
    v_mfma_f32_16x16x32_bf16 v[112:115], v[204:207], v[172:175], v[112:115]
    v_mfma_f32_16x16x32_bf16 v[116:119], v[208:211], v[168:171], v[116:119]
    v_mfma_f32_16x16x32_bf16 v[120:123], v[208:211], v[172:175], v[120:123]
    s_waitcnt lgkmcnt(0)
    v_mfma_f32_16x16x32_bf16 v[52:55], v[132:135], v[124:127], v[52:55]
    ds_read_b128 v[168:171], v213 offset:0
    ds_read_b64_tr_b16 v[176:177], v214 offset:8192
    v_mfma_f32_16x16x32_bf16 v[56:59], v[132:135], v[128:131], v[56:59]
    ds_read_b64_tr_b16 v[178:179], v214 offset:10240
    ds_read_b128 v[172:175], v213 offset:2048
    v_mfma_f32_16x16x32_bf16 v[60:63], v[136:139], v[124:127], v[60:63]
    ds_read_b64_tr_b16 v[180:181], v215 offset:8192
    ds_read_b64_tr_b16 v[182:183], v215 offset:10240
    v_mfma_f32_16x16x32_bf16 v[64:67], v[136:139], v[128:131], v[64:67]
    ds_read_b64_tr_b16 v[184:185], v216 offset:8192
    ds_read_b64_tr_b16 v[186:187], v216 offset:10240
    v_mfma_f32_16x16x32_bf16 v[68:71], v[140:143], v[124:127], v[68:71]
    ds_read_b64_tr_b16 v[188:189], v217 offset:8192
    ds_read_b64_tr_b16 v[190:191], v217 offset:10240
    v_mfma_f32_16x16x32_bf16 v[72:75], v[140:143], v[128:131], v[72:75]
    ds_read_b64_tr_b16 v[192:193], v218 offset:8192
    ds_read_b64_tr_b16 v[194:195], v218 offset:10240
    v_mfma_f32_16x16x32_bf16 v[76:79], v[144:147], v[124:127], v[76:79]
    ds_read_b64_tr_b16 v[196:197], v219 offset:8192
    ds_read_b64_tr_b16 v[198:199], v219 offset:10240
    v_mfma_f32_16x16x32_bf16 v[80:83], v[144:147], v[128:131], v[80:83]
    ds_read_b64_tr_b16 v[200:201], v220 offset:8192
    ds_read_b64_tr_b16 v[202:203], v220 offset:10240
    v_mfma_f32_16x16x32_bf16 v[84:87], v[148:151], v[124:127], v[84:87]
    ds_read_b64_tr_b16 v[204:205], v221 offset:8192
    ds_read_b64_tr_b16 v[206:207], v221 offset:10240
    v_mfma_f32_16x16x32_bf16 v[88:91], v[148:151], v[128:131], v[88:91]
    ds_read_b64_tr_b16 v[208:209], v222 offset:1024
    ds_read_b64_tr_b16 v[210:211], v222 offset:1280
    v_mfma_f32_16x16x32_bf16 v[92:95], v[152:155], v[124:127], v[92:95]
    s_add_u32 s68, s68, 1
    s_and_b32 s68, s68, 3
    s_cselect_b32 s70, s69, -104448
    v_mfma_f32_16x16x32_bf16 v[96:99], v[152:155], v[128:131], v[96:99]
    v_add_u32 v212, s70, v212
    v_add_u32 v213, s70, v213
    v_mfma_f32_16x16x32_bf16 v[100:103], v[156:159], v[124:127], v[100:103]
    v_add_u32 v214, s70, v214
    v_add_u32 v215, s70, v215
    v_mfma_f32_16x16x32_bf16 v[104:107], v[156:159], v[128:131], v[104:107]
    v_add_u32 v216, s70, v216
    v_add_u32 v217, s70, v217
    v_mfma_f32_16x16x32_bf16 v[108:111], v[160:163], v[124:127], v[108:111]
    v_add_u32 v218, s70, v218
    v_add_u32 v219, s70, v219
    v_mfma_f32_16x16x32_bf16 v[112:115], v[160:163], v[128:131], v[112:115]
    v_add_u32 v220, s70, v220
    v_add_u32 v221, s70, v221
    v_mfma_f32_16x16x32_bf16 v[116:119], v[164:167], v[124:127], v[116:119]
    v_add_u32 v222, s70, v222
    v_mfma_f32_16x16x32_bf16 v[120:123], v[164:167], v[128:131], v[120:123]
    s_waitcnt lgkmcnt(0)
    s_barrier
    v_mfma_f32_16x16x32_bf16 v[52:55], v[176:179], v[168:171], v[52:55]
    ds_read_b128 v[124:127], v212 offset:0
    ds_read_b64_tr_b16 v[132:133], v214 offset:0
    v_mfma_f32_16x16x32_bf16 v[56:59], v[176:179], v[172:175], v[56:59]
    ds_read_b64_tr_b16 v[134:135], v214 offset:2048
    ds_read_b128 v[128:131], v212 offset:2048
    v_mfma_f32_16x16x32_bf16 v[60:63], v[180:183], v[168:171], v[60:63]
    ds_read_b64_tr_b16 v[136:137], v215 offset:0
    ds_read_b64_tr_b16 v[138:139], v215 offset:2048
    v_mfma_f32_16x16x32_bf16 v[64:67], v[180:183], v[172:175], v[64:67]
    ds_read_b64_tr_b16 v[140:141], v216 offset:0
    ds_read_b64_tr_b16 v[142:143], v216 offset:2048
    v_mfma_f32_16x16x32_bf16 v[68:71], v[184:187], v[168:171], v[68:71]
    ds_read_b64_tr_b16 v[144:145], v217 offset:0
    ds_read_b64_tr_b16 v[146:147], v217 offset:2048
    v_mfma_f32_16x16x32_bf16 v[72:75], v[184:187], v[172:175], v[72:75]
    ds_read_b64_tr_b16 v[148:149], v218 offset:0
    ds_read_b64_tr_b16 v[150:151], v218 offset:2048
    v_mfma_f32_16x16x32_bf16 v[76:79], v[188:191], v[168:171], v[76:79]
    ds_read_b64_tr_b16 v[152:153], v219 offset:0
    ds_read_b64_tr_b16 v[154:155], v219 offset:2048
    v_mfma_f32_16x16x32_bf16 v[80:83], v[188:191], v[172:175], v[80:83]
    ds_read_b64_tr_b16 v[156:157], v220 offset:0
    ds_read_b64_tr_b16 v[158:159], v220 offset:2048
    v_mfma_f32_16x16x32_bf16 v[84:87], v[192:195], v[168:171], v[84:87]
    ds_read_b64_tr_b16 v[160:161], v221 offset:0
    ds_read_b64_tr_b16 v[162:163], v221 offset:2048
    v_mfma_f32_16x16x32_bf16 v[88:91], v[192:195], v[172:175], v[88:91]
    ds_read_b64_tr_b16 v[164:165], v222 offset:0
    ds_read_b64_tr_b16 v[166:167], v222 offset:256
    v_mfma_f32_16x16x32_bf16 v[92:95], v[196:199], v[168:171], v[92:95]
    v_mfma_f32_16x16x32_bf16 v[96:99], v[196:199], v[172:175], v[96:99]
    v_mfma_f32_16x16x32_bf16 v[100:103], v[200:203], v[168:171], v[100:103]
    v_mfma_f32_16x16x32_bf16 v[104:107], v[200:203], v[172:175], v[104:107]
    v_mfma_f32_16x16x32_bf16 v[108:111], v[204:207], v[168:171], v[108:111]
    v_mfma_f32_16x16x32_bf16 v[112:115], v[204:207], v[172:175], v[112:115]
    v_mfma_f32_16x16x32_bf16 v[116:119], v[208:211], v[168:171], v[116:119]
    v_mfma_f32_16x16x32_bf16 v[120:123], v[208:211], v[172:175], v[120:123]
    s_sub_u32 s71, s71, 1
    s_cmp_lg_u32 s71, 0
    s_cbranch_scc1 gated_mix__ssm_conv_s4d__mixer_gmlp__prompt_kernel_g11
    s_lshl_b32 s65, s25, 8
    s_add_u32 s65, s65, 139264
    v_lshrrev_b32 v7, 4, v0
    v_lshlrev_b32 v7, 6, v7
    v_add_u32 v7, s65, v7
    ds_read_b128 v[184:187], v7 offset:0
    ds_read_b128 v[188:191], v7 offset:16
    ds_read_b128 v[192:195], v7 offset:32
    ds_read_b128 v[196:199], v7 offset:48
    s_lshl_b32 s64, s26, 5
    s_lshl_b32 s66, s27, 1
    s_add_u32 s64, s64, s66
    s_mul_i32 s64, s64, 18432
    s_mul_i32 s66, s25, 9216
    s_add_u32 s64, s64, s66
    s_add_u32 s64, s64, 9437184
    s_add_u32 s4, s62, s64
    s_addc_u32 s5, s63, 0
    s_mov_b32 s6, 9216
    s_mov_b32 s7, 0x20000
    v_lshlrev_b32 v6, 4, v0
    s_movk_i32 s65, 4096
    s_movk_i32 s66, 8192
    s_waitcnt lgkmcnt(0)
    v_lshlrev_b32 v168, 16, v16
    v_and_b32 v169, 0xffff0000, v16
    v_lshlrev_b32 v170, 16, v17
    v_and_b32 v171, 0xffff0000, v17
    v_lshlrev_b32 v172, 16, v18
    v_and_b32 v173, 0xffff0000, v18
    v_lshlrev_b32 v174, 16, v19
    v_and_b32 v175, 0xffff0000, v19
    v_fma_f32 v168, v168, v184, v185
    v_fma_f32 v169, v169, v186, v187
    v_fma_f32 v170, v170, v188, v189
    v_fma_f32 v171, v171, v190, v191
    v_fma_f32 v172, v172, v192, v193
    v_fma_f32 v173, v173, v194, v195
    v_fma_f32 v174, v174, v196, v197
    v_fma_f32 v175, v175, v198, v199
    v_cvt_pk_bf16_f32 v16, v168, v169
    v_cvt_pk_bf16_f32 v17, v170, v171
    v_cvt_pk_bf16_f32 v18, v172, v173
    v_cvt_pk_bf16_f32 v19, v174, v175
    buffer_store_dwordx4 v[16:19], v6, s[4:7], 0 offen offset:0 sc1
    v_lshlrev_b32 v176, 16, v20
    v_and_b32 v177, 0xffff0000, v20
    v_lshlrev_b32 v178, 16, v21
    v_and_b32 v179, 0xffff0000, v21
    v_lshlrev_b32 v180, 16, v22
    v_and_b32 v181, 0xffff0000, v22
    v_lshlrev_b32 v182, 16, v23
    v_and_b32 v183, 0xffff0000, v23
    v_fma_f32 v176, v176, v184, v185
    v_fma_f32 v177, v177, v186, v187
    v_fma_f32 v178, v178, v188, v189
    v_fma_f32 v179, v179, v190, v191
    v_fma_f32 v180, v180, v192, v193
    v_fma_f32 v181, v181, v194, v195
    v_fma_f32 v182, v182, v196, v197
    v_fma_f32 v183, v183, v198, v199
    v_cvt_pk_bf16_f32 v20, v176, v177
    v_cvt_pk_bf16_f32 v21, v178, v179
    v_cvt_pk_bf16_f32 v22, v180, v181
    v_cvt_pk_bf16_f32 v23, v182, v183
    buffer_store_dwordx4 v[20:23], v6, s[4:7], 0 offen offset:1024 sc1
    v_lshlrev_b32 v168, 16, v24
    v_and_b32 v169, 0xffff0000, v24
    v_lshlrev_b32 v170, 16, v25
    v_and_b32 v171, 0xffff0000, v25
    v_lshlrev_b32 v172, 16, v26
    v_and_b32 v173, 0xffff0000, v26
    v_lshlrev_b32 v174, 16, v27
    v_and_b32 v175, 0xffff0000, v27
    v_fma_f32 v168, v168, v184, v185
    v_fma_f32 v169, v169, v186, v187
    v_fma_f32 v170, v170, v188, v189
    v_fma_f32 v171, v171, v190, v191
    v_fma_f32 v172, v172, v192, v193
    v_fma_f32 v173, v173, v194, v195
    v_fma_f32 v174, v174, v196, v197
    v_fma_f32 v175, v175, v198, v199
    v_cvt_pk_bf16_f32 v24, v168, v169
    v_cvt_pk_bf16_f32 v25, v170, v171
    v_cvt_pk_bf16_f32 v26, v172, v173
    v_cvt_pk_bf16_f32 v27, v174, v175
    buffer_store_dwordx4 v[24:27], v6, s[4:7], 0 offen offset:2048 sc1
    v_lshlrev_b32 v176, 16, v28
    v_and_b32 v177, 0xffff0000, v28
    v_lshlrev_b32 v178, 16, v29
    v_and_b32 v179, 0xffff0000, v29
    v_lshlrev_b32 v180, 16, v30
    v_and_b32 v181, 0xffff0000, v30
    v_lshlrev_b32 v182, 16, v31
    v_and_b32 v183, 0xffff0000, v31
    v_fma_f32 v176, v176, v184, v185
    v_fma_f32 v177, v177, v186, v187
    v_fma_f32 v178, v178, v188, v189
    v_fma_f32 v179, v179, v190, v191
    v_fma_f32 v180, v180, v192, v193
    v_fma_f32 v181, v181, v194, v195
    v_fma_f32 v182, v182, v196, v197
    v_fma_f32 v183, v183, v198, v199
    v_cvt_pk_bf16_f32 v28, v176, v177
    v_cvt_pk_bf16_f32 v29, v178, v179
    v_cvt_pk_bf16_f32 v30, v180, v181
    v_cvt_pk_bf16_f32 v31, v182, v183
    buffer_store_dwordx4 v[28:31], v6, s[4:7], 0 offen offset:3072 sc1
    v_lshlrev_b32 v168, 16, v32
    v_and_b32 v169, 0xffff0000, v32
    v_lshlrev_b32 v170, 16, v33
    v_and_b32 v171, 0xffff0000, v33
    v_lshlrev_b32 v172, 16, v34
    v_and_b32 v173, 0xffff0000, v34
    v_lshlrev_b32 v174, 16, v35
    v_and_b32 v175, 0xffff0000, v35
    v_fma_f32 v168, v168, v184, v185
    v_fma_f32 v169, v169, v186, v187
    v_fma_f32 v170, v170, v188, v189
    v_fma_f32 v171, v171, v190, v191
    v_fma_f32 v172, v172, v192, v193
    v_fma_f32 v173, v173, v194, v195
    v_fma_f32 v174, v174, v196, v197
    v_fma_f32 v175, v175, v198, v199
    v_cvt_pk_bf16_f32 v32, v168, v169
    v_cvt_pk_bf16_f32 v33, v170, v171
    v_cvt_pk_bf16_f32 v34, v172, v173
    v_cvt_pk_bf16_f32 v35, v174, v175
    buffer_store_dwordx4 v[32:35], v6, s[4:7], s65 offen offset:0 sc1
    v_lshlrev_b32 v176, 16, v36
    v_and_b32 v177, 0xffff0000, v36
    v_lshlrev_b32 v178, 16, v37
    v_and_b32 v179, 0xffff0000, v37
    v_lshlrev_b32 v180, 16, v38
    v_and_b32 v181, 0xffff0000, v38
    v_lshlrev_b32 v182, 16, v39
    v_and_b32 v183, 0xffff0000, v39
    v_fma_f32 v176, v176, v184, v185
    v_fma_f32 v177, v177, v186, v187
    v_fma_f32 v178, v178, v188, v189
    v_fma_f32 v179, v179, v190, v191
    v_fma_f32 v180, v180, v192, v193
    v_fma_f32 v181, v181, v194, v195
    v_fma_f32 v182, v182, v196, v197
    v_fma_f32 v183, v183, v198, v199
    v_cvt_pk_bf16_f32 v36, v176, v177
    v_cvt_pk_bf16_f32 v37, v178, v179
    v_cvt_pk_bf16_f32 v38, v180, v181
    v_cvt_pk_bf16_f32 v39, v182, v183
    buffer_store_dwordx4 v[36:39], v6, s[4:7], s65 offen offset:1024 sc1
    v_lshlrev_b32 v168, 16, v40
    v_and_b32 v169, 0xffff0000, v40
    v_lshlrev_b32 v170, 16, v41
    v_and_b32 v171, 0xffff0000, v41
    v_lshlrev_b32 v172, 16, v42
    v_and_b32 v173, 0xffff0000, v42
    v_lshlrev_b32 v174, 16, v43
    v_and_b32 v175, 0xffff0000, v43
    v_fma_f32 v168, v168, v184, v185
    v_fma_f32 v169, v169, v186, v187
    v_fma_f32 v170, v170, v188, v189
    v_fma_f32 v171, v171, v190, v191
    v_fma_f32 v172, v172, v192, v193
    v_fma_f32 v173, v173, v194, v195
    v_fma_f32 v174, v174, v196, v197
    v_fma_f32 v175, v175, v198, v199
    v_cvt_pk_bf16_f32 v40, v168, v169
    v_cvt_pk_bf16_f32 v41, v170, v171
    v_cvt_pk_bf16_f32 v42, v172, v173
    v_cvt_pk_bf16_f32 v43, v174, v175
    buffer_store_dwordx4 v[40:43], v6, s[4:7], s65 offen offset:2048 sc1
    v_lshlrev_b32 v176, 16, v44
    v_and_b32 v177, 0xffff0000, v44
    v_lshlrev_b32 v178, 16, v45
    v_and_b32 v179, 0xffff0000, v45
    v_lshlrev_b32 v180, 16, v46
    v_and_b32 v181, 0xffff0000, v46
    v_lshlrev_b32 v182, 16, v47
    v_and_b32 v183, 0xffff0000, v47
    v_fma_f32 v176, v176, v184, v185
    v_fma_f32 v177, v177, v186, v187
    v_fma_f32 v178, v178, v188, v189
    v_fma_f32 v179, v179, v190, v191
    v_fma_f32 v180, v180, v192, v193
    v_fma_f32 v181, v181, v194, v195
    v_fma_f32 v182, v182, v196, v197
    v_fma_f32 v183, v183, v198, v199
    v_cvt_pk_bf16_f32 v44, v176, v177
    v_cvt_pk_bf16_f32 v45, v178, v179
    v_cvt_pk_bf16_f32 v46, v180, v181
    v_cvt_pk_bf16_f32 v47, v182, v183
    buffer_store_dwordx4 v[44:47], v6, s[4:7], s65 offen offset:3072 sc1
    v_lshlrev_b32 v168, 16, v48
    v_and_b32 v169, 0xffff0000, v48
    v_lshlrev_b32 v170, 16, v49
    v_and_b32 v171, 0xffff0000, v49
    v_lshlrev_b32 v172, 16, v50
    v_and_b32 v173, 0xffff0000, v50
    v_lshlrev_b32 v174, 16, v51
    v_and_b32 v175, 0xffff0000, v51
    v_fma_f32 v168, v168, v184, v185
    v_fma_f32 v169, v169, v186, v187
    v_fma_f32 v170, v170, v188, v189
    v_fma_f32 v171, v171, v190, v191
    v_fma_f32 v172, v172, v192, v193
    v_fma_f32 v173, v173, v194, v195
    v_fma_f32 v174, v174, v196, v197
    v_fma_f32 v175, v175, v198, v199
    v_cvt_pk_bf16_f32 v48, v168, v169
    v_cvt_pk_bf16_f32 v49, v170, v171
    v_cvt_pk_bf16_f32 v50, v172, v173
    v_cvt_pk_bf16_f32 v51, v174, v175
    buffer_store_dwordx4 v[48:51], v6, s[4:7], s66 offen offset:0 sc1
    s_waitcnt lgkmcnt(0)
    v_mfma_f32_16x16x32_bf16 v[52:55], v[132:135], v[124:127], v[52:55]
    ds_read_b128 v[168:171], v213 offset:0
    ds_read_b64_tr_b16 v[176:177], v214 offset:8192
    v_mfma_f32_16x16x32_bf16 v[56:59], v[132:135], v[128:131], v[56:59]
    ds_read_b64_tr_b16 v[178:179], v214 offset:10240
    ds_read_b128 v[172:175], v213 offset:2048
    v_mfma_f32_16x16x32_bf16 v[60:63], v[136:139], v[124:127], v[60:63]
    ds_read_b64_tr_b16 v[180:181], v215 offset:8192
    ds_read_b64_tr_b16 v[182:183], v215 offset:10240
    v_mfma_f32_16x16x32_bf16 v[64:67], v[136:139], v[128:131], v[64:67]
    ds_read_b64_tr_b16 v[184:185], v216 offset:8192
    ds_read_b64_tr_b16 v[186:187], v216 offset:10240
    v_mfma_f32_16x16x32_bf16 v[68:71], v[140:143], v[124:127], v[68:71]
    ds_read_b64_tr_b16 v[188:189], v217 offset:8192
    ds_read_b64_tr_b16 v[190:191], v217 offset:10240
    v_mfma_f32_16x16x32_bf16 v[72:75], v[140:143], v[128:131], v[72:75]
    ds_read_b64_tr_b16 v[192:193], v218 offset:8192
    ds_read_b64_tr_b16 v[194:195], v218 offset:10240
    v_mfma_f32_16x16x32_bf16 v[76:79], v[144:147], v[124:127], v[76:79]
    ds_read_b64_tr_b16 v[196:197], v219 offset:8192
    ds_read_b64_tr_b16 v[198:199], v219 offset:10240
    v_mfma_f32_16x16x32_bf16 v[80:83], v[144:147], v[128:131], v[80:83]
    ds_read_b64_tr_b16 v[200:201], v220 offset:8192
    ds_read_b64_tr_b16 v[202:203], v220 offset:10240
    v_mfma_f32_16x16x32_bf16 v[84:87], v[148:151], v[124:127], v[84:87]
    ds_read_b64_tr_b16 v[204:205], v221 offset:8192
    ds_read_b64_tr_b16 v[206:207], v221 offset:10240
    v_mfma_f32_16x16x32_bf16 v[88:91], v[148:151], v[128:131], v[88:91]
    ds_read_b64_tr_b16 v[208:209], v222 offset:1024
    ds_read_b64_tr_b16 v[210:211], v222 offset:1280
    v_mfma_f32_16x16x32_bf16 v[92:95], v[152:155], v[124:127], v[92:95]
    s_add_u32 s68, s68, 1
    s_and_b32 s68, s68, 3
    s_cselect_b32 s70, s69, -104448
    v_mfma_f32_16x16x32_bf16 v[96:99], v[152:155], v[128:131], v[96:99]
    v_add_u32 v212, s70, v212
    v_add_u32 v213, s70, v213
    v_mfma_f32_16x16x32_bf16 v[100:103], v[156:159], v[124:127], v[100:103]
    v_add_u32 v214, s70, v214
    v_add_u32 v215, s70, v215
    v_mfma_f32_16x16x32_bf16 v[104:107], v[156:159], v[128:131], v[104:107]
    v_add_u32 v216, s70, v216
    v_add_u32 v217, s70, v217
    v_mfma_f32_16x16x32_bf16 v[108:111], v[160:163], v[124:127], v[108:111]
    v_add_u32 v218, s70, v218
    v_add_u32 v219, s70, v219
    v_mfma_f32_16x16x32_bf16 v[112:115], v[160:163], v[128:131], v[112:115]
    v_add_u32 v220, s70, v220
    v_add_u32 v221, s70, v221
    v_mfma_f32_16x16x32_bf16 v[116:119], v[164:167], v[124:127], v[116:119]
    v_add_u32 v222, s70, v222
    v_mfma_f32_16x16x32_bf16 v[120:123], v[164:167], v[128:131], v[120:123]
    s_waitcnt lgkmcnt(0)
    s_barrier
    v_mfma_f32_16x16x32_bf16 v[52:55], v[176:179], v[168:171], v[52:55]
    ds_read_b128 v[124:127], v212 offset:0
    ds_read_b64_tr_b16 v[132:133], v214 offset:0
    v_mfma_f32_16x16x32_bf16 v[56:59], v[176:179], v[172:175], v[56:59]
    ds_read_b64_tr_b16 v[134:135], v214 offset:2048
    ds_read_b128 v[128:131], v212 offset:2048
    v_mfma_f32_16x16x32_bf16 v[60:63], v[180:183], v[168:171], v[60:63]
    ds_read_b64_tr_b16 v[136:137], v215 offset:0
    ds_read_b64_tr_b16 v[138:139], v215 offset:2048
    v_mfma_f32_16x16x32_bf16 v[64:67], v[180:183], v[172:175], v[64:67]
    ds_read_b64_tr_b16 v[140:141], v216 offset:0
    ds_read_b64_tr_b16 v[142:143], v216 offset:2048
    v_mfma_f32_16x16x32_bf16 v[68:71], v[184:187], v[168:171], v[68:71]
    ds_read_b64_tr_b16 v[144:145], v217 offset:0
    ds_read_b64_tr_b16 v[146:147], v217 offset:2048
    v_mfma_f32_16x16x32_bf16 v[72:75], v[184:187], v[172:175], v[72:75]
    ds_read_b64_tr_b16 v[148:149], v218 offset:0
    ds_read_b64_tr_b16 v[150:151], v218 offset:2048
    v_mfma_f32_16x16x32_bf16 v[76:79], v[188:191], v[168:171], v[76:79]
    ds_read_b64_tr_b16 v[152:153], v219 offset:0
    ds_read_b64_tr_b16 v[154:155], v219 offset:2048
    v_mfma_f32_16x16x32_bf16 v[80:83], v[188:191], v[172:175], v[80:83]
    ds_read_b64_tr_b16 v[156:157], v220 offset:0
    ds_read_b64_tr_b16 v[158:159], v220 offset:2048
    v_mfma_f32_16x16x32_bf16 v[84:87], v[192:195], v[168:171], v[84:87]
    ds_read_b64_tr_b16 v[160:161], v221 offset:0
    ds_read_b64_tr_b16 v[162:163], v221 offset:2048
    v_mfma_f32_16x16x32_bf16 v[88:91], v[192:195], v[172:175], v[88:91]
    ds_read_b64_tr_b16 v[164:165], v222 offset:0
    ds_read_b64_tr_b16 v[166:167], v222 offset:256
    v_mfma_f32_16x16x32_bf16 v[92:95], v[196:199], v[168:171], v[92:95]
    v_mfma_f32_16x16x32_bf16 v[96:99], v[196:199], v[172:175], v[96:99]
    v_mfma_f32_16x16x32_bf16 v[100:103], v[200:203], v[168:171], v[100:103]
    v_mfma_f32_16x16x32_bf16 v[104:107], v[200:203], v[172:175], v[104:107]
    v_mfma_f32_16x16x32_bf16 v[108:111], v[204:207], v[168:171], v[108:111]
    v_mfma_f32_16x16x32_bf16 v[112:115], v[204:207], v[172:175], v[112:115]
    v_mfma_f32_16x16x32_bf16 v[116:119], v[208:211], v[168:171], v[116:119]
    v_mfma_f32_16x16x32_bf16 v[120:123], v[208:211], v[172:175], v[120:123]
    s_waitcnt lgkmcnt(0)
    v_mfma_f32_16x16x32_bf16 v[52:55], v[132:135], v[124:127], v[52:55]
    ds_read_b128 v[168:171], v213 offset:0
    ds_read_b64_tr_b16 v[176:177], v214 offset:8192
    v_mfma_f32_16x16x32_bf16 v[56:59], v[132:135], v[128:131], v[56:59]
    ds_read_b64_tr_b16 v[178:179], v214 offset:10240
    ds_read_b128 v[172:175], v213 offset:2048
    v_mfma_f32_16x16x32_bf16 v[60:63], v[136:139], v[124:127], v[60:63]
    ds_read_b64_tr_b16 v[180:181], v215 offset:8192
    ds_read_b64_tr_b16 v[182:183], v215 offset:10240
    v_mfma_f32_16x16x32_bf16 v[64:67], v[136:139], v[128:131], v[64:67]
    ds_read_b64_tr_b16 v[184:185], v216 offset:8192
    ds_read_b64_tr_b16 v[186:187], v216 offset:10240
    v_mfma_f32_16x16x32_bf16 v[68:71], v[140:143], v[124:127], v[68:71]
    ds_read_b64_tr_b16 v[188:189], v217 offset:8192
    ds_read_b64_tr_b16 v[190:191], v217 offset:10240
    v_mfma_f32_16x16x32_bf16 v[72:75], v[140:143], v[128:131], v[72:75]
    ds_read_b64_tr_b16 v[192:193], v218 offset:8192
    ds_read_b64_tr_b16 v[194:195], v218 offset:10240
    v_mfma_f32_16x16x32_bf16 v[76:79], v[144:147], v[124:127], v[76:79]
    ds_read_b64_tr_b16 v[196:197], v219 offset:8192
    ds_read_b64_tr_b16 v[198:199], v219 offset:10240
    v_mfma_f32_16x16x32_bf16 v[80:83], v[144:147], v[128:131], v[80:83]
    ds_read_b64_tr_b16 v[200:201], v220 offset:8192
    ds_read_b64_tr_b16 v[202:203], v220 offset:10240
    v_mfma_f32_16x16x32_bf16 v[84:87], v[148:151], v[124:127], v[84:87]
    ds_read_b64_tr_b16 v[204:205], v221 offset:8192
    ds_read_b64_tr_b16 v[206:207], v221 offset:10240
    v_mfma_f32_16x16x32_bf16 v[88:91], v[148:151], v[128:131], v[88:91]
    ds_read_b64_tr_b16 v[208:209], v222 offset:1024
    ds_read_b64_tr_b16 v[210:211], v222 offset:1280
    v_mfma_f32_16x16x32_bf16 v[92:95], v[152:155], v[124:127], v[92:95]
    s_add_u32 s68, s68, 1
    s_and_b32 s68, s68, 3
    s_cselect_b32 s70, s69, -104448
    v_mfma_f32_16x16x32_bf16 v[96:99], v[152:155], v[128:131], v[96:99]
    v_add_u32 v212, s70, v212
    v_add_u32 v213, s70, v213
    v_mfma_f32_16x16x32_bf16 v[100:103], v[156:159], v[124:127], v[100:103]
    v_add_u32 v214, s70, v214
    v_add_u32 v215, s70, v215
    v_mfma_f32_16x16x32_bf16 v[104:107], v[156:159], v[128:131], v[104:107]
    v_add_u32 v216, s70, v216
    v_add_u32 v217, s70, v217
    v_mfma_f32_16x16x32_bf16 v[108:111], v[160:163], v[124:127], v[108:111]
    v_add_u32 v218, s70, v218
    v_add_u32 v219, s70, v219
    v_mfma_f32_16x16x32_bf16 v[112:115], v[160:163], v[128:131], v[112:115]
    v_add_u32 v220, s70, v220
    v_add_u32 v221, s70, v221
    v_mfma_f32_16x16x32_bf16 v[116:119], v[164:167], v[124:127], v[116:119]
    v_add_u32 v222, s70, v222
    v_mfma_f32_16x16x32_bf16 v[120:123], v[164:167], v[128:131], v[120:123]
    s_waitcnt lgkmcnt(0)
    s_barrier
    v_mfma_f32_16x16x32_bf16 v[52:55], v[176:179], v[168:171], v[52:55]
    ds_read_b128 v[124:127], v212 offset:0
    ds_read_b64_tr_b16 v[132:133], v214 offset:0
    v_mfma_f32_16x16x32_bf16 v[56:59], v[176:179], v[172:175], v[56:59]
    ds_read_b64_tr_b16 v[134:135], v214 offset:2048
    ds_read_b128 v[128:131], v212 offset:2048
    v_mfma_f32_16x16x32_bf16 v[60:63], v[180:183], v[168:171], v[60:63]
    ds_read_b64_tr_b16 v[136:137], v215 offset:0
    ds_read_b64_tr_b16 v[138:139], v215 offset:2048
    v_mfma_f32_16x16x32_bf16 v[64:67], v[180:183], v[172:175], v[64:67]
    ds_read_b64_tr_b16 v[140:141], v216 offset:0
    ds_read_b64_tr_b16 v[142:143], v216 offset:2048
    v_mfma_f32_16x16x32_bf16 v[68:71], v[184:187], v[168:171], v[68:71]
    ds_read_b64_tr_b16 v[144:145], v217 offset:0
    ds_read_b64_tr_b16 v[146:147], v217 offset:2048
    v_mfma_f32_16x16x32_bf16 v[72:75], v[184:187], v[172:175], v[72:75]
    ds_read_b64_tr_b16 v[148:149], v218 offset:0
    ds_read_b64_tr_b16 v[150:151], v218 offset:2048
    v_mfma_f32_16x16x32_bf16 v[76:79], v[188:191], v[168:171], v[76:79]
    ds_read_b64_tr_b16 v[152:153], v219 offset:0
    ds_read_b64_tr_b16 v[154:155], v219 offset:2048
    v_mfma_f32_16x16x32_bf16 v[80:83], v[188:191], v[172:175], v[80:83]
    ds_read_b64_tr_b16 v[156:157], v220 offset:0
    ds_read_b64_tr_b16 v[158:159], v220 offset:2048
    v_mfma_f32_16x16x32_bf16 v[84:87], v[192:195], v[168:171], v[84:87]
    ds_read_b64_tr_b16 v[160:161], v221 offset:0
    ds_read_b64_tr_b16 v[162:163], v221 offset:2048
    v_mfma_f32_16x16x32_bf16 v[88:91], v[192:195], v[172:175], v[88:91]
    ds_read_b64_tr_b16 v[164:165], v222 offset:0
    ds_read_b64_tr_b16 v[166:167], v222 offset:256
    v_mfma_f32_16x16x32_bf16 v[92:95], v[196:199], v[168:171], v[92:95]
    v_mfma_f32_16x16x32_bf16 v[96:99], v[196:199], v[172:175], v[96:99]
    v_mfma_f32_16x16x32_bf16 v[100:103], v[200:203], v[168:171], v[100:103]
    v_mfma_f32_16x16x32_bf16 v[104:107], v[200:203], v[172:175], v[104:107]
    v_mfma_f32_16x16x32_bf16 v[108:111], v[204:207], v[168:171], v[108:111]
    v_mfma_f32_16x16x32_bf16 v[112:115], v[204:207], v[172:175], v[112:115]
    v_mfma_f32_16x16x32_bf16 v[116:119], v[208:211], v[168:171], v[116:119]
    v_mfma_f32_16x16x32_bf16 v[120:123], v[208:211], v[172:175], v[120:123]
    s_waitcnt lgkmcnt(0)
    v_mfma_f32_16x16x32_bf16 v[52:55], v[132:135], v[124:127], v[52:55]
    ds_read_b128 v[168:171], v213 offset:0
    ds_read_b64_tr_b16 v[176:177], v214 offset:8192
    v_mfma_f32_16x16x32_bf16 v[56:59], v[132:135], v[128:131], v[56:59]
    ds_read_b64_tr_b16 v[178:179], v214 offset:10240
    ds_read_b128 v[172:175], v213 offset:2048
    v_mfma_f32_16x16x32_bf16 v[60:63], v[136:139], v[124:127], v[60:63]
    ds_read_b64_tr_b16 v[180:181], v215 offset:8192
    ds_read_b64_tr_b16 v[182:183], v215 offset:10240
    v_mfma_f32_16x16x32_bf16 v[64:67], v[136:139], v[128:131], v[64:67]
    ds_read_b64_tr_b16 v[184:185], v216 offset:8192
    ds_read_b64_tr_b16 v[186:187], v216 offset:10240
    v_mfma_f32_16x16x32_bf16 v[68:71], v[140:143], v[124:127], v[68:71]
    ds_read_b64_tr_b16 v[188:189], v217 offset:8192
    ds_read_b64_tr_b16 v[190:191], v217 offset:10240
    v_mfma_f32_16x16x32_bf16 v[72:75], v[140:143], v[128:131], v[72:75]
    ds_read_b64_tr_b16 v[192:193], v218 offset:8192
    ds_read_b64_tr_b16 v[194:195], v218 offset:10240
    v_mfma_f32_16x16x32_bf16 v[76:79], v[144:147], v[124:127], v[76:79]
    ds_read_b64_tr_b16 v[196:197], v219 offset:8192
    ds_read_b64_tr_b16 v[198:199], v219 offset:10240
    v_mfma_f32_16x16x32_bf16 v[80:83], v[144:147], v[128:131], v[80:83]
    ds_read_b64_tr_b16 v[200:201], v220 offset:8192
    ds_read_b64_tr_b16 v[202:203], v220 offset:10240
    v_mfma_f32_16x16x32_bf16 v[84:87], v[148:151], v[124:127], v[84:87]
    ds_read_b64_tr_b16 v[204:205], v221 offset:8192
    ds_read_b64_tr_b16 v[206:207], v221 offset:10240
    v_mfma_f32_16x16x32_bf16 v[88:91], v[148:151], v[128:131], v[88:91]
    ds_read_b64_tr_b16 v[208:209], v222 offset:1024
    ds_read_b64_tr_b16 v[210:211], v222 offset:1280
    v_mfma_f32_16x16x32_bf16 v[92:95], v[152:155], v[124:127], v[92:95]
    s_add_u32 s68, s68, 1
    s_and_b32 s68, s68, 3
    s_cselect_b32 s70, s69, -104448
    v_mfma_f32_16x16x32_bf16 v[96:99], v[152:155], v[128:131], v[96:99]
    v_add_u32 v212, s70, v212
    v_add_u32 v213, s70, v213
    v_mfma_f32_16x16x32_bf16 v[100:103], v[156:159], v[124:127], v[100:103]
    v_add_u32 v214, s70, v214
    v_add_u32 v215, s70, v215
    v_mfma_f32_16x16x32_bf16 v[104:107], v[156:159], v[128:131], v[104:107]
    v_add_u32 v216, s70, v216
    v_add_u32 v217, s70, v217
    v_mfma_f32_16x16x32_bf16 v[108:111], v[160:163], v[124:127], v[108:111]
    v_add_u32 v218, s70, v218
    v_add_u32 v219, s70, v219
    v_mfma_f32_16x16x32_bf16 v[112:115], v[160:163], v[128:131], v[112:115]
    v_add_u32 v220, s70, v220
    v_add_u32 v221, s70, v221
    v_mfma_f32_16x16x32_bf16 v[116:119], v[164:167], v[124:127], v[116:119]
    v_add_u32 v222, s70, v222
    v_mfma_f32_16x16x32_bf16 v[120:123], v[164:167], v[128:131], v[120:123]
    s_waitcnt vmcnt(0) lgkmcnt(0)
    s_barrier
    v_mfma_f32_16x16x32_bf16 v[52:55], v[176:179], v[168:171], v[52:55]
    ds_read_b128 v[124:127], v212 offset:0
    ds_read_b64_tr_b16 v[132:133], v214 offset:0
    v_mfma_f32_16x16x32_bf16 v[56:59], v[176:179], v[172:175], v[56:59]
    ds_read_b64_tr_b16 v[134:135], v214 offset:2048
    ds_read_b128 v[128:131], v212 offset:2048
    v_mfma_f32_16x16x32_bf16 v[60:63], v[180:183], v[168:171], v[60:63]
    ds_read_b64_tr_b16 v[136:137], v215 offset:0
    ds_read_b64_tr_b16 v[138:139], v215 offset:2048
    v_mfma_f32_16x16x32_bf16 v[64:67], v[180:183], v[172:175], v[64:67]
    ds_read_b64_tr_b16 v[140:141], v216 offset:0
    ds_read_b64_tr_b16 v[142:143], v216 offset:2048
    v_mfma_f32_16x16x32_bf16 v[68:71], v[184:187], v[168:171], v[68:71]
    ds_read_b64_tr_b16 v[144:145], v217 offset:0
    ds_read_b64_tr_b16 v[146:147], v217 offset:2048
    v_mfma_f32_16x16x32_bf16 v[72:75], v[184:187], v[172:175], v[72:75]
    ds_read_b64_tr_b16 v[148:149], v218 offset:0
    ds_read_b64_tr_b16 v[150:151], v218 offset:2048
    v_mfma_f32_16x16x32_bf16 v[76:79], v[188:191], v[168:171], v[76:79]
    ds_read_b64_tr_b16 v[152:153], v219 offset:0
    ds_read_b64_tr_b16 v[154:155], v219 offset:2048
    v_mfma_f32_16x16x32_bf16 v[80:83], v[188:191], v[172:175], v[80:83]
    ds_read_b64_tr_b16 v[156:157], v220 offset:0
    ds_read_b64_tr_b16 v[158:159], v220 offset:2048
    v_mfma_f32_16x16x32_bf16 v[84:87], v[192:195], v[168:171], v[84:87]
    ds_read_b64_tr_b16 v[160:161], v221 offset:0
    ds_read_b64_tr_b16 v[162:163], v221 offset:2048
    v_mfma_f32_16x16x32_bf16 v[88:91], v[192:195], v[172:175], v[88:91]
    ds_read_b64_tr_b16 v[164:165], v222 offset:0
    ds_read_b64_tr_b16 v[166:167], v222 offset:256
    v_mfma_f32_16x16x32_bf16 v[92:95], v[196:199], v[168:171], v[92:95]
    v_mfma_f32_16x16x32_bf16 v[96:99], v[196:199], v[172:175], v[96:99]
    v_mfma_f32_16x16x32_bf16 v[100:103], v[200:203], v[168:171], v[100:103]
    v_mfma_f32_16x16x32_bf16 v[104:107], v[200:203], v[172:175], v[104:107]
    v_mfma_f32_16x16x32_bf16 v[108:111], v[204:207], v[168:171], v[108:111]
    v_mfma_f32_16x16x32_bf16 v[112:115], v[204:207], v[172:175], v[112:115]
    v_mfma_f32_16x16x32_bf16 v[116:119], v[208:211], v[168:171], v[116:119]
    v_mfma_f32_16x16x32_bf16 v[120:123], v[208:211], v[172:175], v[120:123]
    s_waitcnt lgkmcnt(0)
    v_mfma_f32_16x16x32_bf16 v[52:55], v[132:135], v[124:127], v[52:55]
    ds_read_b128 v[168:171], v213 offset:0
    ds_read_b64_tr_b16 v[176:177], v214 offset:8192
    v_mfma_f32_16x16x32_bf16 v[56:59], v[132:135], v[128:131], v[56:59]
    ds_read_b64_tr_b16 v[178:179], v214 offset:10240
    ds_read_b128 v[172:175], v213 offset:2048
    v_mfma_f32_16x16x32_bf16 v[60:63], v[136:139], v[124:127], v[60:63]
    ds_read_b64_tr_b16 v[180:181], v215 offset:8192
    ds_read_b64_tr_b16 v[182:183], v215 offset:10240
    v_mfma_f32_16x16x32_bf16 v[64:67], v[136:139], v[128:131], v[64:67]
    ds_read_b64_tr_b16 v[184:185], v216 offset:8192
    ds_read_b64_tr_b16 v[186:187], v216 offset:10240
    v_mfma_f32_16x16x32_bf16 v[68:71], v[140:143], v[124:127], v[68:71]
    ds_read_b64_tr_b16 v[188:189], v217 offset:8192
    ds_read_b64_tr_b16 v[190:191], v217 offset:10240
    v_mfma_f32_16x16x32_bf16 v[72:75], v[140:143], v[128:131], v[72:75]
    ds_read_b64_tr_b16 v[192:193], v218 offset:8192
    ds_read_b64_tr_b16 v[194:195], v218 offset:10240
    v_mfma_f32_16x16x32_bf16 v[76:79], v[144:147], v[124:127], v[76:79]
    ds_read_b64_tr_b16 v[196:197], v219 offset:8192
    ds_read_b64_tr_b16 v[198:199], v219 offset:10240
    v_mfma_f32_16x16x32_bf16 v[80:83], v[144:147], v[128:131], v[80:83]
    ds_read_b64_tr_b16 v[200:201], v220 offset:8192
    ds_read_b64_tr_b16 v[202:203], v220 offset:10240
    v_mfma_f32_16x16x32_bf16 v[84:87], v[148:151], v[124:127], v[84:87]
    ds_read_b64_tr_b16 v[204:205], v221 offset:8192
    ds_read_b64_tr_b16 v[206:207], v221 offset:10240
    v_mfma_f32_16x16x32_bf16 v[88:91], v[148:151], v[128:131], v[88:91]
    ds_read_b64_tr_b16 v[208:209], v222 offset:1024
    ds_read_b64_tr_b16 v[210:211], v222 offset:1280
    v_mfma_f32_16x16x32_bf16 v[92:95], v[152:155], v[124:127], v[92:95]
    s_add_u32 s68, s68, 1
    s_and_b32 s68, s68, 3
    s_cselect_b32 s70, s69, -104448
    v_mfma_f32_16x16x32_bf16 v[96:99], v[152:155], v[128:131], v[96:99]
    v_add_u32 v212, s70, v212
    v_add_u32 v213, s70, v213
    v_mfma_f32_16x16x32_bf16 v[100:103], v[156:159], v[124:127], v[100:103]
    v_add_u32 v214, s70, v214
    v_add_u32 v215, s70, v215
    v_mfma_f32_16x16x32_bf16 v[104:107], v[156:159], v[128:131], v[104:107]
    v_add_u32 v216, s70, v216
    v_add_u32 v217, s70, v217
    v_mfma_f32_16x16x32_bf16 v[108:111], v[160:163], v[124:127], v[108:111]
    v_add_u32 v218, s70, v218
    v_add_u32 v219, s70, v219
    v_mfma_f32_16x16x32_bf16 v[112:115], v[160:163], v[128:131], v[112:115]
    v_add_u32 v220, s70, v220
    v_add_u32 v221, s70, v221
    v_mfma_f32_16x16x32_bf16 v[116:119], v[164:167], v[124:127], v[116:119]
    v_add_u32 v222, s70, v222
    v_mfma_f32_16x16x32_bf16 v[120:123], v[164:167], v[128:131], v[120:123]
    s_waitcnt lgkmcnt(0)
    v_mfma_f32_16x16x32_bf16 v[52:55], v[176:179], v[168:171], v[52:55]
    ds_read_b128 v[124:127], v212 offset:0
    ds_read_b64_tr_b16 v[132:133], v214 offset:0
    v_mfma_f32_16x16x32_bf16 v[56:59], v[176:179], v[172:175], v[56:59]
    ds_read_b64_tr_b16 v[134:135], v214 offset:2048
    ds_read_b128 v[128:131], v212 offset:2048
    v_mfma_f32_16x16x32_bf16 v[60:63], v[180:183], v[168:171], v[60:63]
    ds_read_b64_tr_b16 v[136:137], v215 offset:0
    ds_read_b64_tr_b16 v[138:139], v215 offset:2048
    v_mfma_f32_16x16x32_bf16 v[64:67], v[180:183], v[172:175], v[64:67]
    ds_read_b64_tr_b16 v[140:141], v216 offset:0
    ds_read_b64_tr_b16 v[142:143], v216 offset:2048
    v_mfma_f32_16x16x32_bf16 v[68:71], v[184:187], v[168:171], v[68:71]
    ds_read_b64_tr_b16 v[144:145], v217 offset:0
    ds_read_b64_tr_b16 v[146:147], v217 offset:2048
    v_mfma_f32_16x16x32_bf16 v[72:75], v[184:187], v[172:175], v[72:75]
    ds_read_b64_tr_b16 v[148:149], v218 offset:0
    ds_read_b64_tr_b16 v[150:151], v218 offset:2048
    v_mfma_f32_16x16x32_bf16 v[76:79], v[188:191], v[168:171], v[76:79]
    ds_read_b64_tr_b16 v[152:153], v219 offset:0
    ds_read_b64_tr_b16 v[154:155], v219 offset:2048
    v_mfma_f32_16x16x32_bf16 v[80:83], v[188:191], v[172:175], v[80:83]
    ds_read_b64_tr_b16 v[156:157], v220 offset:0
    ds_read_b64_tr_b16 v[158:159], v220 offset:2048
    v_mfma_f32_16x16x32_bf16 v[84:87], v[192:195], v[168:171], v[84:87]
    ds_read_b64_tr_b16 v[160:161], v221 offset:0
    ds_read_b64_tr_b16 v[162:163], v221 offset:2048
    v_mfma_f32_16x16x32_bf16 v[88:91], v[192:195], v[172:175], v[88:91]
    ds_read_b64_tr_b16 v[164:165], v222 offset:0
    ds_read_b64_tr_b16 v[166:167], v222 offset:256
    v_mfma_f32_16x16x32_bf16 v[92:95], v[196:199], v[168:171], v[92:95]
    v_mfma_f32_16x16x32_bf16 v[96:99], v[196:199], v[172:175], v[96:99]
    v_mfma_f32_16x16x32_bf16 v[100:103], v[200:203], v[168:171], v[100:103]
    v_mfma_f32_16x16x32_bf16 v[104:107], v[200:203], v[172:175], v[104:107]
    v_mfma_f32_16x16x32_bf16 v[108:111], v[204:207], v[168:171], v[108:111]
    v_mfma_f32_16x16x32_bf16 v[112:115], v[204:207], v[172:175], v[112:115]
    v_mfma_f32_16x16x32_bf16 v[116:119], v[208:211], v[168:171], v[116:119]
    v_mfma_f32_16x16x32_bf16 v[120:123], v[208:211], v[172:175], v[120:123]
    s_waitcnt lgkmcnt(0)
    v_mfma_f32_16x16x32_bf16 v[52:55], v[132:135], v[124:127], v[52:55]
    ds_read_b128 v[168:171], v213 offset:0
    ds_read_b64_tr_b16 v[176:177], v214 offset:8192
    v_mfma_f32_16x16x32_bf16 v[56:59], v[132:135], v[128:131], v[56:59]
    ds_read_b64_tr_b16 v[178:179], v214 offset:10240
    ds_read_b128 v[172:175], v213 offset:2048
    v_mfma_f32_16x16x32_bf16 v[60:63], v[136:139], v[124:127], v[60:63]
    ds_read_b64_tr_b16 v[180:181], v215 offset:8192
    ds_read_b64_tr_b16 v[182:183], v215 offset:10240
    v_mfma_f32_16x16x32_bf16 v[64:67], v[136:139], v[128:131], v[64:67]
    ds_read_b64_tr_b16 v[184:185], v216 offset:8192
    ds_read_b64_tr_b16 v[186:187], v216 offset:10240
    v_mfma_f32_16x16x32_bf16 v[68:71], v[140:143], v[124:127], v[68:71]
    ds_read_b64_tr_b16 v[188:189], v217 offset:8192
    ds_read_b64_tr_b16 v[190:191], v217 offset:10240
    v_mfma_f32_16x16x32_bf16 v[72:75], v[140:143], v[128:131], v[72:75]
    ds_read_b64_tr_b16 v[192:193], v218 offset:8192
    ds_read_b64_tr_b16 v[194:195], v218 offset:10240
    v_mfma_f32_16x16x32_bf16 v[76:79], v[144:147], v[124:127], v[76:79]
    ds_read_b64_tr_b16 v[196:197], v219 offset:8192
    ds_read_b64_tr_b16 v[198:199], v219 offset:10240
    v_mfma_f32_16x16x32_bf16 v[80:83], v[144:147], v[128:131], v[80:83]
    ds_read_b64_tr_b16 v[200:201], v220 offset:8192
    ds_read_b64_tr_b16 v[202:203], v220 offset:10240
    v_mfma_f32_16x16x32_bf16 v[84:87], v[148:151], v[124:127], v[84:87]
    ds_read_b64_tr_b16 v[204:205], v221 offset:8192
    ds_read_b64_tr_b16 v[206:207], v221 offset:10240
    v_mfma_f32_16x16x32_bf16 v[88:91], v[148:151], v[128:131], v[88:91]
    ds_read_b64_tr_b16 v[208:209], v222 offset:1024
    ds_read_b64_tr_b16 v[210:211], v222 offset:1280
    v_mfma_f32_16x16x32_bf16 v[92:95], v[152:155], v[124:127], v[92:95]
    v_mfma_f32_16x16x32_bf16 v[96:99], v[152:155], v[128:131], v[96:99]
    v_mfma_f32_16x16x32_bf16 v[100:103], v[156:159], v[124:127], v[100:103]
    v_mfma_f32_16x16x32_bf16 v[104:107], v[156:159], v[128:131], v[104:107]
    v_mfma_f32_16x16x32_bf16 v[108:111], v[160:163], v[124:127], v[108:111]
    v_mfma_f32_16x16x32_bf16 v[112:115], v[160:163], v[128:131], v[112:115]
    v_mfma_f32_16x16x32_bf16 v[116:119], v[164:167], v[124:127], v[116:119]
    v_mfma_f32_16x16x32_bf16 v[120:123], v[164:167], v[128:131], v[120:123]
    s_waitcnt lgkmcnt(0)
    v_mov_b32 v8, 163588
    v_mov_b32 v9, 1
    s_mov_b64 exec, 1
    ds_add_u32 v8, v9
    s_mov_b64 exec, -1
    s_nop 3
    v_mfma_f32_16x16x32_bf16 v[52:55], v[176:179], v[168:171], v[52:55]
    v_mfma_f32_16x16x32_bf16 v[56:59], v[176:179], v[172:175], v[56:59]
    v_mfma_f32_16x16x32_bf16 v[60:63], v[180:183], v[168:171], v[60:63]
    v_mfma_f32_16x16x32_bf16 v[64:67], v[180:183], v[172:175], v[64:67]
    v_mfma_f32_16x16x32_bf16 v[68:71], v[184:187], v[168:171], v[68:71]
    v_mfma_f32_16x16x32_bf16 v[72:75], v[184:187], v[172:175], v[72:75]
    v_mfma_f32_16x16x32_bf16 v[76:79], v[188:191], v[168:171], v[76:79]
    v_mfma_f32_16x16x32_bf16 v[80:83], v[188:191], v[172:175], v[80:83]
    v_mfma_f32_16x16x32_bf16 v[84:87], v[192:195], v[168:171], v[84:87]
    v_mfma_f32_16x16x32_bf16 v[88:91], v[192:195], v[172:175], v[88:91]
    v_mfma_f32_16x16x32_bf16 v[92:95], v[196:199], v[168:171], v[92:95]
    v_mfma_f32_16x16x32_bf16 v[96:99], v[196:199], v[172:175], v[96:99]
    v_mfma_f32_16x16x32_bf16 v[100:103], v[200:203], v[168:171], v[100:103]
    v_mfma_f32_16x16x32_bf16 v[104:107], v[200:203], v[172:175], v[104:107]
    v_mfma_f32_16x16x32_bf16 v[108:111], v[204:207], v[168:171], v[108:111]
    v_mfma_f32_16x16x32_bf16 v[112:115], v[204:207], v[172:175], v[112:115]
    v_mfma_f32_16x16x32_bf16 v[116:119], v[208:211], v[168:171], v[116:119]
    v_mfma_f32_16x16x32_bf16 v[120:123], v[208:211], v[172:175], v[120:123]
    s_lshr_b32 s64, s25, 1
    s_mul_i32 s64, s64, 34816
    s_and_b32 s66, s25, 1
    s_mul_i32 s66, s66, 9216
    s_add_u32 s64, s64, s66
    s_add_u32 s64, s64, 69632
    v_add_u32 v7, s64, v6
    ds_write_b128 v7, v[16:19] offset:0
    ds_write_b128 v7, v[20:23] offset:1024
    ds_write_b128 v7, v[24:27] offset:2048
    ds_write_b128 v7, v[28:31] offset:3072
    ds_write_b128 v7, v[32:35] offset:4096
    ds_write_b128 v7, v[36:39] offset:5120
    ds_write_b128 v7, v[40:43] offset:6144
    ds_write_b128 v7, v[44:47] offset:7168
    ds_write_b128 v7, v[48:51] offset:8192
    s_waitcnt lgkmcnt(0)
    v_mov_b32 v24, v226
    v_mov_b32 v25, v227
    v_mov_b32 v26, v228
    v_mov_b32 v27, v229
    v_mov_b32 v28, v230
    v_cvt_pk_bf16_f32 v216, v52, v53
    v_cvt_pk_bf16_f32 v217, v54, v55
    v_cvt_pk_bf16_f32 v232, v56, v57
    v_cvt_pk_bf16_f32 v233, v58, v59
    v_cvt_pk_bf16_f32 v218, v60, v61
    v_cvt_pk_bf16_f32 v219, v62, v63
    v_cvt_pk_bf16_f32 v234, v64, v65
    v_cvt_pk_bf16_f32 v235, v66, v67
    v_cvt_pk_bf16_f32 v220, v68, v69
    v_cvt_pk_bf16_f32 v221, v70, v71
    v_cvt_pk_bf16_f32 v236, v72, v73
    v_cvt_pk_bf16_f32 v237, v74, v75
    v_cvt_pk_bf16_f32 v222, v76, v77
    v_cvt_pk_bf16_f32 v223, v78, v79
    v_cvt_pk_bf16_f32 v238, v80, v81
    v_cvt_pk_bf16_f32 v239, v82, v83
    v_cvt_pk_bf16_f32 v224, v84, v85
    v_cvt_pk_bf16_f32 v225, v86, v87
    v_cvt_pk_bf16_f32 v240, v88, v89
    v_cvt_pk_bf16_f32 v241, v90, v91
    v_cvt_pk_bf16_f32 v226, v92, v93
    v_cvt_pk_bf16_f32 v227, v94, v95
    v_cvt_pk_bf16_f32 v242, v96, v97
    v_cvt_pk_bf16_f32 v243, v98, v99
    v_cvt_pk_bf16_f32 v228, v100, v101
    v_cvt_pk_bf16_f32 v229, v102, v103
    v_cvt_pk_bf16_f32 v244, v104, v105
    v_cvt_pk_bf16_f32 v245, v106, v107
    v_cvt_pk_bf16_f32 v230, v108, v109
    v_cvt_pk_bf16_f32 v231, v110, v111
    v_cvt_pk_bf16_f32 v246, v112, v113
    v_cvt_pk_bf16_f32 v247, v114, v115
    v_cvt_pk_bf16_f32 v248, v116, v117
    v_cvt_pk_bf16_f32 v249, v118, v119
    v_cvt_pk_bf16_f32 v250, v120, v121
    v_cvt_pk_bf16_f32 v251, v122, v123
    v_mov_b32 v215, v11
    s_cmp_lt_u32 s26, 9
    s_cbranch_scc1 gated_mix__ssm_conv_s4d__mixer_gmlp__prompt_kernel_Cnk4
    s_sub_u32 s67, s30, 576
    s_lshr_b32 s65, s67, 2
    s_and_b32 s66, s65, 15
    s_lshl_b32 s66, s66, 4
    s_lshr_b32 s65, s65, 4
    s_add_u32 s66, s66, s65
    s_and_b32 s65, s67, 3
    s_add_u32 s65, s65, 16
    v_mov_b32 v6, s66
    v_lshlrev_b32 v6, 8, v6
    s_lshl_b32 s64, s65, 2
    s_add_u32 s64, s64, 0
    v_mov_b32 v7, 1
    s_mov_b64 exec, 0x1
    buffer_store_dword v7, v6, s[20:23], s64 offen sc1
    s_mov_b64 exec, -1
    s_sub_u32 s67, s30, 864
    s_cmp_ge_u32 s67, 128
    s_cbranch_scc1 gated_mix__ssm_conv_s4d__mixer_gmlp__prompt_kernel_Cnk2
    s_add_u32 s67, s67, 448
    v_mov_b32 v212, v12
    v_mov_b32 v213, v13
    v_mov_b32 v214, v14
    v_mov_b32 v4, v24
    v_mov_b32 v5, v25
    v_mov_b32 v6, v26
    v_mov_b32 v7, v27
    v_mov_b32 v8, v28
    s_getpc_b64 s[64:65]
gated_mix__ssm_conv_s4d__mixer_gmlp__prompt_kernel_Chpb:
    s_add_u32 s64, s64, gated_mix__ssm_conv_s4d__mixer_gmlp__prompt_kernel_Chelp-gated_mix__ssm_conv_s4d__mixer_gmlp__prompt_kernel_Chpb
    s_addc_u32 s65, s65, 0
    s_swappc_b64 s[70:71], s[64:65]
    v_mov_b32 v12, v212
    v_mov_b32 v13, v213
    v_mov_b32 v14, v214
    s_waitcnt vmcnt(0)
    s_lshr_b32 s65, s67, 2
    s_and_b32 s66, s65, 15
    s_lshl_b32 s66, s66, 4
    s_lshr_b32 s65, s65, 4
    s_add_u32 s66, s66, s65
    s_and_b32 s65, s67, 3
    s_add_u32 s65, s65, 16
    v_mov_b32 v6, s66
    v_lshlrev_b32 v6, 8, v6
    s_lshl_b32 s64, s65, 2
    s_add_u32 s64, s64, 0
    v_mov_b32 v7, 1
    s_mov_b64 exec, 0x1
    buffer_store_dword v7, v6, s[20:23], s64 offen sc1
    s_mov_b64 exec, -1
    s_branch gated_mix__ssm_conv_s4d__mixer_gmlp__prompt_kernel_Cnk2
gated_mix__ssm_conv_s4d__mixer_gmlp__prompt_kernel_Cnk4:
    v_mov_b32 v212, v12
    v_mov_b32 v213, v13
    v_mov_b32 v214, v14
    v_mov_b32 v4, v24
    v_mov_b32 v5, v25
    v_mov_b32 v6, v26
    v_mov_b32 v7, v27
    v_mov_b32 v8, v28
    s_sub_u32 s1, s0, 640
    v_lshlrev_b32 v20, 16, v8
    v_lshlrev_b32 v12, 16, v4
    v_and_b32 v13, 0xffff0000, v4
    v_lshlrev_b32 v14, 16, v5
    v_and_b32 v15, 0xffff0000, v5
    v_lshlrev_b32 v16, 16, v6
    v_and_b32 v18, 0xffff0000, v6
    v_lshlrev_b32 v17, 16, v7
    v_and_b32 v19, 0xffff0000, v7
    v_mov_b32 v23, 0x3fb8aa3b
    v_mov_b32 v24, 0x32a57060
    v_max_f32 v25, abs(v16), abs(v17)
    v_mul_f32 v48, v20, v23
    v_mul_f32 v51, v12, v23
    v_mul_f32 v54, v13, v23
    v_max3_f32 v25, v25, abs(v18), abs(v19)
    v_fma_f32 v49, v20, v23, -v48
    v_fma_f32 v52, v12, v23, -v51
    v_fma_f32 v55, v13, v23, -v54
    v_max_f32_dpp v25, v25, v25 row_ror:8 row_mask:0xf bank_mask:0xf
    v_fmac_f32 v49, v20, v24
    v_fmac_f32 v52, v12, v24
    v_fmac_f32 v55, v13, v24
    v_max_f32_dpp v25, v25, v25 row_ror:4 row_mask:0xf bank_mask:0xf
    v_rndne_f32 v50, v48
    v_rndne_f32 v53, v51
    v_rndne_f32 v56, v54
    v_max_f32_dpp v25, v25, v25 row_ror:2 row_mask:0xf bank_mask:0xf
    v_sub_f32 v48, v48, v50
    v_sub_f32 v51, v51, v53
    v_sub_f32 v54, v54, v56
    v_max_f32_dpp v25, v25, v25 row_ror:1 row_mask:0xf bank_mask:0xf
    v_add_f32 v48, v48, v49
    v_add_f32 v51, v51, v52
    v_add_f32 v54, v54, v55
    v_mov_b32 v26, v25
    v_exp_f32 v48, v48
    v_exp_f32 v51, v51
    v_exp_f32 v54, v54
    v_permlane16_swap_b32 v25, v26
    v_cvt_i32_f32 v50, v50
    v_cvt_i32_f32 v53, v53
    v_cvt_i32_f32 v56, v56
    v_max_f32 v25, v25, v26
    v_ldexp_f32 v20, v48, v50
    v_ldexp_f32 v12, v51, v53
    v_ldexp_f32 v13, v54, v56
    v_mov_b32 v26, v25
    v_cvt_pk_bf16_f32 v20, v20, v20
    v_cvt_pk_bf16_f32 v12, v12, v12
    v_cvt_pk_bf16_f32 v13, v13, v13
    v_permlane32_swap_b32 v25, v26
    v_and_b32 v20, 0xffff0000, v20
    v_and_b32 v12, 0xffff0000, v12
    v_and_b32 v13, 0xffff0000, v13
    v_max_f32 v25, v25, v26
    v_mul_f32 v12, v12, v20
    v_mul_f32 v14, v14, v20
    v_mul_f32 v12, 0xbfb8aa3b, v12
    v_mul_f32 v13, v13, v20
    v_mul_f32 v15, v15, v20
    v_mul_f32 v13, 0xbfb8aa3b, v13
    v_and_b32 v25, 0x7f800000, v25
    v_max_u32 v25, 0x00800000, v25
    v_min_u32 v25, 0x7e800000, v25
    v_sub_u32 v26, 0x7f000000, v25
    v_mul_f32 v16, v16, v26
    v_mul_f32 v17, v17, v26
    v_mul_f32 v18, v18, v26
    v_mul_f32 v19, v19, v26
    v_mul_f32 v22, v25, v20
    v_add_f32 v22, v22, v22
    v_mov_b32 v23, 0x3e22f983
    v_mov_b32 v24, 0x31dc9c88
    v_mul_f32 v48, 0x40000000, v12
    v_mul_f32 v52, 0x40000000, v13
    v_mul_f32 v49, 0x40000000, v14
    v_mul_f32 v53, 0x40000000, v15
    v_exp_f32 v48, v48
    v_exp_f32 v52, v52
    v_mul_f32 v50, v49, v23
    v_mul_f32 v54, v53, v23
    v_fma_f32 v51, v49, v23, -v50
    v_fma_f32 v55, v53, v23, -v54
    v_fmac_f32 v51, v49, v24
    v_fmac_f32 v55, v53, v24
    v_fract_f32 v50, v50
    v_fract_f32 v54, v54
    v_add_f32 v50, v50, v51
    v_add_f32 v54, v54, v55
    v_cos_f32 v49, v50
    v_cos_f32 v53, v54
    v_sin_f32 v51, v50
    v_sin_f32 v55, v54
    v_mul_f32 v40, v48, v49
    v_mul_f32 v42, v52, v53
    v_mul_f32 v41, v48, v51
    v_mul_f32 v43, v52, v55
    v_mul_f32 v48, 0x41000000, v12
    v_mul_f32 v52, 0x41000000, v13
    v_mul_f32 v49, 0xc1000000, v14
    v_mul_f32 v53, 0xc1000000, v15
    v_exp_f32 v48, v48
    v_exp_f32 v52, v52
    v_mul_f32 v50, v49, v23
    v_mul_f32 v54, v53, v23
    v_fma_f32 v51, v49, v23, -v50
    v_fma_f32 v55, v53, v23, -v54
    v_fmac_f32 v51, v49, v24
    v_fmac_f32 v55, v53, v24
    v_fract_f32 v50, v50
    v_fract_f32 v54, v54
    v_add_f32 v50, v50, v51
    v_add_f32 v54, v54, v55
    v_cos_f32 v49, v50
    v_cos_f32 v53, v54
    v_sin_f32 v51, v50
    v_sin_f32 v55, v54
    v_mul_f32 v32, v48, v49
    v_mul_f32 v34, v52, v53
    v_mul_f32 v33, v48, v51
    v_mul_f32 v35, v52, v55
    v_mul_f32 v48, 0x43000000, v12
    v_mul_f32 v52, 0x43000000, v13
    v_mul_f32 v49, 0x43000000, v14
    v_mul_f32 v53, 0x43000000, v15
    v_exp_f32 v48, v48
    v_exp_f32 v52, v52
    v_mul_f32 v50, v49, v23
    v_mul_f32 v54, v53, v23
    v_fma_f32 v51, v49, v23, -v50
    v_fma_f32 v55, v53, v23, -v54
    v_fmac_f32 v51, v49, v24
    v_fmac_f32 v55, v53, v24
    v_fract_f32 v50, v50
    v_fract_f32 v54, v54
    v_add_f32 v50, v50, v51
    v_add_f32 v54, v54, v55
    v_cos_f32 v49, v50
    v_cos_f32 v53, v54
    v_sin_f32 v51, v50
    v_sin_f32 v55, v54
    v_mul_f32 v36, v48, v49
    v_mul_f32 v38, v52, v53
    v_mul_f32 v37, v48, v51
    v_mul_f32 v39, v52, v55
    v_lshlrev_b32 v2, 3, v0
    v_add_u32 v2, s1, v2
    v_and_b32 v4, 15, v0
    v_lshrrev_b32 v5, 4, v0
    v_and_b32 v3, 7, v0
    v_mul_u32_u24 v3, 528, v3
    v_lshl_add_u32 v3, v5, 4, v3
    v_add_u32 v3, s1, v3
    v_pk_mul_f32 v[52:53], v[40:41], v[40:41] op_sel:[0,0] op_sel_hi:[0,1]
    v_pk_mul_f32 v[54:55], v[42:43], v[42:43] op_sel:[0,0] op_sel_hi:[0,1]
    v_pk_fma_f32 v[44:45], v[40:41], v[40:41], v[52:53] op_sel:[1,1,0] op_sel_hi:[1,0,1] neg_lo:[0,1,0]
    v_pk_fma_f32 v[46:47], v[42:43], v[42:43], v[54:55] op_sel:[1,1,0] op_sel_hi:[1,0,1] neg_lo:[0,1,0]
    v_pk_mul_f32 v[52:53], v[16:17], v[36:37] op_sel:[0,0] op_sel_hi:[0,1]
    v_pk_mul_f32 v[54:55], v[18:19], v[38:39] op_sel:[0,0] op_sel_hi:[0,1]
    v_pk_fma_f32 v[16:17], v[16:17], v[36:37], v[52:53] op_sel:[1,1,0] op_sel_hi:[1,0,1] neg_lo:[0,1,0]
    v_pk_fma_f32 v[18:19], v[18:19], v[38:39], v[54:55] op_sel:[1,1,0] op_sel_hi:[1,0,1] neg_lo:[0,1,0]
    v_pk_mul_f32 v[52:53], v[16:17], v[36:37] op_sel:[0,0] op_sel_hi:[0,1]
    v_pk_mul_f32 v[54:55], v[18:19], v[38:39] op_sel:[0,0] op_sel_hi:[0,1]
    v_pk_fma_f32 v[16:17], v[16:17], v[36:37], v[52:53] op_sel:[1,1,0] op_sel_hi:[1,0,1] neg_lo:[0,1,0]
    v_pk_fma_f32 v[18:19], v[18:19], v[38:39], v[54:55] op_sel:[1,1,0] op_sel_hi:[1,0,1] neg_lo:[0,1,0]
    v_mov_b32 v160, 0
    v_mov_b32 v161, 0
    v_mov_b32 v162, 0
    v_mov_b32 v163, 0
    v_mov_b32 v164, 0
    v_mov_b32 v165, 0
    v_mov_b32 v166, 0
    v_mov_b32 v167, 0
    v_mov_b32 v168, 0
    v_mov_b32 v169, 0
    v_mov_b32 v170, 0
    v_mov_b32 v171, 0
    v_mov_b32 v48, 1.0
    v_mov_b32 v49, 0
    v_mov_b32 v50, 1.0
    v_mov_b32 v51, 0
    v_cvt_pk_f16_f32 v56, v48, v49
    v_cvt_pk_f16_f32 v57, v50, v51
    v_pk_mul_f32 v[52:53], v[48:49], v[32:33] op_sel:[0,0] op_sel_hi:[0,1]
    v_pk_mul_f32 v[54:55], v[50:51], v[34:35] op_sel:[0,0] op_sel_hi:[0,1]
    v_pk_fma_f32 v[48:49], v[48:49], v[32:33], v[52:53] op_sel:[1,1,0] op_sel_hi:[1,0,1] neg_lo:[0,1,0]
    v_pk_fma_f32 v[50:51], v[50:51], v[34:35], v[54:55] op_sel:[1,1,0] op_sel_hi:[1,0,1] neg_lo:[0,1,0]
    ds_write_b64 v2, v[56:57] offset:0
    v_cvt_pk_f16_f32 v58, v48, v49
    v_cvt_pk_f16_f32 v59, v50, v51
    v_pk_mul_f32 v[52:53], v[48:49], v[32:33] op_sel:[0,0] op_sel_hi:[0,1]
    v_pk_mul_f32 v[54:55], v[50:51], v[34:35] op_sel:[0,0] op_sel_hi:[0,1]
    v_pk_fma_f32 v[48:49], v[48:49], v[32:33], v[52:53] op_sel:[1,1,0] op_sel_hi:[1,0,1] neg_lo:[0,1,0]
    v_pk_fma_f32 v[50:51], v[50:51], v[34:35], v[54:55] op_sel:[1,1,0] op_sel_hi:[1,0,1] neg_lo:[0,1,0]
    ds_write_b64 v2, v[58:59] offset:528
    v_cvt_pk_f16_f32 v56, v48, v49
    v_cvt_pk_f16_f32 v57, v50, v51
    v_pk_mul_f32 v[52:53], v[48:49], v[32:33] op_sel:[0,0] op_sel_hi:[0,1]
    v_pk_mul_f32 v[54:55], v[50:51], v[34:35] op_sel:[0,0] op_sel_hi:[0,1]
    v_pk_fma_f32 v[48:49], v[48:49], v[32:33], v[52:53] op_sel:[1,1,0] op_sel_hi:[1,0,1] neg_lo:[0,1,0]
    v_pk_fma_f32 v[50:51], v[50:51], v[34:35], v[54:55] op_sel:[1,1,0] op_sel_hi:[1,0,1] neg_lo:[0,1,0]
    ds_write_b64 v2, v[56:57] offset:1056
    v_cvt_pk_f16_f32 v58, v48, v49
    v_cvt_pk_f16_f32 v59, v50, v51
    v_pk_mul_f32 v[52:53], v[48:49], v[32:33] op_sel:[0,0] op_sel_hi:[0,1]
    v_pk_mul_f32 v[54:55], v[50:51], v[34:35] op_sel:[0,0] op_sel_hi:[0,1]
    v_pk_fma_f32 v[48:49], v[48:49], v[32:33], v[52:53] op_sel:[1,1,0] op_sel_hi:[1,0,1] neg_lo:[0,1,0]
    v_pk_fma_f32 v[50:51], v[50:51], v[34:35], v[54:55] op_sel:[1,1,0] op_sel_hi:[1,0,1] neg_lo:[0,1,0]
    ds_write_b64 v2, v[58:59] offset:1584
    v_cvt_pk_f16_f32 v56, v48, v49
    v_cvt_pk_f16_f32 v57, v50, v51
    v_pk_mul_f32 v[52:53], v[48:49], v[32:33] op_sel:[0,0] op_sel_hi:[0,1]
    v_pk_mul_f32 v[54:55], v[50:51], v[34:35] op_sel:[0,0] op_sel_hi:[0,1]
    v_pk_fma_f32 v[48:49], v[48:49], v[32:33], v[52:53] op_sel:[1,1,0] op_sel_hi:[1,0,1] neg_lo:[0,1,0]
    v_pk_fma_f32 v[50:51], v[50:51], v[34:35], v[54:55] op_sel:[1,1,0] op_sel_hi:[1,0,1] neg_lo:[0,1,0]
    ds_write_b64 v2, v[56:57] offset:2112
    v_cvt_pk_f16_f32 v58, v48, v49
    v_cvt_pk_f16_f32 v59, v50, v51
    v_pk_mul_f32 v[52:53], v[48:49], v[32:33] op_sel:[0,0] op_sel_hi:[0,1]
    v_pk_mul_f32 v[54:55], v[50:51], v[34:35] op_sel:[0,0] op_sel_hi:[0,1]
    v_pk_fma_f32 v[48:49], v[48:49], v[32:33], v[52:53] op_sel:[1,1,0] op_sel_hi:[1,0,1] neg_lo:[0,1,0]
    v_pk_fma_f32 v[50:51], v[50:51], v[34:35], v[54:55] op_sel:[1,1,0] op_sel_hi:[1,0,1] neg_lo:[0,1,0]
    ds_write_b64 v2, v[58:59] offset:2640
    v_cvt_pk_f16_f32 v56, v48, v49
    v_cvt_pk_f16_f32 v57, v50, v51
    v_pk_mul_f32 v[52:53], v[48:49], v[32:33] op_sel:[0,0] op_sel_hi:[0,1]
    v_pk_mul_f32 v[54:55], v[50:51], v[34:35] op_sel:[0,0] op_sel_hi:[0,1]
    v_pk_fma_f32 v[48:49], v[48:49], v[32:33], v[52:53] op_sel:[1,1,0] op_sel_hi:[1,0,1] neg_lo:[0,1,0]
    v_pk_fma_f32 v[50:51], v[50:51], v[34:35], v[54:55] op_sel:[1,1,0] op_sel_hi:[1,0,1] neg_lo:[0,1,0]
    ds_write_b64 v2, v[56:57] offset:3168
    v_cvt_pk_f16_f32 v58, v48, v49
    v_cvt_pk_f16_f32 v59, v50, v51
    v_pk_mul_f32 v[52:53], v[48:49], v[32:33] op_sel:[0,0] op_sel_hi:[0,1]
    v_pk_mul_f32 v[54:55], v[50:51], v[34:35] op_sel:[0,0] op_sel_hi:[0,1]
    v_pk_fma_f32 v[48:49], v[48:49], v[32:33], v[52:53] op_sel:[1,1,0] op_sel_hi:[1,0,1] neg_lo:[0,1,0]
    v_pk_fma_f32 v[50:51], v[50:51], v[34:35], v[54:55] op_sel:[1,1,0] op_sel_hi:[1,0,1] neg_lo:[0,1,0]
    ds_write_b64 v2, v[58:59] offset:3696
    s_mov_b32 exec_lo, 0xff00ff
    s_mov_b32 exec_hi, 0xff00ff
    ds_read_b128 v[64:67], v3 offset:0
    ds_read_b128 v[68:71], v3 offset:64
    ds_read_b128 v[72:75], v3 offset:128
    ds_read_b128 v[76:79], v3 offset:192
    ds_read_b128 v[80:83], v3 offset:256
    ds_read_b128 v[84:87], v3 offset:320
    ds_read_b128 v[88:91], v3 offset:384
    ds_read_b128 v[92:95], v3 offset:448
    s_mov_b64 exec, -1
    v_cvt_pk_f16_f32 v56, v48, v49
    v_cvt_pk_f16_f32 v57, v50, v51
    v_pk_mul_f32 v[52:53], v[48:49], v[32:33] op_sel:[0,0] op_sel_hi:[0,1]
    v_pk_mul_f32 v[54:55], v[50:51], v[34:35] op_sel:[0,0] op_sel_hi:[0,1]
    v_pk_fma_f32 v[48:49], v[48:49], v[32:33], v[52:53] op_sel:[1,1,0] op_sel_hi:[1,0,1] neg_lo:[0,1,0]
    v_pk_fma_f32 v[50:51], v[50:51], v[34:35], v[54:55] op_sel:[1,1,0] op_sel_hi:[1,0,1] neg_lo:[0,1,0]
    ds_write_b64 v2, v[56:57] offset:0
    v_cvt_pk_f16_f32 v58, v48, v49
    v_cvt_pk_f16_f32 v59, v50, v51
    v_pk_mul_f32 v[52:53], v[48:49], v[32:33] op_sel:[0,0] op_sel_hi:[0,1]
    v_pk_mul_f32 v[54:55], v[50:51], v[34:35] op_sel:[0,0] op_sel_hi:[0,1]
    v_pk_fma_f32 v[48:49], v[48:49], v[32:33], v[52:53] op_sel:[1,1,0] op_sel_hi:[1,0,1] neg_lo:[0,1,0]
    v_pk_fma_f32 v[50:51], v[50:51], v[34:35], v[54:55] op_sel:[1,1,0] op_sel_hi:[1,0,1] neg_lo:[0,1,0]
    ds_write_b64 v2, v[58:59] offset:528
    v_cvt_pk_f16_f32 v56, v48, v49
    v_cvt_pk_f16_f32 v57, v50, v51
    v_pk_mul_f32 v[52:53], v[48:49], v[32:33] op_sel:[0,0] op_sel_hi:[0,1]
    v_pk_mul_f32 v[54:55], v[50:51], v[34:35] op_sel:[0,0] op_sel_hi:[0,1]
    v_pk_fma_f32 v[48:49], v[48:49], v[32:33], v[52:53] op_sel:[1,1,0] op_sel_hi:[1,0,1] neg_lo:[0,1,0]
    v_pk_fma_f32 v[50:51], v[50:51], v[34:35], v[54:55] op_sel:[1,1,0] op_sel_hi:[1,0,1] neg_lo:[0,1,0]
    ds_write_b64 v2, v[56:57] offset:1056
    v_cvt_pk_f16_f32 v58, v48, v49
    v_cvt_pk_f16_f32 v59, v50, v51
    v_pk_mul_f32 v[52:53], v[48:49], v[32:33] op_sel:[0,0] op_sel_hi:[0,1]
    v_pk_mul_f32 v[54:55], v[50:51], v[34:35] op_sel:[0,0] op_sel_hi:[0,1]
    v_pk_fma_f32 v[48:49], v[48:49], v[32:33], v[52:53] op_sel:[1,1,0] op_sel_hi:[1,0,1] neg_lo:[0,1,0]
    v_pk_fma_f32 v[50:51], v[50:51], v[34:35], v[54:55] op_sel:[1,1,0] op_sel_hi:[1,0,1] neg_lo:[0,1,0]
    ds_write_b64 v2, v[58:59] offset:1584
    v_cvt_pk_f16_f32 v56, v48, v49
    v_cvt_pk_f16_f32 v57, v50, v51
    v_pk_mul_f32 v[52:53], v[48:49], v[32:33] op_sel:[0,0] op_sel_hi:[0,1]
    v_pk_mul_f32 v[54:55], v[50:51], v[34:35] op_sel:[0,0] op_sel_hi:[0,1]
    v_pk_fma_f32 v[48:49], v[48:49], v[32:33], v[52:53] op_sel:[1,1,0] op_sel_hi:[1,0,1] neg_lo:[0,1,0]
    v_pk_fma_f32 v[50:51], v[50:51], v[34:35], v[54:55] op_sel:[1,1,0] op_sel_hi:[1,0,1] neg_lo:[0,1,0]
    ds_write_b64 v2, v[56:57] offset:2112
    v_cvt_pk_f16_f32 v58, v48, v49
    v_cvt_pk_f16_f32 v59, v50, v51
    v_pk_mul_f32 v[52:53], v[48:49], v[32:33] op_sel:[0,0] op_sel_hi:[0,1]
    v_pk_mul_f32 v[54:55], v[50:51], v[34:35] op_sel:[0,0] op_sel_hi:[0,1]
    v_pk_fma_f32 v[48:49], v[48:49], v[32:33], v[52:53] op_sel:[1,1,0] op_sel_hi:[1,0,1] neg_lo:[0,1,0]
    v_pk_fma_f32 v[50:51], v[50:51], v[34:35], v[54:55] op_sel:[1,1,0] op_sel_hi:[1,0,1] neg_lo:[0,1,0]
    ds_write_b64 v2, v[58:59] offset:2640
    v_cvt_pk_f16_f32 v56, v48, v49
    v_cvt_pk_f16_f32 v57, v50, v51
    v_pk_mul_f32 v[52:53], v[48:49], v[32:33] op_sel:[0,0] op_sel_hi:[0,1]
    v_pk_mul_f32 v[54:55], v[50:51], v[34:35] op_sel:[0,0] op_sel_hi:[0,1]
    v_pk_fma_f32 v[48:49], v[48:49], v[32:33], v[52:53] op_sel:[1,1,0] op_sel_hi:[1,0,1] neg_lo:[0,1,0]
    v_pk_fma_f32 v[50:51], v[50:51], v[34:35], v[54:55] op_sel:[1,1,0] op_sel_hi:[1,0,1] neg_lo:[0,1,0]
    ds_write_b64 v2, v[56:57] offset:3168
    v_cvt_pk_f16_f32 v58, v48, v49
    v_cvt_pk_f16_f32 v59, v50, v51
    ds_write_b64 v2, v[58:59] offset:3696
    s_mov_b32 exec_lo, 0xff00ff00
    s_mov_b32 exec_hi, 0xff00ff00
    ds_read_b128 v[64:67], v3 offset:0
    ds_read_b128 v[68:71], v3 offset:64
    ds_read_b128 v[72:75], v3 offset:128
    ds_read_b128 v[76:79], v3 offset:192
    ds_read_b128 v[80:83], v3 offset:256
    ds_read_b128 v[84:87], v3 offset:320
    ds_read_b128 v[88:91], v3 offset:384
    ds_read_b128 v[92:95], v3 offset:448
    s_mov_b64 exec, -1
    v_cvt_pk_f16_f32 v56, v16, v17
    v_cvt_pk_f16_f32 v57, v18, v19
    v_pk_mul_f32 v[52:53], v[16:17], v[40:41] op_sel:[0,0] op_sel_hi:[0,1]
    v_pk_mul_f32 v[54:55], v[18:19], v[42:43] op_sel:[0,0] op_sel_hi:[0,1]
    v_pk_fma_f32 v[48:49], v[16:17], v[40:41], v[52:53] op_sel:[1,1,0] op_sel_hi:[1,0,1] neg_lo:[0,1,0]
    v_pk_fma_f32 v[50:51], v[18:19], v[42:43], v[54:55] op_sel:[1,1,0] op_sel_hi:[1,0,1] neg_lo:[0,1,0]
    ds_write_b64 v2, v[56:57] offset:0
    v_cvt_pk_f16_f32 v58, v48, v49
    v_cvt_pk_f16_f32 v59, v50, v51
    v_pk_mul_f32 v[52:53], v[48:49], v[40:41] op_sel:[0,0] op_sel_hi:[0,1]
    v_pk_mul_f32 v[54:55], v[50:51], v[42:43] op_sel:[0,0] op_sel_hi:[0,1]
    v_pk_fma_f32 v[48:49], v[48:49], v[40:41], v[52:53] op_sel:[1,1,0] op_sel_hi:[1,0,1] neg_lo:[0,1,0]
    v_pk_fma_f32 v[50:51], v[50:51], v[42:43], v[54:55] op_sel:[1,1,0] op_sel_hi:[1,0,1] neg_lo:[0,1,0]
    ds_write_b64 v2, v[58:59] offset:528
    v_cvt_pk_f16_f32 v56, v48, v49
    v_cvt_pk_f16_f32 v57, v50, v51
    v_pk_mul_f32 v[52:53], v[48:49], v[40:41] op_sel:[0,0] op_sel_hi:[0,1]
    v_pk_mul_f32 v[54:55], v[50:51], v[42:43] op_sel:[0,0] op_sel_hi:[0,1]
    v_pk_fma_f32 v[48:49], v[48:49], v[40:41], v[52:53] op_sel:[1,1,0] op_sel_hi:[1,0,1] neg_lo:[0,1,0]
    v_pk_fma_f32 v[50:51], v[50:51], v[42:43], v[54:55] op_sel:[1,1,0] op_sel_hi:[1,0,1] neg_lo:[0,1,0]
    ds_write_b64 v2, v[56:57] offset:1056
    v_cvt_pk_f16_f32 v58, v48, v49
    v_cvt_pk_f16_f32 v59, v50, v51
    v_pk_mul_f32 v[52:53], v[16:17], v[36:37] op_sel:[0,0] op_sel_hi:[0,1]
    v_pk_mul_f32 v[54:55], v[18:19], v[38:39] op_sel:[0,0] op_sel_hi:[0,1]
    v_pk_fma_f32 v[16:17], v[16:17], v[36:37], v[52:53] op_sel:[1,1,0] op_sel_hi:[1,0,1] neg_lo:[0,1,0]
    v_pk_fma_f32 v[18:19], v[18:19], v[38:39], v[54:55] op_sel:[1,1,0] op_sel_hi:[1,0,1] neg_lo:[0,1,0]
    ds_write_b64 v2, v[58:59] offset:1584
    v_cvt_pk_f16_f32 v56, v16, v17
    v_cvt_pk_f16_f32 v57, v18, v19
    v_pk_mul_f32 v[52:53], v[16:17], v[40:41] op_sel:[0,0] op_sel_hi:[0,1]
    v_pk_mul_f32 v[54:55], v[18:19], v[42:43] op_sel:[0,0] op_sel_hi:[0,1]
    v_pk_fma_f32 v[48:49], v[16:17], v[40:41], v[52:53] op_sel:[1,1,0] op_sel_hi:[1,0,1] neg_lo:[0,1,0]
    v_pk_fma_f32 v[50:51], v[18:19], v[42:43], v[54:55] op_sel:[1,1,0] op_sel_hi:[1,0,1] neg_lo:[0,1,0]
    ds_write_b64 v2, v[56:57] offset:2112
    v_cvt_pk_f16_f32 v58, v48, v49
    v_cvt_pk_f16_f32 v59, v50, v51
    v_pk_mul_f32 v[52:53], v[48:49], v[40:41] op_sel:[0,0] op_sel_hi:[0,1]
    v_pk_mul_f32 v[54:55], v[50:51], v[42:43] op_sel:[0,0] op_sel_hi:[0,1]
    v_pk_fma_f32 v[48:49], v[48:49], v[40:41], v[52:53] op_sel:[1,1,0] op_sel_hi:[1,0,1] neg_lo:[0,1,0]
    v_pk_fma_f32 v[50:51], v[50:51], v[42:43], v[54:55] op_sel:[1,1,0] op_sel_hi:[1,0,1] neg_lo:[0,1,0]
    ds_write_b64 v2, v[58:59] offset:2640
    v_cvt_pk_f16_f32 v56, v48, v49
    v_cvt_pk_f16_f32 v57, v50, v51
    v_pk_mul_f32 v[52:53], v[48:49], v[40:41] op_sel:[0,0] op_sel_hi:[0,1]
    v_pk_mul_f32 v[54:55], v[50:51], v[42:43] op_sel:[0,0] op_sel_hi:[0,1]
    v_pk_fma_f32 v[48:49], v[48:49], v[40:41], v[52:53] op_sel:[1,1,0] op_sel_hi:[1,0,1] neg_lo:[0,1,0]
    v_pk_fma_f32 v[50:51], v[50:51], v[42:43], v[54:55] op_sel:[1,1,0] op_sel_hi:[1,0,1] neg_lo:[0,1,0]
    ds_write_b64 v2, v[56:57] offset:3168
    v_cvt_pk_f16_f32 v58, v48, v49
    v_cvt_pk_f16_f32 v59, v50, v51
    v_pk_mul_f32 v[52:53], v[16:17], v[36:37] op_sel:[0,0] op_sel_hi:[0,1]
    v_pk_mul_f32 v[54:55], v[18:19], v[38:39] op_sel:[0,0] op_sel_hi:[0,1]
    v_pk_fma_f32 v[16:17], v[16:17], v[36:37], v[52:53] op_sel:[1,1,0] op_sel_hi:[1,0,1] neg_lo:[0,1,0]
    v_pk_fma_f32 v[18:19], v[18:19], v[38:39], v[54:55] op_sel:[1,1,0] op_sel_hi:[1,0,1] neg_lo:[0,1,0]
    ds_write_b64 v2, v[58:59] offset:3696
    s_mov_b32 exec_lo, 0xff00ff
    s_mov_b32 exec_hi, 0xff00ff
    ds_read_b128 v[128:131], v3 offset:0
    ds_read_b128 v[132:135], v3 offset:64
    ds_read_b128 v[136:139], v3 offset:128
    ds_read_b128 v[140:143], v3 offset:192
    ds_read_b128 v[144:147], v3 offset:256
    ds_read_b128 v[148:151], v3 offset:320
    ds_read_b128 v[152:155], v3 offset:384
    ds_read_b128 v[156:159], v3 offset:448
    s_mov_b64 exec, -1
    v_cvt_pk_f16_f32 v56, v16, v17
    v_cvt_pk_f16_f32 v57, v18, v19
    v_pk_mul_f32 v[52:53], v[16:17], v[44:45] op_sel:[0,0] op_sel_hi:[0,1]
    v_pk_mul_f32 v[54:55], v[18:19], v[46:47] op_sel:[0,0] op_sel_hi:[0,1]
    v_pk_fma_f32 v[48:49], v[16:17], v[44:45], v[52:53] op_sel:[1,1,0] op_sel_hi:[1,0,1] neg_lo:[0,1,0]
    v_pk_fma_f32 v[50:51], v[18:19], v[46:47], v[54:55] op_sel:[1,1,0] op_sel_hi:[1,0,1] neg_lo:[0,1,0]
    ds_write_b64 v2, v[56:57] offset:0
    v_cvt_pk_f16_f32 v58, v48, v49
    v_cvt_pk_f16_f32 v59, v50, v51
    v_pk_mul_f32 v[52:53], v[16:17], v[36:37] op_sel:[0,0] op_sel_hi:[0,1]
    v_pk_mul_f32 v[54:55], v[18:19], v[38:39] op_sel:[0,0] op_sel_hi:[0,1]
    v_pk_fma_f32 v[16:17], v[16:17], v[36:37], v[52:53] op_sel:[1,1,0] op_sel_hi:[1,0,1] neg_lo:[0,1,0]
    v_pk_fma_f32 v[18:19], v[18:19], v[38:39], v[54:55] op_sel:[1,1,0] op_sel_hi:[1,0,1] neg_lo:[0,1,0]
    ds_write_b64 v2, v[58:59] offset:528
    v_cvt_pk_f16_f32 v56, v16, v17
    v_cvt_pk_f16_f32 v57, v18, v19
    v_pk_mul_f32 v[52:53], v[16:17], v[44:45] op_sel:[0,0] op_sel_hi:[0,1]
    v_pk_mul_f32 v[54:55], v[18:19], v[46:47] op_sel:[0,0] op_sel_hi:[0,1]
    v_pk_fma_f32 v[48:49], v[16:17], v[44:45], v[52:53] op_sel:[1,1,0] op_sel_hi:[1,0,1] neg_lo:[0,1,0]
    v_pk_fma_f32 v[50:51], v[18:19], v[46:47], v[54:55] op_sel:[1,1,0] op_sel_hi:[1,0,1] neg_lo:[0,1,0]
    ds_write_b64 v2, v[56:57] offset:1056
    v_cvt_pk_f16_f32 v58, v48, v49
    v_cvt_pk_f16_f32 v59, v50, v51
    v_pk_mul_f32 v[52:53], v[16:17], v[36:37] op_sel:[0,0] op_sel_hi:[0,1]
    v_pk_mul_f32 v[54:55], v[18:19], v[38:39] op_sel:[0,0] op_sel_hi:[0,1]
    v_pk_fma_f32 v[16:17], v[16:17], v[36:37], v[52:53] op_sel:[1,1,0] op_sel_hi:[1,0,1] neg_lo:[0,1,0]
    v_pk_fma_f32 v[18:19], v[18:19], v[38:39], v[54:55] op_sel:[1,1,0] op_sel_hi:[1,0,1] neg_lo:[0,1,0]
    ds_write_b64 v2, v[58:59] offset:1584
    v_cvt_pk_f16_f32 v56, v16, v17
    v_cvt_pk_f16_f32 v57, v18, v19
    v_pk_mul_f32 v[52:53], v[16:17], v[44:45] op_sel:[0,0] op_sel_hi:[0,1]
    v_pk_mul_f32 v[54:55], v[18:19], v[46:47] op_sel:[0,0] op_sel_hi:[0,1]
    v_pk_fma_f32 v[48:49], v[16:17], v[44:45], v[52:53] op_sel:[1,1,0] op_sel_hi:[1,0,1] neg_lo:[0,1,0]
    v_pk_fma_f32 v[50:51], v[18:19], v[46:47], v[54:55] op_sel:[1,1,0] op_sel_hi:[1,0,1] neg_lo:[0,1,0]
    ds_write_b64 v2, v[56:57] offset:2112
    v_cvt_pk_f16_f32 v58, v48, v49
    v_cvt_pk_f16_f32 v59, v50, v51
    v_pk_mul_f32 v[52:53], v[16:17], v[36:37] op_sel:[0,0] op_sel_hi:[0,1]
    v_pk_mul_f32 v[54:55], v[18:19], v[38:39] op_sel:[0,0] op_sel_hi:[0,1]
    v_pk_fma_f32 v[16:17], v[16:17], v[36:37], v[52:53] op_sel:[1,1,0] op_sel_hi:[1,0,1] neg_lo:[0,1,0]
    v_pk_fma_f32 v[18:19], v[18:19], v[38:39], v[54:55] op_sel:[1,1,0] op_sel_hi:[1,0,1] neg_lo:[0,1,0]
    ds_write_b64 v2, v[58:59] offset:2640
    v_cvt_pk_f16_f32 v56, v16, v17
    v_cvt_pk_f16_f32 v57, v18, v19
    v_pk_mul_f32 v[52:53], v[16:17], v[44:45] op_sel:[0,0] op_sel_hi:[0,1]
    v_pk_mul_f32 v[54:55], v[18:19], v[46:47] op_sel:[0,0] op_sel_hi:[0,1]
    v_pk_fma_f32 v[48:49], v[16:17], v[44:45], v[52:53] op_sel:[1,1,0] op_sel_hi:[1,0,1] neg_lo:[0,1,0]
    v_pk_fma_f32 v[50:51], v[18:19], v[46:47], v[54:55] op_sel:[1,1,0] op_sel_hi:[1,0,1] neg_lo:[0,1,0]
    ds_write_b64 v2, v[56:57] offset:3168
    v_cvt_pk_f16_f32 v58, v48, v49
    v_cvt_pk_f16_f32 v59, v50, v51
    ds_write_b64 v2, v[58:59] offset:3696
    s_mov_b32 exec_lo, 0xff00ff00
    s_mov_b32 exec_hi, 0xff00ff00
    ds_read_b128 v[128:131], v3 offset:0
    ds_read_b128 v[132:135], v3 offset:64
    ds_read_b128 v[136:139], v3 offset:128
    ds_read_b128 v[140:143], v3 offset:192
    ds_read_b128 v[144:147], v3 offset:256
    ds_read_b128 v[148:151], v3 offset:320
    ds_read_b128 v[152:155], v3 offset:384
    ds_read_b128 v[156:159], v3 offset:448
    s_mov_b64 exec, -1
    s_waitcnt lgkmcnt(0)
    v_mfma_f32_16x16x32_f16 v[164:167], v[128:131], v[64:67], v[164:167]
    v_mfma_f32_16x16x32_f16 v[164:167], v[132:135], v[68:71], v[164:167]
    v_mfma_f32_16x16x32_f16 v[164:167], v[136:139], v[72:75], v[164:167]
    v_mfma_f32_16x16x32_f16 v[164:167], v[140:143], v[76:79], v[164:167]
    v_mfma_f32_16x16x32_f16 v[164:167], v[144:147], v[80:83], v[164:167]
    v_mfma_f32_16x16x32_f16 v[164:167], v[148:151], v[84:87], v[164:167]
    v_mfma_f32_16x16x32_f16 v[164:167], v[152:155], v[88:91], v[164:167]
    v_mfma_f32_16x16x32_f16 v[164:167], v[156:159], v[92:95], v[164:167]
    v_lshlrev_b32 v8, 4, v4
    v_sub_u32 v8, s0, v8
    v_lshlrev_b32 v9, 10, v5
    v_sub_u32 v9, v8, v9
    v_lshlrev_b32 v10, 9, v5
    v_sub_u32 v10, v8, v10
    v_lshlrev_b32 v11, 8, v5
    v_sub_u32 v11, v8, v11
    v_lshrrev_b32 v6, 1, v5
    v_lshlrev_b32 v6, 8, v6
    v_and_b32 v7, 1, v5
    v_lshl_add_u32 v6, v7, 3, v6
    v_sub_u32 v8, v8, v6
    v_mul_f32 v164, v164, v22
    v_mul_f32 v165, v165, v22
    v_mul_f32 v166, v166, v22
    v_mul_f32 v167, v167, v22
    v_cvt_pk_bf16_f32 v75, v165, v165
    v_cvt_pk_bf16_f32 v72, v165, v164
    v_cvt_pk_bf16_f32 v73, v164, v164
    v_cvt_pk_bf16_f32 v79, v167, v167
    v_cvt_pk_bf16_f32 v76, v167, v166
    v_cvt_pk_bf16_f32 v77, v166, v166
    s_mov_b32 exec_lo, 0
    s_mov_b32 exec_hi, -1
    ds_write_b32 v10, v75 offset:4108
    ds_write_b64 v10, v[72:73] offset:4112
    ds_write_b32 v10, v73 offset:4120
    ds_write_b32 v10, v79 offset:3852
    ds_write_b64 v10, v[76:77] offset:3856
    ds_write_b32 v10, v77 offset:3864
    s_mov_b64 exec, -1
    v_cvt_pk_bf16_f32 v80, v167, v167
    v_cvt_pk_bf16_f32 v81, v166, v166
    v_cvt_pk_bf16_f32 v82, v166, v165
    v_cvt_pk_bf16_f32 v83, v164, v164
    s_mov_b64 exec, 0xffffffff
    ds_write_b16 v11, v80 offset:3594
    ds_write_b32 v11, v81 offset:3596
    ds_write_b64 v11, v[82:83] offset:3600
    s_mov_b32 exec_lo, 0xfffffffe
    ds_write_b16 v11, v83 offset:3608
    s_mov_b64 exec, -1
    v_mov_b32 v12, v212
    v_mov_b32 v13, v213
    v_mov_b32 v14, v214
gated_mix__ssm_conv_s4d__mixer_gmlp__prompt_kernel_Cnk2:
    v_lshlrev_b32 v10, 4, v0
    v_add_u32 v176, 0, v10
    v_add_u32 v180, 0, v14
    v_xor_b32 v181, 64, v180
    v_add_u32 v177, 34816, v10
    v_add_u32 v182, 34816, v14
    v_xor_b32 v183, 64, v182
    v_add_u32 v178, 69632, v10
    v_add_u32 v184, 69632, v14
    v_xor_b32 v185, 64, v184
    v_add_u32 v179, 104448, v10
    v_add_u32 v186, 104448, v14
    v_xor_b32 v187, 64, v186
    s_lshl_b32 s64, s27, 1
    s_lshr_b32 s65, s25, 1
    s_add_u32 s64, s64, s65
    s_mul_i32 s64, s64, 294912
    s_and_b32 s65, s25, 1
    s_lshl_b32 s65, s65, 11
    s_add_u32 s64, s64, s65
    s_add_u32 s64, s64, 18874368
    s_add_u32 s16, s62, s64
    s_addc_u32 s17, s63, 0
    s_mov_b32 s18, 294912
    s_mov_b32 s19, 0x20000
    v_lshlrev_b32 v12, 16, v12
    v_lshlrev_b32 v13, 16, v13
    v_mov_b32 v16, v12
    v_mov_b32 v17, v12
    v_mov_b32 v18, v12
    v_mov_b32 v19, v12
    v_mov_b32 v20, v13
    v_mov_b32 v21, v13
    v_mov_b32 v22, v13
    v_mov_b32 v23, v13
    v_mov_b32 v24, v12
    v_mov_b32 v25, v12
    v_mov_b32 v26, v12
    v_mov_b32 v27, v12
    v_mov_b32 v28, v13
    v_mov_b32 v29, v13
    v_mov_b32 v30, v13
    v_mov_b32 v31, v13
    v_mov_b32 v32, v12
    v_mov_b32 v33, v12
    v_mov_b32 v34, v12
    v_mov_b32 v35, v12
    v_mov_b32 v36, v13
    v_mov_b32 v37, v13
    v_mov_b32 v38, v13
    v_mov_b32 v39, v13
    v_mov_b32 v40, v12
    v_mov_b32 v41, v12
    v_mov_b32 v42, v12
    v_mov_b32 v43, v12
    v_mov_b32 v44, v13
    v_mov_b32 v45, v13
    v_mov_b32 v46, v13
    v_mov_b32 v47, v13
    v_mov_b32 v48, v12
    v_mov_b32 v49, v12
    v_mov_b32 v50, v12
    v_mov_b32 v51, v12
    v_mov_b32 v52, v13
    v_mov_b32 v53, v13
    v_mov_b32 v54, v13
    v_mov_b32 v55, v13
    v_mov_b32 v56, v12
    v_mov_b32 v57, v12
    v_mov_b32 v58, v12
    v_mov_b32 v59, v12
    v_mov_b32 v60, v13
    v_mov_b32 v61, v13
    v_mov_b32 v62, v13
    v_mov_b32 v63, v13
    v_mov_b32 v64, v12
    v_mov_b32 v65, v12
    v_mov_b32 v66, v12
    v_mov_b32 v67, v12
    v_mov_b32 v68, v13
    v_mov_b32 v69, v13
    v_mov_b32 v70, v13
    v_mov_b32 v71, v13
    v_mov_b32 v72, v12
    v_mov_b32 v73, v12
    v_mov_b32 v74, v12
    v_mov_b32 v75, v12
    v_mov_b32 v76, v13
    v_mov_b32 v77, v13
    v_mov_b32 v78, v13
    v_mov_b32 v79, v13
    v_mov_b32 v80, v12
    v_mov_b32 v81, v12
    v_mov_b32 v82, v12
    v_mov_b32 v83, v12
    v_mov_b32 v84, v13
    v_mov_b32 v85, v13
    v_mov_b32 v86, v13
    v_mov_b32 v87, v13
    v_mov_b32 v15, 0xbdd2d3e8
    s_mov_b32 s70, 0
    v_mov_b32 v252, 0
    v_mov_b32 v253, 0
    v_mov_b32 v254, 0
    v_mov_b32 v255, 0
    s_waitcnt lgkmcnt(0)
    s_barrier
    ds_read_b128 v[88:91], v184 offset:0
    ds_read_b128 v[96:99], v178 offset:0
    ds_read_b128 v[92:95], v184 offset:2048
    ds_read_b128 v[100:103], v178 offset:1024
    ds_read_b128 v[104:107], v178 offset:2048
    ds_read_b128 v[108:111], v178 offset:3072
    ds_read_b128 v[112:115], v178 offset:4096
    ds_read_b128 v[116:119], v178 offset:5120
    ds_read_b128 v[120:123], v178 offset:6144
    ds_read_b128 v[124:127], v178 offset:7168
    ds_read_b128 v[128:131], v178 offset:8192
    s_mov_b32 s71, 8
.p2align 6
gated_mix__ssm_conv_s4d__mixer_gmlp__prompt_kernel_g2:
    s_waitcnt lgkmcnt(0)
    v_mfma_f32_16x16x32_bf16 v[16:19], v[96:99], v[88:91], v[16:19]
    ds_read_b128 v[132:135], v185 offset:0
    v_mfma_f32_16x16x32_bf16 v[20:23], v[96:99], v[92:95], v[20:23]
    ds_read_b128 v[140:143], v178 offset:9216
    v_mfma_f32_16x16x32_bf16 v[28:31], v[100:103], v[92:95], v[28:31]
    ds_read_b128 v[136:139], v185 offset:2048
    v_mfma_f32_16x16x32_bf16 v[24:27], v[100:103], v[88:91], v[24:27]
    ds_read_b128 v[144:147], v178 offset:10240
    v_mfma_f32_16x16x32_bf16 v[32:35], v[104:107], v[88:91], v[32:35]
    ds_read_b128 v[148:151], v178 offset:11264
    v_mfma_f32_16x16x32_bf16 v[36:39], v[104:107], v[92:95], v[36:39]
    ds_read_b128 v[152:155], v178 offset:12288
    v_mfma_f32_16x16x32_bf16 v[44:47], v[108:111], v[92:95], v[44:47]
    ds_read_b128 v[156:159], v178 offset:13312
    v_mfma_f32_16x16x32_bf16 v[40:43], v[108:111], v[88:91], v[40:43]
    ds_read_b128 v[160:163], v178 offset:14336
    v_mfma_f32_16x16x32_bf16 v[48:51], v[112:115], v[88:91], v[48:51]
    ds_read_b128 v[164:167], v178 offset:15360
    v_mfma_f32_16x16x32_bf16 v[52:55], v[112:115], v[92:95], v[52:55]
    ds_read_b128 v[168:171], v178 offset:16384
    v_mfma_f32_16x16x32_bf16 v[60:63], v[116:119], v[92:95], v[60:63]
    ds_read_b128 v[172:175], v178 offset:17408
    v_mfma_f32_16x16x32_bf16 v[56:59], v[116:119], v[88:91], v[56:59]
    s_set_gpr_idx_on s70, 0x1
    s_nop 0
    v_mov_b32 v188, v216
    v_mov_b32 v189, v217
    v_mov_b32 v190, v218
    v_mov_b32 v191, v219
    v_mov_b32 v192, v220
    s_set_gpr_idx_off
    v_mfma_f32_16x16x32_bf16 v[64:67], v[120:123], v[88:91], v[64:67]
    v_lshlrev_b32 v193, 16, v188
    v_and_b32 v194, 0xffff0000, v188
    v_mfma_f32_16x16x32_bf16 v[68:71], v[120:123], v[92:95], v[68:71]
    v_lshlrev_b32 v195, 16, v189
    v_and_b32 v196, 0xffff0000, v189
    v_mfma_f32_16x16x32_bf16 v[76:79], v[124:127], v[92:95], v[76:79]
    v_lshlrev_b32 v197, 16, v190
    v_and_b32 v198, 0xffff0000, v190
    v_mfma_f32_16x16x32_bf16 v[72:75], v[124:127], v[88:91], v[72:75]
    v_lshlrev_b32 v199, 16, v191
    v_and_b32 v200, 0xffff0000, v191
    v_mfma_f32_16x16x32_bf16 v[80:83], v[128:131], v[88:91], v[80:83]
    v_lshlrev_b32 v201, 16, v192
    v_and_b32 v202, 0xffff0000, v192
    v_mfma_f32_16x16x32_bf16 v[84:87], v[128:131], v[92:95], v[84:87]
    v_mul_f32 v203, v193, v193
    v_mul_f32 v204, v194, v194
    s_waitcnt lgkmcnt(0)
    s_barrier
    v_mfma_f32_16x16x32_bf16 v[16:19], v[140:143], v[132:135], v[16:19]
    ds_read_b128 v[88:91], v186 offset:0
    v_mfma_f32_16x16x32_bf16 v[20:23], v[140:143], v[136:139], v[20:23]
    ds_read_b128 v[96:99], v179 offset:0
    v_mfma_f32_16x16x32_bf16 v[28:31], v[144:147], v[136:139], v[28:31]
    ds_read_b128 v[92:95], v186 offset:2048
    v_mfma_f32_16x16x32_bf16 v[24:27], v[144:147], v[132:135], v[24:27]
    ds_read_b128 v[100:103], v179 offset:1024
    v_mfma_f32_16x16x32_bf16 v[32:35], v[148:151], v[132:135], v[32:35]
    ds_read_b128 v[104:107], v179 offset:2048
    v_mfma_f32_16x16x32_bf16 v[36:39], v[148:151], v[136:139], v[36:39]
    ds_read_b128 v[108:111], v179 offset:3072
    v_mfma_f32_16x16x32_bf16 v[44:47], v[152:155], v[136:139], v[44:47]
    ds_read_b128 v[112:115], v179 offset:4096
    v_mfma_f32_16x16x32_bf16 v[40:43], v[152:155], v[132:135], v[40:43]
    ds_read_b128 v[116:119], v179 offset:5120
    v_mfma_f32_16x16x32_bf16 v[48:51], v[156:159], v[132:135], v[48:51]
    ds_read_b128 v[120:123], v179 offset:6144
    v_mfma_f32_16x16x32_bf16 v[52:55], v[156:159], v[136:139], v[52:55]
    ds_read_b128 v[124:127], v179 offset:7168
    v_mfma_f32_16x16x32_bf16 v[60:63], v[160:163], v[136:139], v[60:63]
    ds_read_b128 v[128:131], v179 offset:8192
    v_mfma_f32_16x16x32_bf16 v[56:59], v[160:163], v[132:135], v[56:59]
    v_mul_f32 v205, v195, v195
    v_mul_f32 v206, v196, v196
    v_mfma_f32_16x16x32_bf16 v[64:67], v[164:167], v[132:135], v[64:67]
    v_mul_f32 v207, v197, v197
    v_mul_f32 v208, v198, v198
    v_mfma_f32_16x16x32_bf16 v[68:71], v[164:167], v[136:139], v[68:71]
    v_mul_f32 v209, v199, v199
    v_mul_f32 v210, v200, v200
    v_mfma_f32_16x16x32_bf16 v[76:79], v[168:171], v[136:139], v[76:79]
    v_mul_f32 v211, v201, v201
    v_mul_f32 v212, v202, v202
    v_mfma_f32_16x16x32_bf16 v[72:75], v[168:171], v[132:135], v[72:75]
    v_fmaak_f32 v203, v203, v15, 0xc0135761
    v_fmaak_f32 v204, v204, v15, 0xc0135761
    v_mfma_f32_16x16x32_bf16 v[80:83], v[172:175], v[132:135], v[80:83]
    v_fmaak_f32 v205, v205, v15, 0xc0135761
    v_fmaak_f32 v206, v206, v15, 0xc0135761
    v_mfma_f32_16x16x32_bf16 v[84:87], v[172:175], v[136:139], v[84:87]
    v_fmaak_f32 v207, v207, v15, 0xc0135761
    v_fmaak_f32 v208, v208, v15, 0xc0135761
    s_waitcnt lgkmcnt(0)
    v_mfma_f32_16x16x32_bf16 v[16:19], v[96:99], v[88:91], v[16:19]
    ds_read_b128 v[132:135], v187 offset:0
    v_mfma_f32_16x16x32_bf16 v[20:23], v[96:99], v[92:95], v[20:23]
    ds_read_b128 v[140:143], v179 offset:9216
    v_mfma_f32_16x16x32_bf16 v[28:31], v[100:103], v[92:95], v[28:31]
    ds_read_b128 v[136:139], v187 offset:2048
    v_mfma_f32_16x16x32_bf16 v[24:27], v[100:103], v[88:91], v[24:27]
    ds_read_b128 v[144:147], v179 offset:10240
    v_mfma_f32_16x16x32_bf16 v[32:35], v[104:107], v[88:91], v[32:35]
    ds_read_b128 v[148:151], v179 offset:11264
    v_mfma_f32_16x16x32_bf16 v[36:39], v[104:107], v[92:95], v[36:39]
    ds_read_b128 v[152:155], v179 offset:12288
    v_mfma_f32_16x16x32_bf16 v[44:47], v[108:111], v[92:95], v[44:47]
    ds_read_b128 v[156:159], v179 offset:13312
    v_mfma_f32_16x16x32_bf16 v[40:43], v[108:111], v[88:91], v[40:43]
    ds_read_b128 v[160:163], v179 offset:14336
    v_mfma_f32_16x16x32_bf16 v[48:51], v[112:115], v[88:91], v[48:51]
    ds_read_b128 v[164:167], v179 offset:15360
    v_mfma_f32_16x16x32_bf16 v[52:55], v[112:115], v[92:95], v[52:55]
    ds_read_b128 v[168:171], v179 offset:16384
    v_mfma_f32_16x16x32_bf16 v[60:63], v[116:119], v[92:95], v[60:63]
    ds_read_b128 v[172:175], v179 offset:17408
    v_mfma_f32_16x16x32_bf16 v[56:59], v[116:119], v[88:91], v[56:59]
    v_fmaak_f32 v209, v209, v15, 0xc0135761
    v_fmaak_f32 v210, v210, v15, 0xc0135761
    v_mfma_f32_16x16x32_bf16 v[64:67], v[120:123], v[88:91], v[64:67]
    v_fmaak_f32 v211, v211, v15, 0xc0135761
    v_fmaak_f32 v212, v212, v15, 0xc0135761
    v_mfma_f32_16x16x32_bf16 v[68:71], v[120:123], v[92:95], v[68:71]
    v_mul_f32 v203, v193, v203
    v_mul_f32 v204, v194, v204
    v_mfma_f32_16x16x32_bf16 v[76:79], v[124:127], v[92:95], v[76:79]
    v_mul_f32 v205, v195, v205
    v_mul_f32 v206, v196, v206
    v_mfma_f32_16x16x32_bf16 v[72:75], v[124:127], v[88:91], v[72:75]
    v_mul_f32 v207, v197, v207
    v_mul_f32 v208, v198, v208
    v_mfma_f32_16x16x32_bf16 v[80:83], v[128:131], v[88:91], v[80:83]
    v_mul_f32 v209, v199, v209
    v_mul_f32 v210, v200, v210
    v_mfma_f32_16x16x32_bf16 v[84:87], v[128:131], v[92:95], v[84:87]
    v_mul_f32 v211, v201, v211
    v_mul_f32 v212, v202, v212
    s_waitcnt lgkmcnt(0)
    s_barrier
    v_mfma_f32_16x16x32_bf16 v[16:19], v[140:143], v[132:135], v[16:19]
    ds_read_b128 v[88:91], v180 offset:0
    v_mfma_f32_16x16x32_bf16 v[20:23], v[140:143], v[136:139], v[20:23]
    ds_read_b128 v[96:99], v176 offset:0
    v_mfma_f32_16x16x32_bf16 v[28:31], v[144:147], v[136:139], v[28:31]
    ds_read_b128 v[92:95], v180 offset:2048
    v_mfma_f32_16x16x32_bf16 v[24:27], v[144:147], v[132:135], v[24:27]
    ds_read_b128 v[100:103], v176 offset:1024
    v_mfma_f32_16x16x32_bf16 v[32:35], v[148:151], v[132:135], v[32:35]
    ds_read_b128 v[104:107], v176 offset:2048
    v_mfma_f32_16x16x32_bf16 v[36:39], v[148:151], v[136:139], v[36:39]
    ds_read_b128 v[108:111], v176 offset:3072
    v_mfma_f32_16x16x32_bf16 v[44:47], v[152:155], v[136:139], v[44:47]
    ds_read_b128 v[112:115], v176 offset:4096
    v_mfma_f32_16x16x32_bf16 v[40:43], v[152:155], v[132:135], v[40:43]
    ds_read_b128 v[116:119], v176 offset:5120
    v_mfma_f32_16x16x32_bf16 v[48:51], v[156:159], v[132:135], v[48:51]
    ds_read_b128 v[120:123], v176 offset:6144
    v_mfma_f32_16x16x32_bf16 v[52:55], v[156:159], v[136:139], v[52:55]
    ds_read_b128 v[124:127], v176 offset:7168
    v_mfma_f32_16x16x32_bf16 v[60:63], v[160:163], v[136:139], v[60:63]
    ds_read_b128 v[128:131], v176 offset:8192
    v_mfma_f32_16x16x32_bf16 v[56:59], v[160:163], v[132:135], v[56:59]
    v_exp_f32 v203, v203
    v_mfma_f32_16x16x32_bf16 v[64:67], v[164:167], v[132:135], v[64:67]
    v_exp_f32 v204, v204
    v_mfma_f32_16x16x32_bf16 v[68:71], v[164:167], v[136:139], v[68:71]
    v_exp_f32 v205, v205
    v_mfma_f32_16x16x32_bf16 v[76:79], v[168:171], v[136:139], v[76:79]
    v_exp_f32 v206, v206
    v_mfma_f32_16x16x32_bf16 v[72:75], v[168:171], v[132:135], v[72:75]
    v_exp_f32 v207, v207
    v_mfma_f32_16x16x32_bf16 v[80:83], v[172:175], v[132:135], v[80:83]
    v_exp_f32 v208, v208
    v_mfma_f32_16x16x32_bf16 v[84:87], v[172:175], v[136:139], v[84:87]
    v_exp_f32 v209, v209
    s_waitcnt lgkmcnt(0)
    v_mfma_f32_16x16x32_bf16 v[16:19], v[96:99], v[88:91], v[16:19]
    ds_read_b128 v[132:135], v181 offset:0
    v_mfma_f32_16x16x32_bf16 v[20:23], v[96:99], v[92:95], v[20:23]
    ds_read_b128 v[140:143], v176 offset:9216
    v_mfma_f32_16x16x32_bf16 v[28:31], v[100:103], v[92:95], v[28:31]
    ds_read_b128 v[136:139], v181 offset:2048
    v_mfma_f32_16x16x32_bf16 v[24:27], v[100:103], v[88:91], v[24:27]
    ds_read_b128 v[144:147], v176 offset:10240
    v_mfma_f32_16x16x32_bf16 v[32:35], v[104:107], v[88:91], v[32:35]
    ds_read_b128 v[148:151], v176 offset:11264
    v_mfma_f32_16x16x32_bf16 v[36:39], v[104:107], v[92:95], v[36:39]
    ds_read_b128 v[152:155], v176 offset:12288
    v_mfma_f32_16x16x32_bf16 v[44:47], v[108:111], v[92:95], v[44:47]
    ds_read_b128 v[156:159], v176 offset:13312
    v_mfma_f32_16x16x32_bf16 v[40:43], v[108:111], v[88:91], v[40:43]
    ds_read_b128 v[160:163], v176 offset:14336
    v_mfma_f32_16x16x32_bf16 v[48:51], v[112:115], v[88:91], v[48:51]
    ds_read_b128 v[164:167], v176 offset:15360
    v_mfma_f32_16x16x32_bf16 v[52:55], v[112:115], v[92:95], v[52:55]
    ds_read_b128 v[168:171], v176 offset:16384
    v_mfma_f32_16x16x32_bf16 v[60:63], v[116:119], v[92:95], v[60:63]
    ds_read_b128 v[172:175], v176 offset:17408
    v_mfma_f32_16x16x32_bf16 v[56:59], v[116:119], v[88:91], v[56:59]
    v_exp_f32 v210, v210
    v_mfma_f32_16x16x32_bf16 v[64:67], v[120:123], v[88:91], v[64:67]
    v_exp_f32 v211, v211
    v_mfma_f32_16x16x32_bf16 v[68:71], v[120:123], v[92:95], v[68:71]
    v_exp_f32 v212, v212
    v_mfma_f32_16x16x32_bf16 v[76:79], v[124:127], v[92:95], v[76:79]
    v_add_f32 v203, 1.0, v203
    v_add_f32 v204, 1.0, v204
    v_mfma_f32_16x16x32_bf16 v[72:75], v[124:127], v[88:91], v[72:75]
    v_add_f32 v205, 1.0, v205
    v_add_f32 v206, 1.0, v206
    v_mfma_f32_16x16x32_bf16 v[80:83], v[128:131], v[88:91], v[80:83]
    v_add_f32 v207, 1.0, v207
    v_add_f32 v208, 1.0, v208
    v_mfma_f32_16x16x32_bf16 v[84:87], v[128:131], v[92:95], v[84:87]
    v_add_f32 v209, 1.0, v209
    v_add_f32 v210, 1.0, v210
    s_waitcnt lgkmcnt(0)
    s_barrier
    v_mfma_f32_16x16x32_bf16 v[16:19], v[140:143], v[132:135], v[16:19]
    ds_read_b128 v[88:91], v182 offset:0
    v_mfma_f32_16x16x32_bf16 v[20:23], v[140:143], v[136:139], v[20:23]
    ds_read_b128 v[96:99], v177 offset:0
    v_mfma_f32_16x16x32_bf16 v[28:31], v[144:147], v[136:139], v[28:31]
    ds_read_b128 v[92:95], v182 offset:2048
    v_mfma_f32_16x16x32_bf16 v[24:27], v[144:147], v[132:135], v[24:27]
    ds_read_b128 v[100:103], v177 offset:1024
    v_mfma_f32_16x16x32_bf16 v[32:35], v[148:151], v[132:135], v[32:35]
    ds_read_b128 v[104:107], v177 offset:2048
    v_mfma_f32_16x16x32_bf16 v[36:39], v[148:151], v[136:139], v[36:39]
    ds_read_b128 v[108:111], v177 offset:3072
    v_mfma_f32_16x16x32_bf16 v[44:47], v[152:155], v[136:139], v[44:47]
    ds_read_b128 v[112:115], v177 offset:4096
    v_mfma_f32_16x16x32_bf16 v[40:43], v[152:155], v[132:135], v[40:43]
    ds_read_b128 v[116:119], v177 offset:5120
    v_mfma_f32_16x16x32_bf16 v[48:51], v[156:159], v[132:135], v[48:51]
    ds_read_b128 v[120:123], v177 offset:6144
    v_mfma_f32_16x16x32_bf16 v[52:55], v[156:159], v[136:139], v[52:55]
    ds_read_b128 v[124:127], v177 offset:7168
    v_mfma_f32_16x16x32_bf16 v[60:63], v[160:163], v[136:139], v[60:63]
    ds_read_b128 v[128:131], v177 offset:8192
    v_mfma_f32_16x16x32_bf16 v[56:59], v[160:163], v[132:135], v[56:59]
    v_add_f32 v211, 1.0, v211
    v_add_f32 v212, 1.0, v212
    v_mfma_f32_16x16x32_bf16 v[64:67], v[164:167], v[132:135], v[64:67]
    v_rcp_f32 v203, v203
    v_mfma_f32_16x16x32_bf16 v[68:71], v[164:167], v[136:139], v[68:71]
    v_rcp_f32 v204, v204
    v_mfma_f32_16x16x32_bf16 v[76:79], v[168:171], v[136:139], v[76:79]
    v_rcp_f32 v205, v205
    v_mfma_f32_16x16x32_bf16 v[72:75], v[168:171], v[132:135], v[72:75]
    v_rcp_f32 v206, v206
    v_mfma_f32_16x16x32_bf16 v[80:83], v[172:175], v[132:135], v[80:83]
    v_rcp_f32 v207, v207
    v_mfma_f32_16x16x32_bf16 v[84:87], v[172:175], v[136:139], v[84:87]
    v_rcp_f32 v208, v208
    s_waitcnt lgkmcnt(0)
    v_mfma_f32_16x16x32_bf16 v[16:19], v[96:99], v[88:91], v[16:19]
    ds_read_b128 v[132:135], v183 offset:0
    v_mfma_f32_16x16x32_bf16 v[20:23], v[96:99], v[92:95], v[20:23]
    ds_read_b128 v[140:143], v177 offset:9216
    v_mfma_f32_16x16x32_bf16 v[28:31], v[100:103], v[92:95], v[28:31]
    ds_read_b128 v[136:139], v183 offset:2048
    v_mfma_f32_16x16x32_bf16 v[24:27], v[100:103], v[88:91], v[24:27]
    ds_read_b128 v[144:147], v177 offset:10240
    v_mfma_f32_16x16x32_bf16 v[32:35], v[104:107], v[88:91], v[32:35]
    ds_read_b128 v[148:151], v177 offset:11264
    v_mfma_f32_16x16x32_bf16 v[36:39], v[104:107], v[92:95], v[36:39]
    ds_read_b128 v[152:155], v177 offset:12288
    v_mfma_f32_16x16x32_bf16 v[44:47], v[108:111], v[92:95], v[44:47]
    ds_read_b128 v[156:159], v177 offset:13312
    v_mfma_f32_16x16x32_bf16 v[40:43], v[108:111], v[88:91], v[40:43]
    ds_read_b128 v[160:163], v177 offset:14336
    v_mfma_f32_16x16x32_bf16 v[48:51], v[112:115], v[88:91], v[48:51]
    ds_read_b128 v[164:167], v177 offset:15360
    v_mfma_f32_16x16x32_bf16 v[52:55], v[112:115], v[92:95], v[52:55]
    ds_read_b128 v[168:171], v177 offset:16384
    v_mfma_f32_16x16x32_bf16 v[60:63], v[116:119], v[92:95], v[60:63]
    ds_read_b128 v[172:175], v177 offset:17408
    v_mfma_f32_16x16x32_bf16 v[56:59], v[116:119], v[88:91], v[56:59]
    v_rcp_f32 v209, v209
    v_mfma_f32_16x16x32_bf16 v[64:67], v[120:123], v[88:91], v[64:67]
    v_rcp_f32 v210, v210
    v_mfma_f32_16x16x32_bf16 v[68:71], v[120:123], v[92:95], v[68:71]
    v_rcp_f32 v211, v211
    v_mfma_f32_16x16x32_bf16 v[76:79], v[124:127], v[92:95], v[76:79]
    v_rcp_f32 v212, v212
    v_mfma_f32_16x16x32_bf16 v[72:75], v[124:127], v[88:91], v[72:75]
    v_mul_f32 v193, v193, v203
    v_mul_f32 v194, v194, v204
    v_mfma_f32_16x16x32_bf16 v[80:83], v[128:131], v[88:91], v[80:83]
    v_mul_f32 v195, v195, v205
    v_mul_f32 v196, v196, v206
    v_mfma_f32_16x16x32_bf16 v[84:87], v[128:131], v[92:95], v[84:87]
    v_mul_f32 v197, v197, v207
    v_mul_f32 v198, v198, v208
    s_waitcnt lgkmcnt(0)
    s_barrier
    v_mfma_f32_16x16x32_bf16 v[16:19], v[140:143], v[132:135], v[16:19]
    ds_read_b128 v[88:91], v184 offset:0
    v_mfma_f32_16x16x32_bf16 v[20:23], v[140:143], v[136:139], v[20:23]
    ds_read_b128 v[96:99], v178 offset:0
    v_mfma_f32_16x16x32_bf16 v[28:31], v[144:147], v[136:139], v[28:31]
    ds_read_b128 v[92:95], v184 offset:2048
    v_mfma_f32_16x16x32_bf16 v[24:27], v[144:147], v[132:135], v[24:27]
    ds_read_b128 v[100:103], v178 offset:1024
    v_mfma_f32_16x16x32_bf16 v[32:35], v[148:151], v[132:135], v[32:35]
    ds_read_b128 v[104:107], v178 offset:2048
    v_mfma_f32_16x16x32_bf16 v[36:39], v[148:151], v[136:139], v[36:39]
    ds_read_b128 v[108:111], v178 offset:3072
    v_mfma_f32_16x16x32_bf16 v[44:47], v[152:155], v[136:139], v[44:47]
    ds_read_b128 v[112:115], v178 offset:4096
    v_mfma_f32_16x16x32_bf16 v[40:43], v[152:155], v[132:135], v[40:43]
    ds_read_b128 v[116:119], v178 offset:5120
    v_mfma_f32_16x16x32_bf16 v[48:51], v[156:159], v[132:135], v[48:51]
    ds_read_b128 v[120:123], v178 offset:6144
    v_mfma_f32_16x16x32_bf16 v[52:55], v[156:159], v[136:139], v[52:55]
    ds_read_b128 v[124:127], v178 offset:7168
    v_mfma_f32_16x16x32_bf16 v[60:63], v[160:163], v[136:139], v[60:63]
    ds_read_b128 v[128:131], v178 offset:8192
    v_mfma_f32_16x16x32_bf16 v[56:59], v[160:163], v[132:135], v[56:59]
    v_mul_f32 v199, v199, v209
    v_mul_f32 v200, v200, v210
    v_mfma_f32_16x16x32_bf16 v[64:67], v[164:167], v[132:135], v[64:67]
    v_mul_f32 v201, v201, v211
    v_mul_f32 v202, v202, v212
    v_mfma_f32_16x16x32_bf16 v[68:71], v[164:167], v[136:139], v[68:71]
    s_set_gpr_idx_on s70, 0x8
    s_nop 0
    v_cvt_pk_bf16_f32 v216, v193, v194
    v_cvt_pk_bf16_f32 v217, v195, v196
    v_cvt_pk_bf16_f32 v218, v197, v198
    v_cvt_pk_bf16_f32 v219, v199, v200
    v_cvt_pk_bf16_f32 v220, v201, v202
    s_set_gpr_idx_off
    s_add_u32 s70, s70, 5
    v_mfma_f32_16x16x32_bf16 v[76:79], v[168:171], v[136:139], v[76:79]
    v_mfma_f32_16x16x32_bf16 v[72:75], v[168:171], v[132:135], v[72:75]
    v_mfma_f32_16x16x32_bf16 v[80:83], v[172:175], v[132:135], v[80:83]
    v_mfma_f32_16x16x32_bf16 v[84:87], v[172:175], v[136:139], v[84:87]
    s_sub_u32 s71, s71, 1
    s_cmp_lg_u32 s71, 0
    s_cbranch_scc1 gated_mix__ssm_conv_s4d__mixer_gmlp__prompt_kernel_g2
    s_lshl_b32 s70, s26, 14
    s_add_u32 s71, s70, 4096
    s_add_u32 s72, s70, 8192
    s_add_u32 s73, s70, 12288
    s_lshr_b32 s64, s26, 1
    s_lshl_b32 s64, s64, 12
    s_and_b32 s65, s26, 1
    s_lshl_b32 s65, s65, 11
    s_add_u32 s64, s64, s65
    s_and_b32 s65, s25, 1
    s_lshl_b32 s65, s65, 10
    s_sub_u32 s64, s64, s65
    s_add_u32 s64, s64, 262144
    s_waitcnt vmcnt(0) lgkmcnt(0)
    v_lshlrev_b32 v88, 16, v216
    v_and_b32 v89, 0xffff0000, v216
    v_mul_f32 v88, v88, v16
    v_mul_f32 v89, v89, v17
    v_cvt_pk_bf16_f32 v216, v88, v89
    v_lshlrev_b32 v90, 16, v217
    v_and_b32 v91, 0xffff0000, v217
    v_mul_f32 v90, v90, v18
    v_mul_f32 v91, v91, v19
    v_cvt_pk_bf16_f32 v217, v90, v91
    v_lshlrev_b32 v92, 16, v218
    v_and_b32 v93, 0xffff0000, v218
    v_mul_f32 v92, v92, v24
    v_mul_f32 v93, v93, v25
    v_cvt_pk_bf16_f32 v218, v92, v93
    v_lshlrev_b32 v94, 16, v219
    v_and_b32 v95, 0xffff0000, v219
    v_mul_f32 v94, v94, v26
    v_mul_f32 v95, v95, v27
    v_cvt_pk_bf16_f32 v219, v94, v95
    buffer_store_dwordx4 v[216:219], v10, s[16:19], s70 offen offset:0 sc1
    v_lshlrev_b32 v96, 16, v220
    v_and_b32 v97, 0xffff0000, v220
    v_mul_f32 v96, v96, v32
    v_mul_f32 v97, v97, v33
    v_cvt_pk_bf16_f32 v220, v96, v97
    v_lshlrev_b32 v98, 16, v221
    v_and_b32 v99, 0xffff0000, v221
    v_mul_f32 v98, v98, v34
    v_mul_f32 v99, v99, v35
    v_cvt_pk_bf16_f32 v221, v98, v99
    v_lshlrev_b32 v100, 16, v222
    v_and_b32 v101, 0xffff0000, v222
    v_mul_f32 v100, v100, v40
    v_mul_f32 v101, v101, v41
    v_cvt_pk_bf16_f32 v222, v100, v101
    v_lshlrev_b32 v102, 16, v223
    v_and_b32 v103, 0xffff0000, v223
    v_mul_f32 v102, v102, v42
    v_mul_f32 v103, v103, v43
    v_cvt_pk_bf16_f32 v223, v102, v103
    buffer_store_dwordx4 v[220:223], v10, s[16:19], s71 offen offset:0 sc1
    v_lshlrev_b32 v88, 16, v224
    v_and_b32 v89, 0xffff0000, v224
    v_mul_f32 v88, v88, v48
    v_mul_f32 v89, v89, v49
    v_cvt_pk_bf16_f32 v224, v88, v89
    v_lshlrev_b32 v90, 16, v225
    v_and_b32 v91, 0xffff0000, v225
    v_mul_f32 v90, v90, v50
    v_mul_f32 v91, v91, v51
    v_cvt_pk_bf16_f32 v225, v90, v91
    v_lshlrev_b32 v92, 16, v226
    v_and_b32 v93, 0xffff0000, v226
    v_mul_f32 v92, v92, v56
    v_mul_f32 v93, v93, v57
    v_cvt_pk_bf16_f32 v226, v92, v93
    v_lshlrev_b32 v94, 16, v227
    v_and_b32 v95, 0xffff0000, v227
    v_mul_f32 v94, v94, v58
    v_mul_f32 v95, v95, v59
    v_cvt_pk_bf16_f32 v227, v94, v95
    buffer_store_dwordx4 v[224:227], v10, s[16:19], s72 offen offset:0 sc1
    v_lshlrev_b32 v96, 16, v228
    v_and_b32 v97, 0xffff0000, v228
    v_mul_f32 v96, v96, v64
    v_mul_f32 v97, v97, v65
    v_cvt_pk_bf16_f32 v228, v96, v97
    v_lshlrev_b32 v98, 16, v229
    v_and_b32 v99, 0xffff0000, v229
    v_mul_f32 v98, v98, v66
    v_mul_f32 v99, v99, v67
    v_cvt_pk_bf16_f32 v229, v98, v99
    v_lshlrev_b32 v100, 16, v230
    v_and_b32 v101, 0xffff0000, v230
    v_mul_f32 v100, v100, v72
    v_mul_f32 v101, v101, v73
    v_cvt_pk_bf16_f32 v230, v100, v101
    v_lshlrev_b32 v102, 16, v231
    v_and_b32 v103, 0xffff0000, v231
    v_mul_f32 v102, v102, v74
    v_mul_f32 v103, v103, v75
    v_cvt_pk_bf16_f32 v231, v102, v103
    buffer_store_dwordx4 v[228:231], v10, s[16:19], s73 offen offset:0 sc1
    v_lshlrev_b32 v88, 16, v232
    v_and_b32 v89, 0xffff0000, v232
    v_mul_f32 v88, v88, v20
    v_mul_f32 v89, v89, v21
    v_cvt_pk_bf16_f32 v232, v88, v89
    v_lshlrev_b32 v90, 16, v233
    v_and_b32 v91, 0xffff0000, v233
    v_mul_f32 v90, v90, v22
    v_mul_f32 v91, v91, v23
    v_cvt_pk_bf16_f32 v233, v90, v91
    v_lshlrev_b32 v92, 16, v234
    v_and_b32 v93, 0xffff0000, v234
    v_mul_f32 v92, v92, v28
    v_mul_f32 v93, v93, v29
    v_cvt_pk_bf16_f32 v234, v92, v93
    v_lshlrev_b32 v94, 16, v235
    v_and_b32 v95, 0xffff0000, v235
    v_mul_f32 v94, v94, v30
    v_mul_f32 v95, v95, v31
    v_cvt_pk_bf16_f32 v235, v94, v95
    buffer_store_dwordx4 v[232:235], v10, s[16:19], s70 offen offset:1024 sc1
    v_lshlrev_b32 v96, 16, v236
    v_and_b32 v97, 0xffff0000, v236
    v_mul_f32 v96, v96, v36
    v_mul_f32 v97, v97, v37
    v_cvt_pk_bf16_f32 v236, v96, v97
    v_lshlrev_b32 v98, 16, v237
    v_and_b32 v99, 0xffff0000, v237
    v_mul_f32 v98, v98, v38
    v_mul_f32 v99, v99, v39
    v_cvt_pk_bf16_f32 v237, v98, v99
    v_lshlrev_b32 v100, 16, v238
    v_and_b32 v101, 0xffff0000, v238
    v_mul_f32 v100, v100, v44
    v_mul_f32 v101, v101, v45
    v_cvt_pk_bf16_f32 v238, v100, v101
    v_lshlrev_b32 v102, 16, v239
    v_and_b32 v103, 0xffff0000, v239
    v_mul_f32 v102, v102, v46
    v_mul_f32 v103, v103, v47
    v_cvt_pk_bf16_f32 v239, v102, v103
    buffer_store_dwordx4 v[236:239], v10, s[16:19], s71 offen offset:1024 sc1
    v_lshlrev_b32 v88, 16, v240
    v_and_b32 v89, 0xffff0000, v240
    v_mul_f32 v88, v88, v52
    v_mul_f32 v89, v89, v53
    v_cvt_pk_bf16_f32 v240, v88, v89
    v_lshlrev_b32 v90, 16, v241
    v_and_b32 v91, 0xffff0000, v241
    v_mul_f32 v90, v90, v54
    v_mul_f32 v91, v91, v55
    v_cvt_pk_bf16_f32 v241, v90, v91
    v_lshlrev_b32 v92, 16, v242
    v_and_b32 v93, 0xffff0000, v242
    v_mul_f32 v92, v92, v60
    v_mul_f32 v93, v93, v61
    v_cvt_pk_bf16_f32 v242, v92, v93
    v_lshlrev_b32 v94, 16, v243
    v_and_b32 v95, 0xffff0000, v243
    v_mul_f32 v94, v94, v62
    v_mul_f32 v95, v95, v63
    v_cvt_pk_bf16_f32 v243, v94, v95
    buffer_store_dwordx4 v[240:243], v10, s[16:19], s72 offen offset:1024 sc1
    v_lshlrev_b32 v96, 16, v244
    v_and_b32 v97, 0xffff0000, v244
    v_mul_f32 v96, v96, v68
    v_mul_f32 v97, v97, v69
    v_cvt_pk_bf16_f32 v244, v96, v97
    v_lshlrev_b32 v98, 16, v245
    v_and_b32 v99, 0xffff0000, v245
    v_mul_f32 v98, v98, v70
    v_mul_f32 v99, v99, v71
    v_cvt_pk_bf16_f32 v245, v98, v99
    v_lshlrev_b32 v100, 16, v246
    v_and_b32 v101, 0xffff0000, v246
    v_mul_f32 v100, v100, v76
    v_mul_f32 v101, v101, v77
    v_cvt_pk_bf16_f32 v246, v100, v101
    v_lshlrev_b32 v102, 16, v247
    v_and_b32 v103, 0xffff0000, v247
    v_mul_f32 v102, v102, v78
    v_mul_f32 v103, v103, v79
    v_cvt_pk_bf16_f32 v247, v102, v103
    buffer_store_dwordx4 v[244:247], v10, s[16:19], s73 offen offset:1024 sc1
    v_lshlrev_b32 v88, 16, v248
    v_and_b32 v89, 0xffff0000, v248
    v_mul_f32 v88, v88, v80
    v_mul_f32 v89, v89, v81
    v_cvt_pk_bf16_f32 v248, v88, v89
    v_lshlrev_b32 v90, 16, v249
    v_and_b32 v91, 0xffff0000, v249
    v_mul_f32 v90, v90, v82
    v_mul_f32 v91, v91, v83
    v_cvt_pk_bf16_f32 v249, v90, v91
    v_lshlrev_b32 v92, 16, v250
    v_and_b32 v93, 0xffff0000, v250
    v_mul_f32 v92, v92, v84
    v_mul_f32 v93, v93, v85
    v_cvt_pk_bf16_f32 v250, v92, v93
    v_lshlrev_b32 v94, 16, v251
    v_and_b32 v95, 0xffff0000, v251
    v_mul_f32 v94, v94, v86
    v_mul_f32 v95, v95, v87
    v_cvt_pk_bf16_f32 v251, v94, v95
    buffer_store_dwordx4 v[248:251], v10, s[16:19], s64 offen sc1
    s_barrier
    s_cmp_ge_u32 s26, 9
    s_cbranch_scc1 gated_mix__ssm_conv_s4d__mixer_gmlp__prompt_kernel_Cnc
    s_mul_i32 s64, s25, 4800
    s_add_u32 s1, s64, 140288
    s_add_u32 s72, s64, 140928
    s_add_u32 s73, s64, 104512
    s_mul_i32 s74, s25, 4608
    s_add_u32 s74, s74, 81920
    v_lshlrev_b32 v9, 4, v0
    v_add_u32 v8, s72, v9
    v_add_u32 v9, s73, v9
    ds_read_b128 v[16:19], v8 offset:0
    ds_read_b32 v20, v8 offset:16
    ds_read_b128 v[24:27], v8 offset:1024
    ds_read_b32 v28, v8 offset:1040
    ds_read_b128 v[32:35], v8 offset:2048
    ds_read_b32 v36, v8 offset:2064
    ds_read_b128 v[40:43], v8 offset:3072
    ds_read_b32 v44, v8 offset:3088
    s_mov_b64 exec, 0xf
    ds_read_b128 v[48:51], v8 offset:4096
    ds_read_b32 v52, v8 offset:4112
    s_mov_b64 exec, -1
    s_waitcnt lgkmcnt(0)
    v_alignbit_b32 v16, v17, v16, 16
    v_alignbit_b32 v17, v18, v17, 16
    v_alignbit_b32 v18, v19, v18, 16
    v_alignbit_b32 v19, v20, v19, 16
    ds_write_b128 v9, v[16:19] offset:0
    v_alignbit_b32 v24, v25, v24, 16
    v_alignbit_b32 v25, v26, v25, 16
    v_alignbit_b32 v26, v27, v26, 16
    v_alignbit_b32 v27, v28, v27, 16
    ds_write_b128 v9, v[24:27] offset:1024
    v_alignbit_b32 v32, v33, v32, 16
    v_alignbit_b32 v33, v34, v33, 16
    v_alignbit_b32 v34, v35, v34, 16
    v_alignbit_b32 v35, v36, v35, 16
    ds_write_b128 v9, v[32:35] offset:2048
    v_alignbit_b32 v40, v41, v40, 16
    v_alignbit_b32 v41, v42, v41, 16
    v_alignbit_b32 v42, v43, v42, 16
    v_alignbit_b32 v43, v44, v43, 16
    ds_write_b128 v9, v[40:43] offset:3072
    v_alignbit_b32 v48, v49, v48, 16
    v_alignbit_b32 v49, v50, v49, 16
    v_alignbit_b32 v50, v51, v50, 16
    v_alignbit_b32 v51, v52, v51, 16
    s_mov_b64 exec, 0xf
    ds_write_b128 v9, v[48:51] offset:4096
    s_mov_b64 exec, -1
    v_mov_b32 v6, 0
    v_mov_b32 v7, 0
    v_lshlrev_b32 v8, 3, v0
    v_add_u32 v8, s74, v8
    s_mov_b32 exec_lo, -1
    s_mov_b32 exec_hi, 268435455
    ds_write_b64 v8, v[6:7]
    s_mov_b64 exec, -1
    v_and_b32 v4, 15, v0
    v_lshrrev_b32 v5, 4, v0
    v_lshlrev_b32 v8, 3, v5
    v_sub_u32 v8, v8, v4
    v_add_u32 v8, 2043, v8
    v_and_b32 v9, 1, v8
    v_sub_u32 v8, v8, v9
    v_lshlrev_b32 v8, 1, v8
    s_sub_u32 s64, s73, s72
    v_mul_lo_u32 v9, v9, s64
    v_add_u32 v8, v8, v9
    v_add_u32 v8, s72, v8
    v_subrev_u32 v24, 960, v8
    v_subrev_u32 v25, 1984, v8
    v_subrev_u32 v26, 3008, v8
    v_subrev_u32 v27, 4032, v8
    v_lshlrev_b32 v28, 5, v4
    v_lshl_add_u32 v29, v5, 3, v28
    v_lshl_add_u32 v28, v5, 4, v28
    v_add_u32 v28, s74, v28
    v_add_u32 v30, s74, v29
    ds_read2_b32 v[64:65], v24 offset0:240 offset1:241
    ds_read2_b32 v[66:67], v24 offset0:242 offset1:243
    ds_read_b128 v[96:99], v28 offset:448
    ds_read2_b32 v[68:69], v24 offset0:112 offset1:113
    ds_read2_b32 v[70:71], v24 offset0:114 offset1:115
    ds_read_b128 v[100:103], v28 offset:960
    ds_read2_b32 v[72:73], v25 offset0:240 offset1:241
    ds_read2_b32 v[74:75], v25 offset0:242 offset1:243
    ds_read_b128 v[104:107], v28 offset:1472
    ds_read2_b32 v[76:77], v25 offset0:112 offset1:113
    ds_read2_b32 v[78:79], v25 offset0:114 offset1:115
    ds_read_b128 v[108:111], v28 offset:1984
    ds_read2_b32 v[80:81], v26 offset0:240 offset1:241
    ds_read2_b32 v[82:83], v26 offset0:242 offset1:243
    ds_read_b128 v[112:115], v28 offset:2496
    ds_read2_b32 v[84:85], v26 offset0:112 offset1:113
    ds_read2_b32 v[86:87], v26 offset0:114 offset1:115
    ds_read_b128 v[116:119], v28 offset:3008
    ds_read2_b32 v[88:89], v27 offset0:240 offset1:241
    ds_read2_b32 v[90:91], v27 offset0:242 offset1:243
    ds_read_b128 v[120:123], v28 offset:3520
    ds_read2_b32 v[92:93], v27 offset0:112 offset1:113
    ds_read2_b32 v[94:95], v27 offset0:114 offset1:115
    ds_read_b128 v[124:127], v28 offset:4032
    v_mov_b32 v32, 0
    v_mov_b32 v33, 0
    v_mov_b32 v34, 0
    v_mov_b32 v35, 0
    v_mov_b32 v36, 0
    v_mov_b32 v37, 0
    v_mov_b32 v38, 0
    v_mov_b32 v39, 0
    v_mov_b32 v40, 0
    v_mov_b32 v41, 0
    v_mov_b32 v42, 0
    v_mov_b32 v43, 0
    v_mov_b32 v44, 0
    v_mov_b32 v45, 0
    v_mov_b32 v46, 0
    v_mov_b32 v47, 0
    v_mov_b32 v48, 0
    v_mov_b32 v49, 0
    v_mov_b32 v50, 0
    v_mov_b32 v51, 0
    v_mov_b32 v52, 0
    v_mov_b32 v53, 0
    v_mov_b32 v54, 0
    v_mov_b32 v55, 0
    v_mov_b32 v56, 0
    v_mov_b32 v57, 0
    v_mov_b32 v58, 0
    v_mov_b32 v59, 0
    v_mov_b32 v60, 0
    v_mov_b32 v61, 0
    v_mov_b32 v62, 0
    v_mov_b32 v63, 0
    s_waitcnt lgkmcnt(0)
    v_mfma_f32_16x16x32_bf16 v[32:35], v[64:67], v[96:99], v[32:35]
    ds_read2_b32 v[128:129], v24 offset0:224 offset1:225
    ds_read2_b32 v[130:131], v24 offset0:226 offset1:227
    v_mfma_f32_16x16x32_bf16 v[36:39], v[64:67], v[100:103], v[36:39]
    ds_read_b128 v[160:163], v28 offset:384
    v_mfma_f32_16x16x32_bf16 v[40:43], v[64:67], v[104:107], v[40:43]
    ds_read2_b32 v[132:133], v24 offset0:96 offset1:97
    ds_read2_b32 v[134:135], v24 offset0:98 offset1:99
    v_mfma_f32_16x16x32_bf16 v[44:47], v[64:67], v[108:111], v[44:47]
    ds_read_b128 v[164:167], v28 offset:896
    v_mfma_f32_16x16x32_bf16 v[48:51], v[64:67], v[112:115], v[48:51]
    ds_read2_b32 v[136:137], v25 offset0:224 offset1:225
    ds_read2_b32 v[138:139], v25 offset0:226 offset1:227
    v_mfma_f32_16x16x32_bf16 v[52:55], v[64:67], v[116:119], v[52:55]
    ds_read_b128 v[168:171], v28 offset:1408
    v_mfma_f32_16x16x32_bf16 v[56:59], v[64:67], v[120:123], v[56:59]
    ds_read2_b32 v[140:141], v25 offset0:96 offset1:97
    ds_read2_b32 v[142:143], v25 offset0:98 offset1:99
    v_mfma_f32_16x16x32_bf16 v[60:63], v[64:67], v[124:127], v[60:63]
    ds_read_b128 v[172:175], v28 offset:1920
    v_mfma_f32_16x16x32_bf16 v[36:39], v[68:71], v[96:99], v[36:39]
    ds_read2_b32 v[144:145], v26 offset0:224 offset1:225
    ds_read2_b32 v[146:147], v26 offset0:226 offset1:227
    v_mfma_f32_16x16x32_bf16 v[40:43], v[68:71], v[100:103], v[40:43]
    ds_read_b128 v[176:179], v28 offset:2432
    v_mfma_f32_16x16x32_bf16 v[44:47], v[68:71], v[104:107], v[44:47]
    ds_read2_b32 v[148:149], v26 offset0:96 offset1:97
    ds_read2_b32 v[150:151], v26 offset0:98 offset1:99
    v_mfma_f32_16x16x32_bf16 v[48:51], v[68:71], v[108:111], v[48:51]
    ds_read_b128 v[180:183], v28 offset:2944
    v_mfma_f32_16x16x32_bf16 v[52:55], v[68:71], v[112:115], v[52:55]
    ds_read2_b32 v[152:153], v27 offset0:224 offset1:225
    ds_read2_b32 v[154:155], v27 offset0:226 offset1:227
    v_mfma_f32_16x16x32_bf16 v[56:59], v[68:71], v[116:119], v[56:59]
    ds_read_b128 v[184:187], v28 offset:3456
    v_mfma_f32_16x16x32_bf16 v[60:63], v[68:71], v[120:123], v[60:63]
    ds_read2_b32 v[156:157], v27 offset0:96 offset1:97
    ds_read2_b32 v[158:159], v27 offset0:98 offset1:99
    v_mfma_f32_16x16x32_bf16 v[40:43], v[72:75], v[96:99], v[40:43]
    ds_read_b128 v[188:191], v28 offset:3968
    v_mfma_f32_16x16x32_bf16 v[44:47], v[72:75], v[100:103], v[44:47]
    v_mfma_f32_16x16x32_bf16 v[48:51], v[72:75], v[104:107], v[48:51]
    v_mfma_f32_16x16x32_bf16 v[52:55], v[72:75], v[108:111], v[52:55]
    v_mfma_f32_16x16x32_bf16 v[56:59], v[72:75], v[112:115], v[56:59]
    v_mfma_f32_16x16x32_bf16 v[60:63], v[72:75], v[116:119], v[60:63]
    v_mfma_f32_16x16x32_bf16 v[44:47], v[76:79], v[96:99], v[44:47]
    v_mfma_f32_16x16x32_bf16 v[48:51], v[76:79], v[100:103], v[48:51]
    v_mfma_f32_16x16x32_bf16 v[52:55], v[76:79], v[104:107], v[52:55]
    v_mfma_f32_16x16x32_bf16 v[56:59], v[76:79], v[108:111], v[56:59]
    v_mfma_f32_16x16x32_bf16 v[60:63], v[76:79], v[112:115], v[60:63]
    v_mfma_f32_16x16x32_bf16 v[48:51], v[80:83], v[96:99], v[48:51]
    v_mfma_f32_16x16x32_bf16 v[52:55], v[80:83], v[100:103], v[52:55]
    v_mfma_f32_16x16x32_bf16 v[56:59], v[80:83], v[104:107], v[56:59]
    v_mfma_f32_16x16x32_bf16 v[60:63], v[80:83], v[108:111], v[60:63]
    v_mfma_f32_16x16x32_bf16 v[52:55], v[84:87], v[96:99], v[52:55]
    v_mfma_f32_16x16x32_bf16 v[56:59], v[84:87], v[100:103], v[56:59]
    v_mfma_f32_16x16x32_bf16 v[60:63], v[84:87], v[104:107], v[60:63]
    v_mfma_f32_16x16x32_bf16 v[56:59], v[88:91], v[96:99], v[56:59]
    v_mfma_f32_16x16x32_bf16 v[60:63], v[88:91], v[100:103], v[60:63]
    v_mfma_f32_16x16x32_bf16 v[60:63], v[92:95], v[96:99], v[60:63]
    s_waitcnt vmcnt(0)
    s_lshr_b32 s65, s25, 1
    s_lshl_b32 s70, s65, 2
    s_add_u32 s70, s70, 163592
    v_mov_b32 v200, s70
    v_mov_b32 v201, 1
    s_mov_b64 exec, 1
    ds_add_rtn_u32 v201, v200, v201
    s_mov_b64 exec, -1
    s_waitcnt lgkmcnt(0)
    v_readfirstlane_b32 s64, v201
    s_nop 0
    s_cmp_lg_u32 s64, 1
    s_cbranch_scc1 gated_mix__ssm_conv_s4d__mixer_gmlp__prompt_kernel_Cnha
    s_lshl_b32 s71, s27, 1
    s_add_u32 s71, s71, s65
    s_lshl_b32 s71, s71, 3
    v_add_u32 v200, s71, v0
    v_lshlrev_b32 v200, 8, v200
    s_lshl_b32 s64, s26, 2
    s_add_u32 s64, s64, 65536
    v_mov_b32 v201, 1
    s_mov_b64 exec, 0xff
    buffer_store_dword v201, v200, s[20:23], s64 offen sc1
    s_mov_b64 exec, -1
gated_mix__ssm_conv_s4d__mixer_gmlp__prompt_kernel_Cnha:
    s_waitcnt lgkmcnt(0)
    v_mfma_f32_16x16x32_bf16 v[32:35], v[128:131], v[160:163], v[32:35]
    ds_read2_b32 v[64:65], v24 offset0:208 offset1:209
    ds_read2_b32 v[66:67], v24 offset0:210 offset1:211
    v_mfma_f32_16x16x32_bf16 v[36:39], v[128:131], v[164:167], v[36:39]
    ds_read_b128 v[96:99], v28 offset:320
    v_mfma_f32_16x16x32_bf16 v[40:43], v[128:131], v[168:171], v[40:43]
    ds_read2_b32 v[68:69], v24 offset0:80 offset1:81
    ds_read2_b32 v[70:71], v24 offset0:82 offset1:83
    v_mfma_f32_16x16x32_bf16 v[44:47], v[128:131], v[172:175], v[44:47]
    ds_read_b128 v[100:103], v28 offset:832
    v_mfma_f32_16x16x32_bf16 v[48:51], v[128:131], v[176:179], v[48:51]
    ds_read2_b32 v[72:73], v25 offset0:208 offset1:209
    ds_read2_b32 v[74:75], v25 offset0:210 offset1:211
    v_mfma_f32_16x16x32_bf16 v[52:55], v[128:131], v[180:183], v[52:55]
    ds_read_b128 v[104:107], v28 offset:1344
    v_mfma_f32_16x16x32_bf16 v[56:59], v[128:131], v[184:187], v[56:59]
    ds_read2_b32 v[76:77], v25 offset0:80 offset1:81
    ds_read2_b32 v[78:79], v25 offset0:82 offset1:83
    v_mfma_f32_16x16x32_bf16 v[60:63], v[128:131], v[188:191], v[60:63]
    ds_read_b128 v[108:111], v28 offset:1856
    v_mfma_f32_16x16x32_bf16 v[36:39], v[132:135], v[160:163], v[36:39]
    ds_read2_b32 v[80:81], v26 offset0:208 offset1:209
    ds_read2_b32 v[82:83], v26 offset0:210 offset1:211
    v_mfma_f32_16x16x32_bf16 v[40:43], v[132:135], v[164:167], v[40:43]
    ds_read_b128 v[112:115], v28 offset:2368
    v_mfma_f32_16x16x32_bf16 v[44:47], v[132:135], v[168:171], v[44:47]
    ds_read2_b32 v[84:85], v26 offset0:80 offset1:81
    ds_read2_b32 v[86:87], v26 offset0:82 offset1:83
    v_mfma_f32_16x16x32_bf16 v[48:51], v[132:135], v[172:175], v[48:51]
    ds_read_b128 v[116:119], v28 offset:2880
    v_mfma_f32_16x16x32_bf16 v[52:55], v[132:135], v[176:179], v[52:55]
    ds_read2_b32 v[88:89], v27 offset0:208 offset1:209
    ds_read2_b32 v[90:91], v27 offset0:210 offset1:211
    v_mfma_f32_16x16x32_bf16 v[56:59], v[132:135], v[180:183], v[56:59]
    ds_read_b128 v[120:123], v28 offset:3392
    v_mfma_f32_16x16x32_bf16 v[60:63], v[132:135], v[184:187], v[60:63]
    ds_read2_b32 v[92:93], v27 offset0:80 offset1:81
    ds_read2_b32 v[94:95], v27 offset0:82 offset1:83
    v_mfma_f32_16x16x32_bf16 v[40:43], v[136:139], v[160:163], v[40:43]
    ds_read_b128 v[124:127], v28 offset:3904
    v_mfma_f32_16x16x32_bf16 v[44:47], v[136:139], v[164:167], v[44:47]
    v_mfma_f32_16x16x32_bf16 v[48:51], v[136:139], v[168:171], v[48:51]
    v_mfma_f32_16x16x32_bf16 v[52:55], v[136:139], v[172:175], v[52:55]
    v_mfma_f32_16x16x32_bf16 v[56:59], v[136:139], v[176:179], v[56:59]
    v_mfma_f32_16x16x32_bf16 v[60:63], v[136:139], v[180:183], v[60:63]
    v_mfma_f32_16x16x32_bf16 v[44:47], v[140:143], v[160:163], v[44:47]
    v_mfma_f32_16x16x32_bf16 v[48:51], v[140:143], v[164:167], v[48:51]
    v_mfma_f32_16x16x32_bf16 v[52:55], v[140:143], v[168:171], v[52:55]
    v_mfma_f32_16x16x32_bf16 v[56:59], v[140:143], v[172:175], v[56:59]
    v_mfma_f32_16x16x32_bf16 v[60:63], v[140:143], v[176:179], v[60:63]
    v_mfma_f32_16x16x32_bf16 v[48:51], v[144:147], v[160:163], v[48:51]
    v_mfma_f32_16x16x32_bf16 v[52:55], v[144:147], v[164:167], v[52:55]
    v_mfma_f32_16x16x32_bf16 v[56:59], v[144:147], v[168:171], v[56:59]
    v_mfma_f32_16x16x32_bf16 v[60:63], v[144:147], v[172:175], v[60:63]
    v_mfma_f32_16x16x32_bf16 v[52:55], v[148:151], v[160:163], v[52:55]
    v_mfma_f32_16x16x32_bf16 v[56:59], v[148:151], v[164:167], v[56:59]
    v_mfma_f32_16x16x32_bf16 v[60:63], v[148:151], v[168:171], v[60:63]
    v_mfma_f32_16x16x32_bf16 v[56:59], v[152:155], v[160:163], v[56:59]
    v_mfma_f32_16x16x32_bf16 v[60:63], v[152:155], v[164:167], v[60:63]
    v_mfma_f32_16x16x32_bf16 v[60:63], v[156:159], v[160:163], v[60:63]
    s_waitcnt lgkmcnt(0)
    v_mfma_f32_16x16x32_bf16 v[32:35], v[64:67], v[96:99], v[32:35]
    ds_read2_b32 v[128:129], v24 offset0:192 offset1:193
    ds_read2_b32 v[130:131], v24 offset0:194 offset1:195
    v_mfma_f32_16x16x32_bf16 v[36:39], v[64:67], v[100:103], v[36:39]
    ds_read_b128 v[160:163], v28 offset:256
    v_mfma_f32_16x16x32_bf16 v[40:43], v[64:67], v[104:107], v[40:43]
    ds_read2_b32 v[132:133], v24 offset0:64 offset1:65
    ds_read2_b32 v[134:135], v24 offset0:66 offset1:67
    v_mfma_f32_16x16x32_bf16 v[44:47], v[64:67], v[108:111], v[44:47]
    ds_read_b128 v[164:167], v28 offset:768
    v_mfma_f32_16x16x32_bf16 v[48:51], v[64:67], v[112:115], v[48:51]
    ds_read2_b32 v[136:137], v25 offset0:192 offset1:193
    ds_read2_b32 v[138:139], v25 offset0:194 offset1:195
    v_mfma_f32_16x16x32_bf16 v[52:55], v[64:67], v[116:119], v[52:55]
    ds_read_b128 v[168:171], v28 offset:1280
    v_mfma_f32_16x16x32_bf16 v[56:59], v[64:67], v[120:123], v[56:59]
    ds_read2_b32 v[140:141], v25 offset0:64 offset1:65
    ds_read2_b32 v[142:143], v25 offset0:66 offset1:67
    v_mfma_f32_16x16x32_bf16 v[60:63], v[64:67], v[124:127], v[60:63]
    ds_read_b128 v[172:175], v28 offset:1792
    v_mfma_f32_16x16x32_bf16 v[36:39], v[68:71], v[96:99], v[36:39]
    ds_read2_b32 v[144:145], v26 offset0:192 offset1:193
    ds_read2_b32 v[146:147], v26 offset0:194 offset1:195
    v_mfma_f32_16x16x32_bf16 v[40:43], v[68:71], v[100:103], v[40:43]
    ds_read_b128 v[176:179], v28 offset:2304
    v_mfma_f32_16x16x32_bf16 v[44:47], v[68:71], v[104:107], v[44:47]
    ds_read2_b32 v[148:149], v26 offset0:64 offset1:65
    ds_read2_b32 v[150:151], v26 offset0:66 offset1:67
    v_mfma_f32_16x16x32_bf16 v[48:51], v[68:71], v[108:111], v[48:51]
    ds_read_b128 v[180:183], v28 offset:2816
    v_mfma_f32_16x16x32_bf16 v[52:55], v[68:71], v[112:115], v[52:55]
    ds_read2_b32 v[152:153], v27 offset0:192 offset1:193
    ds_read2_b32 v[154:155], v27 offset0:194 offset1:195
    v_mfma_f32_16x16x32_bf16 v[56:59], v[68:71], v[116:119], v[56:59]
    ds_read_b128 v[184:187], v28 offset:3328
    v_mfma_f32_16x16x32_bf16 v[60:63], v[68:71], v[120:123], v[60:63]
    ds_read2_b32 v[156:157], v27 offset0:64 offset1:65
    ds_read2_b32 v[158:159], v27 offset0:66 offset1:67
    v_mfma_f32_16x16x32_bf16 v[40:43], v[72:75], v[96:99], v[40:43]
    ds_read_b128 v[188:191], v28 offset:3840
    v_mfma_f32_16x16x32_bf16 v[44:47], v[72:75], v[100:103], v[44:47]
    v_mfma_f32_16x16x32_bf16 v[48:51], v[72:75], v[104:107], v[48:51]
    v_mfma_f32_16x16x32_bf16 v[52:55], v[72:75], v[108:111], v[52:55]
    v_mfma_f32_16x16x32_bf16 v[56:59], v[72:75], v[112:115], v[56:59]
    v_mfma_f32_16x16x32_bf16 v[60:63], v[72:75], v[116:119], v[60:63]
    v_mfma_f32_16x16x32_bf16 v[44:47], v[76:79], v[96:99], v[44:47]
    v_mfma_f32_16x16x32_bf16 v[48:51], v[76:79], v[100:103], v[48:51]
    v_mfma_f32_16x16x32_bf16 v[52:55], v[76:79], v[104:107], v[52:55]
    v_mfma_f32_16x16x32_bf16 v[56:59], v[76:79], v[108:111], v[56:59]
    v_mfma_f32_16x16x32_bf16 v[60:63], v[76:79], v[112:115], v[60:63]
    v_mfma_f32_16x16x32_bf16 v[48:51], v[80:83], v[96:99], v[48:51]
    v_mfma_f32_16x16x32_bf16 v[52:55], v[80:83], v[100:103], v[52:55]
    v_mfma_f32_16x16x32_bf16 v[56:59], v[80:83], v[104:107], v[56:59]
    v_mfma_f32_16x16x32_bf16 v[60:63], v[80:83], v[108:111], v[60:63]
    v_mfma_f32_16x16x32_bf16 v[52:55], v[84:87], v[96:99], v[52:55]
    v_mfma_f32_16x16x32_bf16 v[56:59], v[84:87], v[100:103], v[56:59]
    v_mfma_f32_16x16x32_bf16 v[60:63], v[84:87], v[104:107], v[60:63]
    v_mfma_f32_16x16x32_bf16 v[56:59], v[88:91], v[96:99], v[56:59]
    v_mfma_f32_16x16x32_bf16 v[60:63], v[88:91], v[100:103], v[60:63]
    v_mfma_f32_16x16x32_bf16 v[60:63], v[92:95], v[96:99], v[60:63]
    s_waitcnt lgkmcnt(0)
    v_mfma_f32_16x16x32_bf16 v[32:35], v[128:131], v[160:163], v[32:35]
    ds_read2_b32 v[64:65], v24 offset0:176 offset1:177
    ds_read2_b32 v[66:67], v24 offset0:178 offset1:179
    v_mfma_f32_16x16x32_bf16 v[36:39], v[128:131], v[164:167], v[36:39]
    ds_read_b128 v[96:99], v28 offset:192
    v_mfma_f32_16x16x32_bf16 v[40:43], v[128:131], v[168:171], v[40:43]
    ds_read2_b32 v[68:69], v24 offset0:48 offset1:49
    ds_read2_b32 v[70:71], v24 offset0:50 offset1:51
    v_mfma_f32_16x16x32_bf16 v[44:47], v[128:131], v[172:175], v[44:47]
    ds_read_b128 v[100:103], v28 offset:704
    v_mfma_f32_16x16x32_bf16 v[48:51], v[128:131], v[176:179], v[48:51]
    ds_read2_b32 v[72:73], v25 offset0:176 offset1:177
    ds_read2_b32 v[74:75], v25 offset0:178 offset1:179
    v_mfma_f32_16x16x32_bf16 v[52:55], v[128:131], v[180:183], v[52:55]
    ds_read_b128 v[104:107], v28 offset:1216
    v_mfma_f32_16x16x32_bf16 v[56:59], v[128:131], v[184:187], v[56:59]
    ds_read2_b32 v[76:77], v25 offset0:48 offset1:49
    ds_read2_b32 v[78:79], v25 offset0:50 offset1:51
    v_mfma_f32_16x16x32_bf16 v[60:63], v[128:131], v[188:191], v[60:63]
    ds_read_b128 v[108:111], v28 offset:1728
    v_mfma_f32_16x16x32_bf16 v[36:39], v[132:135], v[160:163], v[36:39]
    ds_read2_b32 v[80:81], v26 offset0:176 offset1:177
    ds_read2_b32 v[82:83], v26 offset0:178 offset1:179
    v_mfma_f32_16x16x32_bf16 v[40:43], v[132:135], v[164:167], v[40:43]
    ds_read_b128 v[112:115], v28 offset:2240
    v_mfma_f32_16x16x32_bf16 v[44:47], v[132:135], v[168:171], v[44:47]
    ds_read2_b32 v[84:85], v26 offset0:48 offset1:49
    ds_read2_b32 v[86:87], v26 offset0:50 offset1:51
    v_mfma_f32_16x16x32_bf16 v[48:51], v[132:135], v[172:175], v[48:51]
    ds_read_b128 v[116:119], v28 offset:2752
    v_mfma_f32_16x16x32_bf16 v[52:55], v[132:135], v[176:179], v[52:55]
    ds_read2_b32 v[88:89], v27 offset0:176 offset1:177
    ds_read2_b32 v[90:91], v27 offset0:178 offset1:179
    v_mfma_f32_16x16x32_bf16 v[56:59], v[132:135], v[180:183], v[56:59]
    ds_read_b128 v[120:123], v28 offset:3264
    v_mfma_f32_16x16x32_bf16 v[60:63], v[132:135], v[184:187], v[60:63]
    ds_read2_b32 v[92:93], v27 offset0:48 offset1:49
    ds_read2_b32 v[94:95], v27 offset0:50 offset1:51
    v_mfma_f32_16x16x32_bf16 v[40:43], v[136:139], v[160:163], v[40:43]
    ds_read_b128 v[124:127], v28 offset:3776
    v_mfma_f32_16x16x32_bf16 v[44:47], v[136:139], v[164:167], v[44:47]
    v_mfma_f32_16x16x32_bf16 v[48:51], v[136:139], v[168:171], v[48:51]
    v_mfma_f32_16x16x32_bf16 v[52:55], v[136:139], v[172:175], v[52:55]
    v_mfma_f32_16x16x32_bf16 v[56:59], v[136:139], v[176:179], v[56:59]
    v_mfma_f32_16x16x32_bf16 v[60:63], v[136:139], v[180:183], v[60:63]
    v_mfma_f32_16x16x32_bf16 v[44:47], v[140:143], v[160:163], v[44:47]
    v_mfma_f32_16x16x32_bf16 v[48:51], v[140:143], v[164:167], v[48:51]
    v_mfma_f32_16x16x32_bf16 v[52:55], v[140:143], v[168:171], v[52:55]
    v_mfma_f32_16x16x32_bf16 v[56:59], v[140:143], v[172:175], v[56:59]
    v_mfma_f32_16x16x32_bf16 v[60:63], v[140:143], v[176:179], v[60:63]
    v_mfma_f32_16x16x32_bf16 v[48:51], v[144:147], v[160:163], v[48:51]
    v_mfma_f32_16x16x32_bf16 v[52:55], v[144:147], v[164:167], v[52:55]
    v_mfma_f32_16x16x32_bf16 v[56:59], v[144:147], v[168:171], v[56:59]
    v_mfma_f32_16x16x32_bf16 v[60:63], v[144:147], v[172:175], v[60:63]
    v_mfma_f32_16x16x32_bf16 v[52:55], v[148:151], v[160:163], v[52:55]
    v_mfma_f32_16x16x32_bf16 v[56:59], v[148:151], v[164:167], v[56:59]
    v_mfma_f32_16x16x32_bf16 v[60:63], v[148:151], v[168:171], v[60:63]
    v_mfma_f32_16x16x32_bf16 v[56:59], v[152:155], v[160:163], v[56:59]
    v_mfma_f32_16x16x32_bf16 v[60:63], v[152:155], v[164:167], v[60:63]
    v_mfma_f32_16x16x32_bf16 v[60:63], v[156:159], v[160:163], v[60:63]
    s_waitcnt lgkmcnt(0)
    v_mfma_f32_16x16x32_bf16 v[32:35], v[64:67], v[96:99], v[32:35]
    ds_read2_b32 v[128:129], v24 offset0:160 offset1:161
    ds_read2_b32 v[130:131], v24 offset0:162 offset1:163
    v_mfma_f32_16x16x32_bf16 v[36:39], v[64:67], v[100:103], v[36:39]
    ds_read_b128 v[160:163], v28 offset:128
    v_mfma_f32_16x16x32_bf16 v[40:43], v[64:67], v[104:107], v[40:43]
    ds_read2_b32 v[132:133], v24 offset0:32 offset1:33
    ds_read2_b32 v[134:135], v24 offset0:34 offset1:35
    v_mfma_f32_16x16x32_bf16 v[44:47], v[64:67], v[108:111], v[44:47]
    ds_read_b128 v[164:167], v28 offset:640
    v_mfma_f32_16x16x32_bf16 v[48:51], v[64:67], v[112:115], v[48:51]
    ds_read2_b32 v[136:137], v25 offset0:160 offset1:161
    ds_read2_b32 v[138:139], v25 offset0:162 offset1:163
    v_mfma_f32_16x16x32_bf16 v[52:55], v[64:67], v[116:119], v[52:55]
    ds_read_b128 v[168:171], v28 offset:1152
    v_mfma_f32_16x16x32_bf16 v[56:59], v[64:67], v[120:123], v[56:59]
    ds_read2_b32 v[140:141], v25 offset0:32 offset1:33
    ds_read2_b32 v[142:143], v25 offset0:34 offset1:35
    v_mfma_f32_16x16x32_bf16 v[60:63], v[64:67], v[124:127], v[60:63]
    ds_read_b128 v[172:175], v28 offset:1664
    v_mfma_f32_16x16x32_bf16 v[36:39], v[68:71], v[96:99], v[36:39]
    ds_read2_b32 v[144:145], v26 offset0:160 offset1:161
    ds_read2_b32 v[146:147], v26 offset0:162 offset1:163
    v_mfma_f32_16x16x32_bf16 v[40:43], v[68:71], v[100:103], v[40:43]
    ds_read_b128 v[176:179], v28 offset:2176
    v_mfma_f32_16x16x32_bf16 v[44:47], v[68:71], v[104:107], v[44:47]
    ds_read2_b32 v[148:149], v26 offset0:32 offset1:33
    ds_read2_b32 v[150:151], v26 offset0:34 offset1:35
    v_mfma_f32_16x16x32_bf16 v[48:51], v[68:71], v[108:111], v[48:51]
    ds_read_b128 v[180:183], v28 offset:2688
    v_mfma_f32_16x16x32_bf16 v[52:55], v[68:71], v[112:115], v[52:55]
    ds_read2_b32 v[152:153], v27 offset0:160 offset1:161
    ds_read2_b32 v[154:155], v27 offset0:162 offset1:163
    v_mfma_f32_16x16x32_bf16 v[56:59], v[68:71], v[116:119], v[56:59]
    ds_read_b128 v[184:187], v28 offset:3200
    v_mfma_f32_16x16x32_bf16 v[60:63], v[68:71], v[120:123], v[60:63]
    ds_read2_b32 v[156:157], v27 offset0:32 offset1:33
    ds_read2_b32 v[158:159], v27 offset0:34 offset1:35
    v_mfma_f32_16x16x32_bf16 v[40:43], v[72:75], v[96:99], v[40:43]
    ds_read_b128 v[188:191], v28 offset:3712
    v_mfma_f32_16x16x32_bf16 v[44:47], v[72:75], v[100:103], v[44:47]
    v_mfma_f32_16x16x32_bf16 v[48:51], v[72:75], v[104:107], v[48:51]
    v_mfma_f32_16x16x32_bf16 v[52:55], v[72:75], v[108:111], v[52:55]
    v_mfma_f32_16x16x32_bf16 v[56:59], v[72:75], v[112:115], v[56:59]
    v_mfma_f32_16x16x32_bf16 v[60:63], v[72:75], v[116:119], v[60:63]
    v_mfma_f32_16x16x32_bf16 v[44:47], v[76:79], v[96:99], v[44:47]
    v_mfma_f32_16x16x32_bf16 v[48:51], v[76:79], v[100:103], v[48:51]
    v_mfma_f32_16x16x32_bf16 v[52:55], v[76:79], v[104:107], v[52:55]
    v_mfma_f32_16x16x32_bf16 v[56:59], v[76:79], v[108:111], v[56:59]
    v_mfma_f32_16x16x32_bf16 v[60:63], v[76:79], v[112:115], v[60:63]
    v_mfma_f32_16x16x32_bf16 v[48:51], v[80:83], v[96:99], v[48:51]
    v_mfma_f32_16x16x32_bf16 v[52:55], v[80:83], v[100:103], v[52:55]
    v_mfma_f32_16x16x32_bf16 v[56:59], v[80:83], v[104:107], v[56:59]
    v_mfma_f32_16x16x32_bf16 v[60:63], v[80:83], v[108:111], v[60:63]
    v_mfma_f32_16x16x32_bf16 v[52:55], v[84:87], v[96:99], v[52:55]
    v_mfma_f32_16x16x32_bf16 v[56:59], v[84:87], v[100:103], v[56:59]
    v_mfma_f32_16x16x32_bf16 v[60:63], v[84:87], v[104:107], v[60:63]
    v_mfma_f32_16x16x32_bf16 v[56:59], v[88:91], v[96:99], v[56:59]
    v_mfma_f32_16x16x32_bf16 v[60:63], v[88:91], v[100:103], v[60:63]
    v_mfma_f32_16x16x32_bf16 v[60:63], v[92:95], v[96:99], v[60:63]
    s_waitcnt lgkmcnt(0)
    v_mfma_f32_16x16x32_bf16 v[32:35], v[128:131], v[160:163], v[32:35]
    ds_read2_b32 v[64:65], v24 offset0:144 offset1:145
    ds_read2_b32 v[66:67], v24 offset0:146 offset1:147
    v_mfma_f32_16x16x32_bf16 v[36:39], v[128:131], v[164:167], v[36:39]
    ds_read_b128 v[96:99], v28 offset:64
    v_mfma_f32_16x16x32_bf16 v[40:43], v[128:131], v[168:171], v[40:43]
    ds_read2_b32 v[68:69], v24 offset0:16 offset1:17
    ds_read2_b32 v[70:71], v24 offset0:18 offset1:19
    v_mfma_f32_16x16x32_bf16 v[44:47], v[128:131], v[172:175], v[44:47]
    ds_read_b128 v[100:103], v28 offset:576
    v_mfma_f32_16x16x32_bf16 v[48:51], v[128:131], v[176:179], v[48:51]
    ds_read2_b32 v[72:73], v25 offset0:144 offset1:145
    ds_read2_b32 v[74:75], v25 offset0:146 offset1:147
    v_mfma_f32_16x16x32_bf16 v[52:55], v[128:131], v[180:183], v[52:55]
    ds_read_b128 v[104:107], v28 offset:1088
    v_mfma_f32_16x16x32_bf16 v[56:59], v[128:131], v[184:187], v[56:59]
    ds_read2_b32 v[76:77], v25 offset0:16 offset1:17
    ds_read2_b32 v[78:79], v25 offset0:18 offset1:19
    v_mfma_f32_16x16x32_bf16 v[60:63], v[128:131], v[188:191], v[60:63]
    ds_read_b128 v[108:111], v28 offset:1600
    v_mfma_f32_16x16x32_bf16 v[36:39], v[132:135], v[160:163], v[36:39]
    ds_read2_b32 v[80:81], v26 offset0:144 offset1:145
    ds_read2_b32 v[82:83], v26 offset0:146 offset1:147
    v_mfma_f32_16x16x32_bf16 v[40:43], v[132:135], v[164:167], v[40:43]
    ds_read_b128 v[112:115], v28 offset:2112
    v_mfma_f32_16x16x32_bf16 v[44:47], v[132:135], v[168:171], v[44:47]
    ds_read2_b32 v[84:85], v26 offset0:16 offset1:17
    ds_read2_b32 v[86:87], v26 offset0:18 offset1:19
    v_mfma_f32_16x16x32_bf16 v[48:51], v[132:135], v[172:175], v[48:51]
    ds_read_b128 v[116:119], v28 offset:2624
    v_mfma_f32_16x16x32_bf16 v[52:55], v[132:135], v[176:179], v[52:55]
    ds_read2_b32 v[88:89], v27 offset0:144 offset1:145
    ds_read2_b32 v[90:91], v27 offset0:146 offset1:147
    v_mfma_f32_16x16x32_bf16 v[56:59], v[132:135], v[180:183], v[56:59]
    ds_read_b128 v[120:123], v28 offset:3136
    v_mfma_f32_16x16x32_bf16 v[60:63], v[132:135], v[184:187], v[60:63]
    ds_read2_b32 v[92:93], v27 offset0:16 offset1:17
    ds_read2_b32 v[94:95], v27 offset0:18 offset1:19
    v_mfma_f32_16x16x32_bf16 v[40:43], v[136:139], v[160:163], v[40:43]
    ds_read_b128 v[124:127], v28 offset:3648
    v_mfma_f32_16x16x32_bf16 v[44:47], v[136:139], v[164:167], v[44:47]
    v_mfma_f32_16x16x32_bf16 v[48:51], v[136:139], v[168:171], v[48:51]
    v_mfma_f32_16x16x32_bf16 v[52:55], v[136:139], v[172:175], v[52:55]
    v_mfma_f32_16x16x32_bf16 v[56:59], v[136:139], v[176:179], v[56:59]
    v_mfma_f32_16x16x32_bf16 v[60:63], v[136:139], v[180:183], v[60:63]
    v_mfma_f32_16x16x32_bf16 v[44:47], v[140:143], v[160:163], v[44:47]
    v_mfma_f32_16x16x32_bf16 v[48:51], v[140:143], v[164:167], v[48:51]
    v_mfma_f32_16x16x32_bf16 v[52:55], v[140:143], v[168:171], v[52:55]
    v_mfma_f32_16x16x32_bf16 v[56:59], v[140:143], v[172:175], v[56:59]
    v_mfma_f32_16x16x32_bf16 v[60:63], v[140:143], v[176:179], v[60:63]
    v_mfma_f32_16x16x32_bf16 v[48:51], v[144:147], v[160:163], v[48:51]
    v_mfma_f32_16x16x32_bf16 v[52:55], v[144:147], v[164:167], v[52:55]
    v_mfma_f32_16x16x32_bf16 v[56:59], v[144:147], v[168:171], v[56:59]
    v_mfma_f32_16x16x32_bf16 v[60:63], v[144:147], v[172:175], v[60:63]
    v_mfma_f32_16x16x32_bf16 v[52:55], v[148:151], v[160:163], v[52:55]
    v_mfma_f32_16x16x32_bf16 v[56:59], v[148:151], v[164:167], v[56:59]
    v_mfma_f32_16x16x32_bf16 v[60:63], v[148:151], v[168:171], v[60:63]
    v_mfma_f32_16x16x32_bf16 v[56:59], v[152:155], v[160:163], v[56:59]
    v_mfma_f32_16x16x32_bf16 v[60:63], v[152:155], v[164:167], v[60:63]
    v_mfma_f32_16x16x32_bf16 v[60:63], v[156:159], v[160:163], v[60:63]
    s_waitcnt lgkmcnt(0)
    v_mfma_f32_16x16x32_bf16 v[32:35], v[64:67], v[96:99], v[32:35]
    ds_read2_b32 v[128:129], v24 offset0:128 offset1:129
    ds_read2_b32 v[130:131], v24 offset0:130 offset1:131
    v_mfma_f32_16x16x32_bf16 v[36:39], v[64:67], v[100:103], v[36:39]
    ds_read_b128 v[160:163], v28 offset:0
    v_mfma_f32_16x16x32_bf16 v[40:43], v[64:67], v[104:107], v[40:43]
    ds_read2_b32 v[132:133], v24 offset0:0 offset1:1
    ds_read2_b32 v[134:135], v24 offset0:2 offset1:3
    v_mfma_f32_16x16x32_bf16 v[44:47], v[64:67], v[108:111], v[44:47]
    ds_read_b128 v[164:167], v28 offset:512
    v_mfma_f32_16x16x32_bf16 v[48:51], v[64:67], v[112:115], v[48:51]
    ds_read2_b32 v[136:137], v25 offset0:128 offset1:129
    ds_read2_b32 v[138:139], v25 offset0:130 offset1:131
    v_mfma_f32_16x16x32_bf16 v[52:55], v[64:67], v[116:119], v[52:55]
    ds_read_b128 v[168:171], v28 offset:1024
    v_mfma_f32_16x16x32_bf16 v[56:59], v[64:67], v[120:123], v[56:59]
    ds_read2_b32 v[140:141], v25 offset0:0 offset1:1
    ds_read2_b32 v[142:143], v25 offset0:2 offset1:3
    v_mfma_f32_16x16x32_bf16 v[60:63], v[64:67], v[124:127], v[60:63]
    ds_read_b128 v[172:175], v28 offset:1536
    v_mfma_f32_16x16x32_bf16 v[36:39], v[68:71], v[96:99], v[36:39]
    ds_read2_b32 v[144:145], v26 offset0:128 offset1:129
    ds_read2_b32 v[146:147], v26 offset0:130 offset1:131
    v_mfma_f32_16x16x32_bf16 v[40:43], v[68:71], v[100:103], v[40:43]
    ds_read_b128 v[176:179], v28 offset:2048
    v_mfma_f32_16x16x32_bf16 v[44:47], v[68:71], v[104:107], v[44:47]
    ds_read2_b32 v[148:149], v26 offset0:0 offset1:1
    ds_read2_b32 v[150:151], v26 offset0:2 offset1:3
    v_mfma_f32_16x16x32_bf16 v[48:51], v[68:71], v[108:111], v[48:51]
    ds_read_b128 v[180:183], v28 offset:2560
    v_mfma_f32_16x16x32_bf16 v[52:55], v[68:71], v[112:115], v[52:55]
    ds_read2_b32 v[152:153], v27 offset0:128 offset1:129
    ds_read2_b32 v[154:155], v27 offset0:130 offset1:131
    v_mfma_f32_16x16x32_bf16 v[56:59], v[68:71], v[116:119], v[56:59]
    ds_read_b128 v[184:187], v28 offset:3072
    v_mfma_f32_16x16x32_bf16 v[60:63], v[68:71], v[120:123], v[60:63]
    ds_read2_b32 v[156:157], v27 offset0:0 offset1:1
    ds_read2_b32 v[158:159], v27 offset0:2 offset1:3
    v_mfma_f32_16x16x32_bf16 v[40:43], v[72:75], v[96:99], v[40:43]
    ds_read_b128 v[188:191], v28 offset:3584
    v_mfma_f32_16x16x32_bf16 v[44:47], v[72:75], v[100:103], v[44:47]
    v_mfma_f32_16x16x32_bf16 v[48:51], v[72:75], v[104:107], v[48:51]
    v_mfma_f32_16x16x32_bf16 v[52:55], v[72:75], v[108:111], v[52:55]
    v_mfma_f32_16x16x32_bf16 v[56:59], v[72:75], v[112:115], v[56:59]
    v_mfma_f32_16x16x32_bf16 v[60:63], v[72:75], v[116:119], v[60:63]
    v_mfma_f32_16x16x32_bf16 v[44:47], v[76:79], v[96:99], v[44:47]
    v_mfma_f32_16x16x32_bf16 v[48:51], v[76:79], v[100:103], v[48:51]
    v_mfma_f32_16x16x32_bf16 v[52:55], v[76:79], v[104:107], v[52:55]
    v_mfma_f32_16x16x32_bf16 v[56:59], v[76:79], v[108:111], v[56:59]
    v_mfma_f32_16x16x32_bf16 v[60:63], v[76:79], v[112:115], v[60:63]
    v_mfma_f32_16x16x32_bf16 v[48:51], v[80:83], v[96:99], v[48:51]
    v_mfma_f32_16x16x32_bf16 v[52:55], v[80:83], v[100:103], v[52:55]
    v_mfma_f32_16x16x32_bf16 v[56:59], v[80:83], v[104:107], v[56:59]
    v_mfma_f32_16x16x32_bf16 v[60:63], v[80:83], v[108:111], v[60:63]
    v_mfma_f32_16x16x32_bf16 v[52:55], v[84:87], v[96:99], v[52:55]
    v_mfma_f32_16x16x32_bf16 v[56:59], v[84:87], v[100:103], v[56:59]
    v_mfma_f32_16x16x32_bf16 v[60:63], v[84:87], v[104:107], v[60:63]
    v_mfma_f32_16x16x32_bf16 v[56:59], v[88:91], v[96:99], v[56:59]
    v_mfma_f32_16x16x32_bf16 v[60:63], v[88:91], v[100:103], v[60:63]
    v_mfma_f32_16x16x32_bf16 v[60:63], v[92:95], v[96:99], v[60:63]
    s_waitcnt lgkmcnt(0)
    v_mfma_f32_16x16x32_bf16 v[32:35], v[128:131], v[160:163], v[32:35]
    ds_read_b64 v[64:65], v30 offset:480
    v_mfma_f32_16x16x32_bf16 v[36:39], v[128:131], v[164:167], v[36:39]
    ds_read_b64 v[66:67], v30 offset:992
    v_mfma_f32_16x16x32_bf16 v[40:43], v[128:131], v[168:171], v[40:43]
    ds_read_b64 v[68:69], v30 offset:1504
    v_mfma_f32_16x16x32_bf16 v[44:47], v[128:131], v[172:175], v[44:47]
    ds_read_b64 v[70:71], v30 offset:2016
    v_mfma_f32_16x16x32_bf16 v[48:51], v[128:131], v[176:179], v[48:51]
    ds_read_b64 v[72:73], v30 offset:2528
    v_mfma_f32_16x16x32_bf16 v[52:55], v[128:131], v[180:183], v[52:55]
    ds_read_b64 v[74:75], v30 offset:3040
    v_mfma_f32_16x16x32_bf16 v[56:59], v[128:131], v[184:187], v[56:59]
    ds_read_b64 v[76:77], v30 offset:3552
    v_mfma_f32_16x16x32_bf16 v[60:63], v[128:131], v[188:191], v[60:63]
    ds_read_b64 v[78:79], v30 offset:4064
    v_mfma_f32_16x16x32_bf16 v[36:39], v[132:135], v[160:163], v[36:39]
    v_mfma_f32_16x16x32_bf16 v[40:43], v[132:135], v[164:167], v[40:43]
    v_mfma_f32_16x16x32_bf16 v[44:47], v[132:135], v[168:171], v[44:47]
    v_mfma_f32_16x16x32_bf16 v[48:51], v[132:135], v[172:175], v[48:51]
    v_mfma_f32_16x16x32_bf16 v[52:55], v[132:135], v[176:179], v[52:55]
    v_mfma_f32_16x16x32_bf16 v[56:59], v[132:135], v[180:183], v[56:59]
    v_mfma_f32_16x16x32_bf16 v[60:63], v[132:135], v[184:187], v[60:63]
    v_mfma_f32_16x16x32_bf16 v[40:43], v[136:139], v[160:163], v[40:43]
    v_mfma_f32_16x16x32_bf16 v[44:47], v[136:139], v[164:167], v[44:47]
    v_mfma_f32_16x16x32_bf16 v[48:51], v[136:139], v[168:171], v[48:51]
    v_mfma_f32_16x16x32_bf16 v[52:55], v[136:139], v[172:175], v[52:55]
    v_mfma_f32_16x16x32_bf16 v[56:59], v[136:139], v[176:179], v[56:59]
    v_mfma_f32_16x16x32_bf16 v[60:63], v[136:139], v[180:183], v[60:63]
    v_mfma_f32_16x16x32_bf16 v[44:47], v[140:143], v[160:163], v[44:47]
    v_mfma_f32_16x16x32_bf16 v[48:51], v[140:143], v[164:167], v[48:51]
    v_mfma_f32_16x16x32_bf16 v[52:55], v[140:143], v[168:171], v[52:55]
    v_mfma_f32_16x16x32_bf16 v[56:59], v[140:143], v[172:175], v[56:59]
    v_mfma_f32_16x16x32_bf16 v[60:63], v[140:143], v[176:179], v[60:63]
    v_mfma_f32_16x16x32_bf16 v[48:51], v[144:147], v[160:163], v[48:51]
    v_mfma_f32_16x16x32_bf16 v[52:55], v[144:147], v[164:167], v[52:55]
    v_mfma_f32_16x16x32_bf16 v[56:59], v[144:147], v[168:171], v[56:59]
    v_mfma_f32_16x16x32_bf16 v[60:63], v[144:147], v[172:175], v[60:63]
    v_mfma_f32_16x16x32_bf16 v[52:55], v[148:151], v[160:163], v[52:55]
    v_mfma_f32_16x16x32_bf16 v[56:59], v[148:151], v[164:167], v[56:59]
    v_mfma_f32_16x16x32_bf16 v[60:63], v[148:151], v[168:171], v[60:63]
    v_mfma_f32_16x16x32_bf16 v[56:59], v[152:155], v[160:163], v[56:59]
    v_mfma_f32_16x16x32_bf16 v[60:63], v[152:155], v[164:167], v[60:63]
    v_mfma_f32_16x16x32_bf16 v[60:63], v[156:159], v[160:163], v[60:63]
    s_lshl_b32 s64, s30, 12
    s_add_u32 s64, s64, 37748736
    s_add_u32 s4, s62, s64
    s_addc_u32 s5, s63, 0
    s_mov_b32 s6, 4096
    s_mov_b32 s7, 0x20000
    s_waitcnt lgkmcnt(0)
    v_lshlrev_b32 v21, 16, v215
    s_nop 3
    v_cvt_pk_bf16_f32 v128, v32, v33
    v_lshlrev_b32 v130, 16, v64
    v_and_b32 v131, 0xffff0000, v64
    v_mul_f32 v130, v130, v21
    v_mul_f32 v131, v131, v21
    v_and_b32 v129, 0xffff0000, v128
    v_cvt_pk_bf16_f32 v130, v130, v131
    v_lshlrev_b32 v128, 16, v128
    v_and_b32 v131, 0xffff0000, v130
    v_lshlrev_b32 v130, 16, v130
    v_add_f32 v129, v129, v131
    v_add_f32 v128, v128, v130
    v_cvt_pk_bf16_f32 v64, v128, v129
    v_cvt_pk_bf16_f32 v136, v34, v35
    v_lshlrev_b32 v138, 16, v65
    v_and_b32 v139, 0xffff0000, v65
    v_mul_f32 v138, v138, v21
    v_mul_f32 v139, v139, v21
    v_and_b32 v137, 0xffff0000, v136
    v_cvt_pk_bf16_f32 v138, v138, v139
    v_lshlrev_b32 v136, 16, v136
    v_and_b32 v139, 0xffff0000, v138
    v_lshlrev_b32 v138, 16, v138
    v_add_f32 v137, v137, v139
    v_add_f32 v136, v136, v138
    v_cvt_pk_bf16_f32 v65, v136, v137
    buffer_store_dwordx2 v[64:65], v29, s[4:7], 0 offen offset:0 sc1
    v_cvt_pk_bf16_f32 v144, v36, v37
    v_lshlrev_b32 v146, 16, v66
    v_and_b32 v147, 0xffff0000, v66
    v_mul_f32 v146, v146, v21
    v_mul_f32 v147, v147, v21
    v_and_b32 v145, 0xffff0000, v144
    v_cvt_pk_bf16_f32 v146, v146, v147
    v_lshlrev_b32 v144, 16, v144
    v_and_b32 v147, 0xffff0000, v146
    v_lshlrev_b32 v146, 16, v146
    v_add_f32 v145, v145, v147
    v_add_f32 v144, v144, v146
    v_cvt_pk_bf16_f32 v66, v144, v145
    v_cvt_pk_bf16_f32 v152, v38, v39
    v_lshlrev_b32 v154, 16, v67
    v_and_b32 v155, 0xffff0000, v67
    v_mul_f32 v154, v154, v21
    v_mul_f32 v155, v155, v21
    v_and_b32 v153, 0xffff0000, v152
    v_cvt_pk_bf16_f32 v154, v154, v155
    v_lshlrev_b32 v152, 16, v152
    v_and_b32 v155, 0xffff0000, v154
    v_lshlrev_b32 v154, 16, v154
    v_add_f32 v153, v153, v155
    v_add_f32 v152, v152, v154
    v_cvt_pk_bf16_f32 v67, v152, v153
    buffer_store_dwordx2 v[66:67], v29, s[4:7], 0 offen offset:512 sc1
    v_cvt_pk_bf16_f32 v128, v40, v41
    v_lshlrev_b32 v130, 16, v68
    v_and_b32 v131, 0xffff0000, v68
    v_mul_f32 v130, v130, v21
    v_mul_f32 v131, v131, v21
    v_and_b32 v129, 0xffff0000, v128
    v_cvt_pk_bf16_f32 v130, v130, v131
    v_lshlrev_b32 v128, 16, v128
    v_and_b32 v131, 0xffff0000, v130
    v_lshlrev_b32 v130, 16, v130
    v_add_f32 v129, v129, v131
    v_add_f32 v128, v128, v130
    v_cvt_pk_bf16_f32 v68, v128, v129
    v_cvt_pk_bf16_f32 v136, v42, v43
    v_lshlrev_b32 v138, 16, v69
    v_and_b32 v139, 0xffff0000, v69
    v_mul_f32 v138, v138, v21
    v_mul_f32 v139, v139, v21
    v_and_b32 v137, 0xffff0000, v136
    v_cvt_pk_bf16_f32 v138, v138, v139
    v_lshlrev_b32 v136, 16, v136
    v_and_b32 v139, 0xffff0000, v138
    v_lshlrev_b32 v138, 16, v138
    v_add_f32 v137, v137, v139
    v_add_f32 v136, v136, v138
    v_cvt_pk_bf16_f32 v69, v136, v137
    buffer_store_dwordx2 v[68:69], v29, s[4:7], 0 offen offset:1024 sc1
    v_cvt_pk_bf16_f32 v144, v44, v45
    v_lshlrev_b32 v146, 16, v70
    v_and_b32 v147, 0xffff0000, v70
    v_mul_f32 v146, v146, v21
    v_mul_f32 v147, v147, v21
    v_and_b32 v145, 0xffff0000, v144
    v_cvt_pk_bf16_f32 v146, v146, v147
    v_lshlrev_b32 v144, 16, v144
    v_and_b32 v147, 0xffff0000, v146
    v_lshlrev_b32 v146, 16, v146
    v_add_f32 v145, v145, v147
    v_add_f32 v144, v144, v146
    v_cvt_pk_bf16_f32 v70, v144, v145
    v_cvt_pk_bf16_f32 v152, v46, v47
    v_lshlrev_b32 v154, 16, v71
    v_and_b32 v155, 0xffff0000, v71
    v_mul_f32 v154, v154, v21
    v_mul_f32 v155, v155, v21
    v_and_b32 v153, 0xffff0000, v152
    v_cvt_pk_bf16_f32 v154, v154, v155
    v_lshlrev_b32 v152, 16, v152
    v_and_b32 v155, 0xffff0000, v154
    v_lshlrev_b32 v154, 16, v154
    v_add_f32 v153, v153, v155
    v_add_f32 v152, v152, v154
    v_cvt_pk_bf16_f32 v71, v152, v153
    buffer_store_dwordx2 v[70:71], v29, s[4:7], 0 offen offset:1536 sc1
    v_cvt_pk_bf16_f32 v128, v48, v49
    v_lshlrev_b32 v130, 16, v72
    v_and_b32 v131, 0xffff0000, v72
    v_mul_f32 v130, v130, v21
    v_mul_f32 v131, v131, v21
    v_and_b32 v129, 0xffff0000, v128
    v_cvt_pk_bf16_f32 v130, v130, v131
    v_lshlrev_b32 v128, 16, v128
    v_and_b32 v131, 0xffff0000, v130
    v_lshlrev_b32 v130, 16, v130
    v_add_f32 v129, v129, v131
    v_add_f32 v128, v128, v130
    v_cvt_pk_bf16_f32 v72, v128, v129
    v_cvt_pk_bf16_f32 v136, v50, v51
    v_lshlrev_b32 v138, 16, v73
    v_and_b32 v139, 0xffff0000, v73
    v_mul_f32 v138, v138, v21
    v_mul_f32 v139, v139, v21
    v_and_b32 v137, 0xffff0000, v136
    v_cvt_pk_bf16_f32 v138, v138, v139
    v_lshlrev_b32 v136, 16, v136
    v_and_b32 v139, 0xffff0000, v138
    v_lshlrev_b32 v138, 16, v138
    v_add_f32 v137, v137, v139
    v_add_f32 v136, v136, v138
    v_cvt_pk_bf16_f32 v73, v136, v137
    buffer_store_dwordx2 v[72:73], v29, s[4:7], 0 offen offset:2048 sc1
    v_cvt_pk_bf16_f32 v144, v52, v53
    v_lshlrev_b32 v146, 16, v74
    v_and_b32 v147, 0xffff0000, v74
    v_mul_f32 v146, v146, v21
    v_mul_f32 v147, v147, v21
    v_and_b32 v145, 0xffff0000, v144
    v_cvt_pk_bf16_f32 v146, v146, v147
    v_lshlrev_b32 v144, 16, v144
    v_and_b32 v147, 0xffff0000, v146
    v_lshlrev_b32 v146, 16, v146
    v_add_f32 v145, v145, v147
    v_add_f32 v144, v144, v146
    v_cvt_pk_bf16_f32 v74, v144, v145
    v_cvt_pk_bf16_f32 v152, v54, v55
    v_lshlrev_b32 v154, 16, v75
    v_and_b32 v155, 0xffff0000, v75
    v_mul_f32 v154, v154, v21
    v_mul_f32 v155, v155, v21
    v_and_b32 v153, 0xffff0000, v152
    v_cvt_pk_bf16_f32 v154, v154, v155
    v_lshlrev_b32 v152, 16, v152
    v_and_b32 v155, 0xffff0000, v154
    v_lshlrev_b32 v154, 16, v154
    v_add_f32 v153, v153, v155
    v_add_f32 v152, v152, v154
    v_cvt_pk_bf16_f32 v75, v152, v153
    buffer_store_dwordx2 v[74:75], v29, s[4:7], 0 offen offset:2560 sc1
    v_cvt_pk_bf16_f32 v128, v56, v57
    v_lshlrev_b32 v130, 16, v76
    v_and_b32 v131, 0xffff0000, v76
    v_mul_f32 v130, v130, v21
    v_mul_f32 v131, v131, v21
    v_and_b32 v129, 0xffff0000, v128
    v_cvt_pk_bf16_f32 v130, v130, v131
    v_lshlrev_b32 v128, 16, v128
    v_and_b32 v131, 0xffff0000, v130
    v_lshlrev_b32 v130, 16, v130
    v_add_f32 v129, v129, v131
    v_add_f32 v128, v128, v130
    v_cvt_pk_bf16_f32 v76, v128, v129
    v_cvt_pk_bf16_f32 v136, v58, v59
    v_lshlrev_b32 v138, 16, v77
    v_and_b32 v139, 0xffff0000, v77
    v_mul_f32 v138, v138, v21
    v_mul_f32 v139, v139, v21
    v_and_b32 v137, 0xffff0000, v136
    v_cvt_pk_bf16_f32 v138, v138, v139
    v_lshlrev_b32 v136, 16, v136
    v_and_b32 v139, 0xffff0000, v138
    v_lshlrev_b32 v138, 16, v138
    v_add_f32 v137, v137, v139
    v_add_f32 v136, v136, v138
    v_cvt_pk_bf16_f32 v77, v136, v137
    buffer_store_dwordx2 v[76:77], v29, s[4:7], 0 offen offset:3072 sc1
    v_cvt_pk_bf16_f32 v144, v60, v61
    v_lshlrev_b32 v146, 16, v78
    v_and_b32 v147, 0xffff0000, v78
    v_mul_f32 v146, v146, v21
    v_mul_f32 v147, v147, v21
    v_and_b32 v145, 0xffff0000, v144
    v_cvt_pk_bf16_f32 v146, v146, v147
    v_lshlrev_b32 v144, 16, v144
    v_and_b32 v147, 0xffff0000, v146
    v_lshlrev_b32 v146, 16, v146
    v_add_f32 v145, v145, v147
    v_add_f32 v144, v144, v146
    v_cvt_pk_bf16_f32 v78, v144, v145
    v_cvt_pk_bf16_f32 v152, v62, v63
    v_lshlrev_b32 v154, 16, v79
    v_and_b32 v155, 0xffff0000, v79
    v_mul_f32 v154, v154, v21
    v_mul_f32 v155, v155, v21
    v_and_b32 v153, 0xffff0000, v152
    v_cvt_pk_bf16_f32 v154, v154, v155
    v_lshlrev_b32 v152, 16, v152
    v_and_b32 v155, 0xffff0000, v154
    v_lshlrev_b32 v154, 16, v154
    v_add_f32 v153, v153, v155
    v_add_f32 v152, v152, v154
    v_cvt_pk_bf16_f32 v79, v152, v153
    buffer_store_dwordx2 v[78:79], v29, s[4:7], 0 offen offset:3584 sc1
    s_waitcnt vmcnt(0)
    v_mov_b32 v6, 163584
    v_mov_b32 v7, 1
    s_mov_b64 exec, 1
    ds_add_rtn_u32 v7, v6, v7
    s_mov_b64 exec, -1
    s_waitcnt lgkmcnt(0)
    v_readfirstlane_b32 s64, v7
    s_nop 0
    s_cmp_lg_u32 s64, 3
    s_cbranch_scc1 gated_mix__ssm_conv_s4d__mixer_gmlp__prompt_kernel_Cnc2
    s_lshr_b32 s74, s30, 2
    s_mul_i32 s72, s74, 3641
    s_lshr_b32 s72, s72, 16
    s_mul_i32 s73, s72, 18
    s_sub_u32 s73, s74, s73
    v_lshlrev_b32 v14, 3, v0
    v_add_u32 v14, s72, v14
    v_lshlrev_b32 v14, 8, v14
    s_lshl_b32 s64, s73, 2
    s_add_u32 s64, s64, 131072
    v_mov_b32 v15, 1
    s_mov_b64 exec, 0xffffffff
    buffer_store_dword v15, v14, s[20:23], s64 offen sc1
    s_mov_b64 exec, -1
    s_branch gated_mix__ssm_conv_s4d__mixer_gmlp__prompt_kernel_Cnc2
gated_mix__ssm_conv_s4d__mixer_gmlp__prompt_kernel_Cnc:
    s_waitcnt vmcnt(0)
    s_lshr_b32 s65, s25, 1
    s_lshl_b32 s70, s65, 2
    s_add_u32 s70, s70, 163592
    v_mov_b32 v200, s70
    v_mov_b32 v201, 1
    s_mov_b64 exec, 1
    ds_add_rtn_u32 v201, v200, v201
    s_mov_b64 exec, -1
    s_waitcnt lgkmcnt(0)
    v_readfirstlane_b32 s64, v201
    s_nop 0
    s_cmp_lg_u32 s64, 1
    s_cbranch_scc1 gated_mix__ssm_conv_s4d__mixer_gmlp__prompt_kernel_Cnhb
    s_lshl_b32 s71, s27, 1
    s_add_u32 s71, s71, s65
    s_lshl_b32 s71, s71, 3
    v_add_u32 v200, s71, v0
    v_lshlrev_b32 v200, 8, v200
    s_lshl_b32 s64, s26, 2
    s_add_u32 s64, s64, 65536
    v_mov_b32 v201, 1
    s_mov_b64 exec, 0xff
    buffer_store_dword v201, v200, s[20:23], s64 offen sc1
    s_mov_b64 exec, -1
gated_mix__ssm_conv_s4d__mixer_gmlp__prompt_kernel_Cnhb:
    s_cmp_lt_u32 s26, 12
    s_cbranch_scc1 gated_mix__ssm_conv_s4d__mixer_gmlp__prompt_kernel_Cnc2
    s_cmp_lt_u32 s26, 12
    s_cbranch_scc1 gated_mix__ssm_conv_s4d__mixer_gmlp__prompt_kernel_gi
    s_mov_b32 s4, s32
    s_mov_b32 s5, s33
    s_mov_b32 s6, 2359296
    s_mov_b32 s7, 0x20000
    s_lshl_b32 s64, s27, 2
    s_add_u32 s64, s64, s26
    s_sub_u32 s64, s64, 12
    s_lshl_b32 s64, s64, 2
    s_add_u32 s64, s64, s25
    s_lshl_b32 s64, s64, 3
    v_lshrrev_b32 v165, 4, v0
    v_add_u32 v165, s64, v165
    v_and_b32 v126, 15, v0
    v_lshlrev_b32 v126, 3, v126
    v_mul_u32_u24 v127, 1152, v165
    v_add_u32 v127, v127, v126
    s_movk_i32 s64, 4608
    buffer_load_dwordx2 v[64:65], v127, s[4:7], 0 offen offset:0
    buffer_load_dwordx2 v[66:67], v127, s[4:7], 0 offen offset:128
    buffer_load_dwordx2 v[68:69], v127, s[4:7], 0 offen offset:256
    buffer_load_dwordx2 v[70:71], v127, s[4:7], 0 offen offset:384
    buffer_load_dwordx2 v[72:73], v127, s[4:7], 0 offen offset:512
    buffer_load_dwordx2 v[74:75], v127, s[4:7], 0 offen offset:640
    buffer_load_dwordx2 v[76:77], v127, s[4:7], 0 offen offset:768
    buffer_load_dwordx2 v[78:79], v127, s[4:7], 0 offen offset:896
    buffer_load_dwordx2 v[80:81], v127, s[4:7], 0 offen offset:1024
    buffer_load_dwordx2 v[82:83], v127, s[4:7], s64 offen offset:0
    buffer_load_dwordx2 v[84:85], v127, s[4:7], s64 offen offset:128
    buffer_load_dwordx2 v[86:87], v127, s[4:7], s64 offen offset:256
    buffer_load_dwordx2 v[88:89], v127, s[4:7], s64 offen offset:384
    buffer_load_dwordx2 v[90:91], v127, s[4:7], s64 offen offset:512
    buffer_load_dwordx2 v[92:93], v127, s[4:7], s64 offen offset:640
    buffer_load_dwordx2 v[94:95], v127, s[4:7], s64 offen offset:768
    buffer_load_dwordx2 v[96:97], v127, s[4:7], s64 offen offset:896
    buffer_load_dwordx2 v[98:99], v127, s[4:7], s64 offen offset:1024
    s_mov_b32 s4, s56
    s_mov_b32 s5, s57
    s_mov_b32 s6, 1152
    s_mov_b32 s7, 0x20000
    buffer_load_dwordx2 v[100:101], v126, s[4:7], 0 offen offset:0
    buffer_load_dwordx2 v[102:103], v126, s[4:7], 0 offen offset:128
    buffer_load_dwordx2 v[104:105], v126, s[4:7], 0 offen offset:256
    buffer_load_dwordx2 v[106:107], v126, s[4:7], 0 offen offset:384
    buffer_load_dwordx2 v[108:109], v126, s[4:7], 0 offen offset:512
    buffer_load_dwordx2 v[110:111], v126, s[4:7], 0 offen offset:640
    buffer_load_dwordx2 v[112:113], v126, s[4:7], 0 offen offset:768
    buffer_load_dwordx2 v[114:115], v126, s[4:7], 0 offen offset:896
    buffer_load_dwordx2 v[116:117], v126, s[4:7], 0 offen offset:1024
gated_mix__ssm_conv_s4d__mixer_gmlp__prompt_kernel_gi:
    s_cmp_lt_u32 s26, 12
    s_cbranch_scc1 gated_mix__ssm_conv_s4d__mixer_gmlp__prompt_kernel_gj0
    v_mov_b32 v128, 0
    s_waitcnt vmcnt(0)
    v_lshlrev_b32 v156, 16, v64
    v_and_b32 v157, 0xffff0000, v64
    v_lshlrev_b32 v158, 16, v100
    v_and_b32 v159, 0xffff0000, v100
    v_mul_f32 v156, v156, v158
    v_mul_f32 v157, v157, v159
    v_cvt_pk_bf16_f32 v156, v156, v157
    v_and_b32 v157, 0xffff0000, v156
    v_lshlrev_b32 v156, 16, v156
    v_add_f32 v128, v128, v157
    v_add_f32 v128, v128, v156
    v_lshlrev_b32 v160, 16, v65
    v_and_b32 v161, 0xffff0000, v65
    v_lshlrev_b32 v162, 16, v101
    v_and_b32 v163, 0xffff0000, v101
    v_mul_f32 v160, v160, v162
    v_mul_f32 v161, v161, v163
    v_cvt_pk_bf16_f32 v160, v160, v161
    v_and_b32 v161, 0xffff0000, v160
    v_lshlrev_b32 v160, 16, v160
    v_add_f32 v128, v128, v161
    v_add_f32 v128, v128, v160
    v_lshlrev_b32 v156, 16, v66
    v_and_b32 v157, 0xffff0000, v66
    v_lshlrev_b32 v158, 16, v102
    v_and_b32 v159, 0xffff0000, v102
    v_mul_f32 v156, v156, v158
    v_mul_f32 v157, v157, v159
    v_cvt_pk_bf16_f32 v156, v156, v157
    v_and_b32 v157, 0xffff0000, v156
    v_lshlrev_b32 v156, 16, v156
    v_add_f32 v128, v128, v157
    v_add_f32 v128, v128, v156
    v_lshlrev_b32 v160, 16, v67
    v_and_b32 v161, 0xffff0000, v67
    v_lshlrev_b32 v162, 16, v103
    v_and_b32 v163, 0xffff0000, v103
    v_mul_f32 v160, v160, v162
    v_mul_f32 v161, v161, v163
    v_cvt_pk_bf16_f32 v160, v160, v161
    v_and_b32 v161, 0xffff0000, v160
    v_lshlrev_b32 v160, 16, v160
    v_add_f32 v128, v128, v161
    v_add_f32 v128, v128, v160
    v_lshlrev_b32 v156, 16, v68
    v_and_b32 v157, 0xffff0000, v68
    v_lshlrev_b32 v158, 16, v104
    v_and_b32 v159, 0xffff0000, v104
    v_mul_f32 v156, v156, v158
    v_mul_f32 v157, v157, v159
    v_cvt_pk_bf16_f32 v156, v156, v157
    v_and_b32 v157, 0xffff0000, v156
    v_lshlrev_b32 v156, 16, v156
    v_add_f32 v128, v128, v157
    v_add_f32 v128, v128, v156
    v_lshlrev_b32 v160, 16, v69
    v_and_b32 v161, 0xffff0000, v69
    v_lshlrev_b32 v162, 16, v105
    v_and_b32 v163, 0xffff0000, v105
    v_mul_f32 v160, v160, v162
    v_mul_f32 v161, v161, v163
    v_cvt_pk_bf16_f32 v160, v160, v161
    v_and_b32 v161, 0xffff0000, v160
    v_lshlrev_b32 v160, 16, v160
    v_add_f32 v128, v128, v161
    v_add_f32 v128, v128, v160
    v_lshlrev_b32 v156, 16, v70
    v_and_b32 v157, 0xffff0000, v70
    v_lshlrev_b32 v158, 16, v106
    v_and_b32 v159, 0xffff0000, v106
    v_mul_f32 v156, v156, v158
    v_mul_f32 v157, v157, v159
    v_cvt_pk_bf16_f32 v156, v156, v157
    v_and_b32 v157, 0xffff0000, v156
    v_lshlrev_b32 v156, 16, v156
    v_add_f32 v128, v128, v157
    v_add_f32 v128, v128, v156
    v_lshlrev_b32 v160, 16, v71
    v_and_b32 v161, 0xffff0000, v71
    v_lshlrev_b32 v162, 16, v107
    v_and_b32 v163, 0xffff0000, v107
    v_mul_f32 v160, v160, v162
    v_mul_f32 v161, v161, v163
    v_cvt_pk_bf16_f32 v160, v160, v161
    v_and_b32 v161, 0xffff0000, v160
    v_lshlrev_b32 v160, 16, v160
    v_add_f32 v128, v128, v161
    v_add_f32 v128, v128, v160
    v_lshlrev_b32 v156, 16, v72
    v_and_b32 v157, 0xffff0000, v72
    v_lshlrev_b32 v158, 16, v108
    v_and_b32 v159, 0xffff0000, v108
    v_mul_f32 v156, v156, v158
    v_mul_f32 v157, v157, v159
    v_cvt_pk_bf16_f32 v156, v156, v157
    v_and_b32 v157, 0xffff0000, v156
    v_lshlrev_b32 v156, 16, v156
    v_add_f32 v128, v128, v157
    v_add_f32 v128, v128, v156
    v_lshlrev_b32 v160, 16, v73
    v_and_b32 v161, 0xffff0000, v73
    v_lshlrev_b32 v162, 16, v109
    v_and_b32 v163, 0xffff0000, v109
    v_mul_f32 v160, v160, v162
    v_mul_f32 v161, v161, v163
    v_cvt_pk_bf16_f32 v160, v160, v161
    v_and_b32 v161, 0xffff0000, v160
    v_lshlrev_b32 v160, 16, v160
    v_add_f32 v128, v128, v161
    v_add_f32 v128, v128, v160
    v_lshlrev_b32 v156, 16, v74
    v_and_b32 v157, 0xffff0000, v74
    v_lshlrev_b32 v158, 16, v110
    v_and_b32 v159, 0xffff0000, v110
    v_mul_f32 v156, v156, v158
    v_mul_f32 v157, v157, v159
    v_cvt_pk_bf16_f32 v156, v156, v157
    v_and_b32 v157, 0xffff0000, v156
    v_lshlrev_b32 v156, 16, v156
    v_add_f32 v128, v128, v157
    v_add_f32 v128, v128, v156
    v_lshlrev_b32 v160, 16, v75
    v_and_b32 v161, 0xffff0000, v75
    v_lshlrev_b32 v162, 16, v111
    v_and_b32 v163, 0xffff0000, v111
    v_mul_f32 v160, v160, v162
    v_mul_f32 v161, v161, v163
    v_cvt_pk_bf16_f32 v160, v160, v161
    v_and_b32 v161, 0xffff0000, v160
    v_lshlrev_b32 v160, 16, v160
    v_add_f32 v128, v128, v161
    v_add_f32 v128, v128, v160
    v_lshlrev_b32 v156, 16, v76
    v_and_b32 v157, 0xffff0000, v76
    v_lshlrev_b32 v158, 16, v112
    v_and_b32 v159, 0xffff0000, v112
    v_mul_f32 v156, v156, v158
    v_mul_f32 v157, v157, v159
    v_cvt_pk_bf16_f32 v156, v156, v157
    v_and_b32 v157, 0xffff0000, v156
    v_lshlrev_b32 v156, 16, v156
    v_add_f32 v128, v128, v157
    v_add_f32 v128, v128, v156
    v_lshlrev_b32 v160, 16, v77
    v_and_b32 v161, 0xffff0000, v77
    v_lshlrev_b32 v162, 16, v113
    v_and_b32 v163, 0xffff0000, v113
    v_mul_f32 v160, v160, v162
    v_mul_f32 v161, v161, v163
    v_cvt_pk_bf16_f32 v160, v160, v161
    v_and_b32 v161, 0xffff0000, v160
    v_lshlrev_b32 v160, 16, v160
    v_add_f32 v128, v128, v161
    v_add_f32 v128, v128, v160
    v_lshlrev_b32 v156, 16, v78
    v_and_b32 v157, 0xffff0000, v78
    v_lshlrev_b32 v158, 16, v114
    v_and_b32 v159, 0xffff0000, v114
    v_mul_f32 v156, v156, v158
    v_mul_f32 v157, v157, v159
    v_cvt_pk_bf16_f32 v156, v156, v157
    v_and_b32 v157, 0xffff0000, v156
    v_lshlrev_b32 v156, 16, v156
    v_add_f32 v128, v128, v157
    v_add_f32 v128, v128, v156
    v_lshlrev_b32 v160, 16, v79
    v_and_b32 v161, 0xffff0000, v79
    v_lshlrev_b32 v162, 16, v115
    v_and_b32 v163, 0xffff0000, v115
    v_mul_f32 v160, v160, v162
    v_mul_f32 v161, v161, v163
    v_cvt_pk_bf16_f32 v160, v160, v161
    v_and_b32 v161, 0xffff0000, v160
    v_lshlrev_b32 v160, 16, v160
    v_add_f32 v128, v128, v161
    v_add_f32 v128, v128, v160
    v_lshlrev_b32 v156, 16, v80
    v_and_b32 v157, 0xffff0000, v80
    v_lshlrev_b32 v158, 16, v116
    v_and_b32 v159, 0xffff0000, v116
    v_mul_f32 v156, v156, v158
    v_mul_f32 v157, v157, v159
    v_cvt_pk_bf16_f32 v156, v156, v157
    v_and_b32 v157, 0xffff0000, v156
    v_lshlrev_b32 v156, 16, v156
    v_add_f32 v128, v128, v157
    v_add_f32 v128, v128, v156
    v_lshlrev_b32 v160, 16, v81
    v_and_b32 v161, 0xffff0000, v81
    v_lshlrev_b32 v162, 16, v117
    v_and_b32 v163, 0xffff0000, v117
    v_mul_f32 v160, v160, v162
    v_mul_f32 v161, v161, v163
    v_cvt_pk_bf16_f32 v160, v160, v161
    v_and_b32 v161, 0xffff0000, v160
    v_lshlrev_b32 v160, 16, v160
    v_add_f32 v128, v128, v161
    v_add_f32 v128, v128, v160
    s_nop 1
    v_add_f32_dpp v128, v128, v128 row_ror:8 row_mask:0xf bank_mask:0xf
    s_nop 1
    v_add_f32_dpp v128, v128, v128 row_ror:4 row_mask:0xf bank_mask:0xf
    s_nop 1
    v_add_f32_dpp v128, v128, v128 row_ror:2 row_mask:0xf bank_mask:0xf
    s_nop 1
    v_add_f32_dpp v128, v128, v128 row_ror:1 row_mask:0xf bank_mask:0xf
    v_cvt_pk_bf16_f32 v128, v128, v128
    v_and_b32 v128, 0xffff0000, v128
    v_mul_f32 v128, 0xbfb8aa3b, v128
    v_exp_f32 v128, v128
    s_nop 0
    v_add_f32 v128, 1.0, v128
    v_rcp_f32 v128, v128
    s_nop 0
    v_cvt_pk_bf16_f32 v128, v128, v128
    v_and_b32 v128, 0xffff0000, v128
    v_sub_f32 v129, 1.0, v128
    v_cvt_pk_bf16_f32 v129, v129, v129
    v_and_b32 v129, 0xffff0000, v129
    s_add_u32 s4, s62, 34865152
    s_addc_u32 s5, s63, 0
    s_mov_b32 s6, 16384
    s_mov_b32 s7, 0x20000
    v_lshlrev_b32 v125, 3, v165
    s_mov_b32 exec_lo, 65537
    s_mov_b32 exec_hi, 65537
    buffer_store_dwordx2 v[128:129], v125, s[4:7], 0 offen offset:0 sc1
    s_mov_b64 exec, -1
gated_mix__ssm_conv_s4d__mixer_gmlp__prompt_kernel_gj0:
    s_cmp_lt_u32 s26, 12
    s_cbranch_scc1 gated_mix__ssm_conv_s4d__mixer_gmlp__prompt_kernel_gj1
    v_mov_b32 v128, 0
    v_lshlrev_b32 v156, 16, v82
    v_and_b32 v157, 0xffff0000, v82
    v_lshlrev_b32 v158, 16, v100
    v_and_b32 v159, 0xffff0000, v100
    v_mul_f32 v156, v156, v158
    v_mul_f32 v157, v157, v159
    v_cvt_pk_bf16_f32 v156, v156, v157
    v_and_b32 v157, 0xffff0000, v156
    v_lshlrev_b32 v156, 16, v156
    v_add_f32 v128, v128, v157
    v_add_f32 v128, v128, v156
    v_lshlrev_b32 v160, 16, v83
    v_and_b32 v161, 0xffff0000, v83
    v_lshlrev_b32 v162, 16, v101
    v_and_b32 v163, 0xffff0000, v101
    v_mul_f32 v160, v160, v162
    v_mul_f32 v161, v161, v163
    v_cvt_pk_bf16_f32 v160, v160, v161
    v_and_b32 v161, 0xffff0000, v160
    v_lshlrev_b32 v160, 16, v160
    v_add_f32 v128, v128, v161
    v_add_f32 v128, v128, v160
    v_lshlrev_b32 v156, 16, v84
    v_and_b32 v157, 0xffff0000, v84
    v_lshlrev_b32 v158, 16, v102
    v_and_b32 v159, 0xffff0000, v102
    v_mul_f32 v156, v156, v158
    v_mul_f32 v157, v157, v159
    v_cvt_pk_bf16_f32 v156, v156, v157
    v_and_b32 v157, 0xffff0000, v156
    v_lshlrev_b32 v156, 16, v156
    v_add_f32 v128, v128, v157
    v_add_f32 v128, v128, v156
    v_lshlrev_b32 v160, 16, v85
    v_and_b32 v161, 0xffff0000, v85
    v_lshlrev_b32 v162, 16, v103
    v_and_b32 v163, 0xffff0000, v103
    v_mul_f32 v160, v160, v162
    v_mul_f32 v161, v161, v163
    v_cvt_pk_bf16_f32 v160, v160, v161
    v_and_b32 v161, 0xffff0000, v160
    v_lshlrev_b32 v160, 16, v160
    v_add_f32 v128, v128, v161
    v_add_f32 v128, v128, v160
    v_lshlrev_b32 v156, 16, v86
    v_and_b32 v157, 0xffff0000, v86
    v_lshlrev_b32 v158, 16, v104
    v_and_b32 v159, 0xffff0000, v104
    v_mul_f32 v156, v156, v158
    v_mul_f32 v157, v157, v159
    v_cvt_pk_bf16_f32 v156, v156, v157
    v_and_b32 v157, 0xffff0000, v156
    v_lshlrev_b32 v156, 16, v156
    v_add_f32 v128, v128, v157
    v_add_f32 v128, v128, v156
    v_lshlrev_b32 v160, 16, v87
    v_and_b32 v161, 0xffff0000, v87
    v_lshlrev_b32 v162, 16, v105
    v_and_b32 v163, 0xffff0000, v105
    v_mul_f32 v160, v160, v162
    v_mul_f32 v161, v161, v163
    v_cvt_pk_bf16_f32 v160, v160, v161
    v_and_b32 v161, 0xffff0000, v160
    v_lshlrev_b32 v160, 16, v160
    v_add_f32 v128, v128, v161
    v_add_f32 v128, v128, v160
    v_lshlrev_b32 v156, 16, v88
    v_and_b32 v157, 0xffff0000, v88
    v_lshlrev_b32 v158, 16, v106
    v_and_b32 v159, 0xffff0000, v106
    v_mul_f32 v156, v156, v158
    v_mul_f32 v157, v157, v159
    v_cvt_pk_bf16_f32 v156, v156, v157
    v_and_b32 v157, 0xffff0000, v156
    v_lshlrev_b32 v156, 16, v156
    v_add_f32 v128, v128, v157
    v_add_f32 v128, v128, v156
    v_lshlrev_b32 v160, 16, v89
    v_and_b32 v161, 0xffff0000, v89
    v_lshlrev_b32 v162, 16, v107
    v_and_b32 v163, 0xffff0000, v107
    v_mul_f32 v160, v160, v162
    v_mul_f32 v161, v161, v163
    v_cvt_pk_bf16_f32 v160, v160, v161
    v_and_b32 v161, 0xffff0000, v160
    v_lshlrev_b32 v160, 16, v160
    v_add_f32 v128, v128, v161
    v_add_f32 v128, v128, v160
    v_lshlrev_b32 v156, 16, v90
    v_and_b32 v157, 0xffff0000, v90
    v_lshlrev_b32 v158, 16, v108
    v_and_b32 v159, 0xffff0000, v108
    v_mul_f32 v156, v156, v158
    v_mul_f32 v157, v157, v159
    v_cvt_pk_bf16_f32 v156, v156, v157
    v_and_b32 v157, 0xffff0000, v156
    v_lshlrev_b32 v156, 16, v156
    v_add_f32 v128, v128, v157
    v_add_f32 v128, v128, v156
    v_lshlrev_b32 v160, 16, v91
    v_and_b32 v161, 0xffff0000, v91
    v_lshlrev_b32 v162, 16, v109
    v_and_b32 v163, 0xffff0000, v109
    v_mul_f32 v160, v160, v162
    v_mul_f32 v161, v161, v163
    v_cvt_pk_bf16_f32 v160, v160, v161
    v_and_b32 v161, 0xffff0000, v160
    v_lshlrev_b32 v160, 16, v160
    v_add_f32 v128, v128, v161
    v_add_f32 v128, v128, v160
    v_lshlrev_b32 v156, 16, v92
    v_and_b32 v157, 0xffff0000, v92
    v_lshlrev_b32 v158, 16, v110
    v_and_b32 v159, 0xffff0000, v110
    v_mul_f32 v156, v156, v158
    v_mul_f32 v157, v157, v159
    v_cvt_pk_bf16_f32 v156, v156, v157
    v_and_b32 v157, 0xffff0000, v156
    v_lshlrev_b32 v156, 16, v156
    v_add_f32 v128, v128, v157
    v_add_f32 v128, v128, v156
    v_lshlrev_b32 v160, 16, v93
    v_and_b32 v161, 0xffff0000, v93
    v_lshlrev_b32 v162, 16, v111
    v_and_b32 v163, 0xffff0000, v111
    v_mul_f32 v160, v160, v162
    v_mul_f32 v161, v161, v163
    v_cvt_pk_bf16_f32 v160, v160, v161
    v_and_b32 v161, 0xffff0000, v160
    v_lshlrev_b32 v160, 16, v160
    v_add_f32 v128, v128, v161
    v_add_f32 v128, v128, v160
    v_lshlrev_b32 v156, 16, v94
    v_and_b32 v157, 0xffff0000, v94
    v_lshlrev_b32 v158, 16, v112
    v_and_b32 v159, 0xffff0000, v112
    v_mul_f32 v156, v156, v158
    v_mul_f32 v157, v157, v159
    v_cvt_pk_bf16_f32 v156, v156, v157
    v_and_b32 v157, 0xffff0000, v156
    v_lshlrev_b32 v156, 16, v156
    v_add_f32 v128, v128, v157
    v_add_f32 v128, v128, v156
    v_lshlrev_b32 v160, 16, v95
    v_and_b32 v161, 0xffff0000, v95
    v_lshlrev_b32 v162, 16, v113
    v_and_b32 v163, 0xffff0000, v113
    v_mul_f32 v160, v160, v162
    v_mul_f32 v161, v161, v163
    v_cvt_pk_bf16_f32 v160, v160, v161
    v_and_b32 v161, 0xffff0000, v160
    v_lshlrev_b32 v160, 16, v160
    v_add_f32 v128, v128, v161
    v_add_f32 v128, v128, v160
    v_lshlrev_b32 v156, 16, v96
    v_and_b32 v157, 0xffff0000, v96
    v_lshlrev_b32 v158, 16, v114
    v_and_b32 v159, 0xffff0000, v114
    v_mul_f32 v156, v156, v158
    v_mul_f32 v157, v157, v159
    v_cvt_pk_bf16_f32 v156, v156, v157
    v_and_b32 v157, 0xffff0000, v156
    v_lshlrev_b32 v156, 16, v156
    v_add_f32 v128, v128, v157
    v_add_f32 v128, v128, v156
    v_lshlrev_b32 v160, 16, v97
    v_and_b32 v161, 0xffff0000, v97
    v_lshlrev_b32 v162, 16, v115
    v_and_b32 v163, 0xffff0000, v115
    v_mul_f32 v160, v160, v162
    v_mul_f32 v161, v161, v163
    v_cvt_pk_bf16_f32 v160, v160, v161
    v_and_b32 v161, 0xffff0000, v160
    v_lshlrev_b32 v160, 16, v160
    v_add_f32 v128, v128, v161
    v_add_f32 v128, v128, v160
    v_lshlrev_b32 v156, 16, v98
    v_and_b32 v157, 0xffff0000, v98
    v_lshlrev_b32 v158, 16, v116
    v_and_b32 v159, 0xffff0000, v116
    v_mul_f32 v156, v156, v158
    v_mul_f32 v157, v157, v159
    v_cvt_pk_bf16_f32 v156, v156, v157
    v_and_b32 v157, 0xffff0000, v156
    v_lshlrev_b32 v156, 16, v156
    v_add_f32 v128, v128, v157
    v_add_f32 v128, v128, v156
    v_lshlrev_b32 v160, 16, v99
    v_and_b32 v161, 0xffff0000, v99
    v_lshlrev_b32 v162, 16, v117
    v_and_b32 v163, 0xffff0000, v117
    v_mul_f32 v160, v160, v162
    v_mul_f32 v161, v161, v163
    v_cvt_pk_bf16_f32 v160, v160, v161
    v_and_b32 v161, 0xffff0000, v160
    v_lshlrev_b32 v160, 16, v160
    v_add_f32 v128, v128, v161
    v_add_f32 v128, v128, v160
    s_nop 1
    v_add_f32_dpp v128, v128, v128 row_ror:8 row_mask:0xf bank_mask:0xf
    s_nop 1
    v_add_f32_dpp v128, v128, v128 row_ror:4 row_mask:0xf bank_mask:0xf
    s_nop 1
    v_add_f32_dpp v128, v128, v128 row_ror:2 row_mask:0xf bank_mask:0xf
    s_nop 1
    v_add_f32_dpp v128, v128, v128 row_ror:1 row_mask:0xf bank_mask:0xf
    v_cvt_pk_bf16_f32 v128, v128, v128
    v_and_b32 v128, 0xffff0000, v128
    v_mul_f32 v128, 0xbfb8aa3b, v128
    v_exp_f32 v128, v128
    s_nop 0
    v_add_f32 v128, 1.0, v128
    v_rcp_f32 v128, v128
    s_nop 0
    v_cvt_pk_bf16_f32 v128, v128, v128
    v_and_b32 v128, 0xffff0000, v128
    v_sub_f32 v129, 1.0, v128
    v_cvt_pk_bf16_f32 v129, v129, v129
    v_and_b32 v129, 0xffff0000, v129
    s_add_u32 s4, s62, 34865152
    s_addc_u32 s5, s63, 0
    s_mov_b32 s6, 16384
    s_mov_b32 s7, 0x20000
    v_lshlrev_b32 v125, 3, v165
    s_mov_b32 exec_lo, 65537
    s_mov_b32 exec_hi, 65537
    buffer_store_dwordx2 v[128:129], v125, s[4:7], 0 offen offset:32 sc1
    s_mov_b64 exec, -1
gated_mix__ssm_conv_s4d__mixer_gmlp__prompt_kernel_gj1:
    s_waitcnt vmcnt(0)
    v_mov_b32 v6, 163584
    v_mov_b32 v7, 1
    s_mov_b64 exec, 1
    ds_add_rtn_u32 v7, v6, v7
    s_mov_b64 exec, -1
    s_waitcnt lgkmcnt(0)
    v_readfirstlane_b32 s64, v7
    s_nop 0
    s_cmp_lg_u32 s64, 3
    s_cbranch_scc1 gated_mix__ssm_conv_s4d__mixer_gmlp__prompt_kernel_Cnc2
    s_sub_u32 s72, s26, 12
    s_lshr_b32 s73, s72, 1
    s_lshl_b32 s74, s27, 1
    s_add_u32 s73, s73, s74
    s_lshl_b32 s73, s73, 3
    s_and_b32 s72, s72, 1
    s_add_u32 s72, s72, 18
    v_add_u32 v14, s73, v0
    v_lshlrev_b32 v14, 8, v14
    s_lshl_b32 s64, s72, 2
    s_add_u32 s64, s64, 131072
    v_mov_b32 v15, 1
    s_mov_b64 exec, 0xff
    buffer_store_dword v15, v14, s[20:23], s64 offen sc1
    s_mov_b64 exec, -1
gated_mix__ssm_conv_s4d__mixer_gmlp__prompt_kernel_Cnc2:
    v_lshlrev_b32 v2, 4, v0
    v_lshrrev_b32 v4, 4, v0
    v_and_b32 v5, 15, v0
    v_lshrrev_b32 v6, 2, v5
    v_lshlrev_b32 v6, 3, v6
    v_and_b32 v7, 3, v5
    v_add_u32 v6, v6, v7
    s_lshr_b32 s70, s25, 1
    s_lshl_b32 s70, s70, 5
    s_and_b32 s66, s25, 1
    s_lshl_b32 s66, s66, 2
    s_add_u32 s70, s70, s66
    v_add_u32 v6, s70, v6
    v_lshlrev_b32 v15, 3, v6
    v_add_u32 v15, 134144, v15
    s_lshl_b32 s66, s28, 6
    v_add_u32 v6, s66, v6
    v_mul_u32_u24 v6, 1152, v6
    s_mul_i32 s66, s29, 144
    v_add_u32 v6, s66, v6
    v_lshl_add_u32 v10, v4, 4, v6
    v_lshl_add_u32 v11, v4, 3, v6
    s_mov_b32 s16, s58
    s_mov_b32 s17, s59
    s_mov_b32 s18, 2359296
    s_mov_b32 s19, 0x20000
    v_lshrrev_b32 v12, 2, v5
    v_lshl_add_u32 v13, v4, 3, v12
    v_lshlrev_b32 v13, 7, v13
    v_and_b32 v14, 3, v5
    v_lshl_add_u32 v13, v14, 4, v13
    s_lshl_b32 s70, s70, 1
    s_add_u32 s70, s70, 123904
    v_add_u32 v13, s70, v13
    v_lshl_add_u32 v12, v4, 2, v12
    v_lshlrev_b32 v12, 7, v12
    v_lshl_add_u32 v12, v14, 4, v12
    v_add_u32 v12, s70, v12
    s_cmp_lg_u32 s25, 0
    s_cbranch_scc1 gated_mix__ssm_conv_s4d__mixer_gmlp__prompt_kernel_Cna
    v_mov_b32 v16, 163608
    s_mov_b32 s65, 0
gated_mix__ssm_conv_s4d__mixer_gmlp__prompt_kernel_Cah:
    ds_read_b32 v17, v16
    s_waitcnt lgkmcnt(0)
    v_readfirstlane_b32 s66, v17
    s_add_u32 s65, s65, 1
    s_cmp_lg_u32 s66, 0
    s_cbranch_scc1 gated_mix__ssm_conv_s4d__mixer_gmlp__prompt_kernel_Cah2
    s_sleep 2
    s_cmp_lt_u32 s65, 1000000
    s_cbranch_scc1 gated_mix__ssm_conv_s4d__mixer_gmlp__prompt_kernel_Cah
gated_mix__ssm_conv_s4d__mixer_gmlp__prompt_kernel_Cah2:
    s_lshl_b32 s64, s75, 8
    s_add_u32 s64, s64, 131072
    v_min_u32 v16, 19, v0
    v_lshlrev_b32 v16, 2, v16
    s_mov_b32 s65, 0
gated_mix__ssm_conv_s4d__mixer_gmlp__prompt_kernel_Ca_poll:
    buffer_load_dword v17, v16, s[20:23], s64 offen sc1
    s_waitcnt vmcnt(0)
    v_cmp_eq_u32 vcc, 0, v17
    s_add_u32 s65, s65, 1
    s_cmp_eq_u64 vcc, 0
    s_cbranch_scc1 gated_mix__ssm_conv_s4d__mixer_gmlp__prompt_kernel_Ca_ok
    s_sleep 8
    s_cmp_lt_u32 s65, 100000
    s_cbranch_scc1 gated_mix__ssm_conv_s4d__mixer_gmlp__prompt_kernel_Ca_poll
gated_mix__ssm_conv_s4d__mixer_gmlp__prompt_kernel_Ca_ok:
    s_mul_i32 s64, s29, 294912
    s_lshl_b32 s65, s28, 7
    s_add_u32 s64, s64, s65
    s_add_u32 s64, s64, 37748736
    s_add_u32 s12, s62, s64
    s_addc_u32 s13, s63, 0
    s_mov_b32 s14, 290944
    s_mov_b32 s15, 0x20000
    v_lshrrev_b32 v5, 3, v0
    v_and_b32 v6, 7, v0
    v_lshlrev_b32 v5, 12, v5
    v_lshl_add_u32 v5, v6, 4, v5
    s_mov_b32 m0, 123904
    s_mov_b32 s70, 0
    buffer_load_dwordx4 v5, s[12:15], s70 offen sc1 lds
    s_mov_b32 m0, 124928
    s_mov_b32 s70, 32768
    buffer_load_dwordx4 v5, s[12:15], s70 offen sc1 lds
    s_mov_b32 m0, 125952
    s_mov_b32 s70, 65536
    buffer_load_dwordx4 v5, s[12:15], s70 offen sc1 lds
    s_mov_b32 m0, 126976
    s_mov_b32 s70, 98304
    buffer_load_dwordx4 v5, s[12:15], s70 offen sc1 lds
    s_mov_b32 m0, 128000
    s_mov_b32 s70, 131072
    buffer_load_dwordx4 v5, s[12:15], s70 offen sc1 lds
    s_mov_b32 m0, 129024
    s_mov_b32 s70, 163840
    buffer_load_dwordx4 v5, s[12:15], s70 offen sc1 lds
    s_mov_b32 m0, 130048
    s_mov_b32 s70, 196608
    buffer_load_dwordx4 v5, s[12:15], s70 offen sc1 lds
    s_mov_b32 m0, 131072
    s_mov_b32 s70, 229376
    buffer_load_dwordx4 v5, s[12:15], s70 offen sc1 lds
    s_mov_b32 m0, 132096
    s_mov_b32 s70, 262144
    buffer_load_dwordx4 v5, s[12:15], s70 offen sc1 lds
    s_lshl_b32 s64, s28, 9
    s_add_u32 s64, s64, 34865152
    s_add_u32 s12, s62, s64
    s_addc_u32 s13, s63, 0
    s_mov_b32 s14, 512
    s_mov_b32 s15, 0x20000
    s_mov_b32 m0, 134144
    s_mov_b64 exec, 0xffffffff
    buffer_load_dwordx4 v2, s[12:15], 0 offen sc1 lds
    s_mov_b64 exec, -1
    v_mov_b32 v16, 163612
    s_waitcnt vmcnt(0)
    ds_write_b32 v16, v16
    s_branch gated_mix__ssm_conv_s4d__mixer_gmlp__prompt_kernel_Cna2
gated_mix__ssm_conv_s4d__mixer_gmlp__prompt_kernel_Cna:
    v_mov_b32 v16, 163612
    s_mov_b32 s65, 0
gated_mix__ssm_conv_s4d__mixer_gmlp__prompt_kernel_Cas:
    ds_read_b32 v17, v16
    s_waitcnt lgkmcnt(0)
    v_readfirstlane_b32 s66, v17
    s_add_u32 s65, s65, 1
    s_cmp_lg_u32 s66, 0
    s_cbranch_scc1 gated_mix__ssm_conv_s4d__mixer_gmlp__prompt_kernel_Cna2
    s_sleep 2
    s_cmp_lt_u32 s65, 2000000
    s_cbranch_scc1 gated_mix__ssm_conv_s4d__mixer_gmlp__prompt_kernel_Cas
gated_mix__ssm_conv_s4d__mixer_gmlp__prompt_kernel_Cna2:
    ds_read_b64_tr_b16 v[16:17], v13 offset:0
    ds_read_b64_tr_b16 v[18:19], v13 offset:512
    ds_read_b64_tr_b16 v[20:21], v13 offset:4096
    ds_read_b64_tr_b16 v[22:23], v13 offset:4608
    ds_read_b64_tr_b16 v[24:25], v12 offset:8192
    ds_read_b64 v[8:9], v15
    s_mul_i32 s65, s25, 5120
    v_add_u32 v14, s65, v2
    v_add_u32 v3, 40960, v14
    s_waitcnt lgkmcnt(0)
    v_lshlrev_b32 v32, 16, v16
    v_and_b32 v33, 0xffff0000, v16
    v_lshlrev_b32 v34, 16, v17
    v_and_b32 v35, 0xffff0000, v17
    v_lshlrev_b32 v36, 16, v18
    v_and_b32 v37, 0xffff0000, v18
    v_lshlrev_b32 v38, 16, v19
    v_and_b32 v39, 0xffff0000, v19
    v_lshlrev_b32 v40, 16, v20
    v_and_b32 v41, 0xffff0000, v20
    v_lshlrev_b32 v42, 16, v21
    v_and_b32 v43, 0xffff0000, v21
    v_lshlrev_b32 v44, 16, v22
    v_and_b32 v45, 0xffff0000, v22
    v_lshlrev_b32 v46, 16, v23
    v_and_b32 v47, 0xffff0000, v23
    v_lshlrev_b32 v48, 16, v24
    v_and_b32 v49, 0xffff0000, v24
    v_lshlrev_b32 v50, 16, v25
    v_and_b32 v51, 0xffff0000, v25
    v_mul_f32 v32, v8, v32
    v_mul_f32 v33, v8, v33
    v_mul_f32 v34, v8, v34
    v_mul_f32 v35, v8, v35
    v_mul_f32 v36, v8, v36
    v_mul_f32 v37, v8, v37
    v_mul_f32 v38, v8, v38
    v_mul_f32 v39, v8, v39
    v_mul_f32 v40, v8, v40
    v_mul_f32 v41, v8, v41
    v_mul_f32 v42, v8, v42
    v_mul_f32 v43, v8, v43
    v_mul_f32 v44, v8, v44
    v_mul_f32 v45, v8, v45
    v_mul_f32 v46, v8, v46
    v_mul_f32 v47, v8, v47
    v_mul_f32 v48, v8, v48
    v_mul_f32 v49, v8, v49
    v_mul_f32 v50, v8, v50
    v_mul_f32 v51, v8, v51
    v_mov_b32 v8, v9
    s_barrier
    ds_read_b128 v[96:99], v14 offset:0
    ds_read_b128 v[116:119], v14 offset:20480
    ds_read_b128 v[136:139], v3 offset:0
    ds_read_b128 v[156:159], v3 offset:20480
    ds_read_b128 v[100:103], v14 offset:1024
    ds_read_b128 v[120:123], v14 offset:21504
    ds_read_b128 v[140:143], v3 offset:1024
    ds_read_b128 v[160:163], v3 offset:21504
    ds_read_b128 v[104:107], v14 offset:2048
    ds_read_b128 v[124:127], v14 offset:22528
    ds_read_b128 v[144:147], v3 offset:2048
    ds_read_b128 v[164:167], v3 offset:22528
    ds_read_b128 v[108:111], v14 offset:3072
    ds_read_b128 v[128:131], v14 offset:23552
    ds_read_b128 v[148:151], v3 offset:3072
    ds_read_b128 v[168:171], v3 offset:23552
    ds_read_b128 v[112:115], v14 offset:4096
    ds_read_b128 v[132:135], v14 offset:24576
    ds_read_b128 v[152:155], v3 offset:4096
    ds_read_b128 v[172:175], v3 offset:24576
    s_waitcnt lgkmcnt(15)
    v_pk_add_f32 v[96:97], v[96:97], v[116:117]
    v_pk_add_f32 v[136:137], v[136:137], v[156:157]
    v_pk_add_f32 v[98:99], v[98:99], v[118:119]
    v_pk_add_f32 v[138:139], v[138:139], v[158:159]
    v_pk_add_f32 v[96:97], v[96:97], v[136:137]
    v_pk_add_f32 v[98:99], v[98:99], v[138:139]
    v_pk_fma_f32 v[32:33], v[96:97], v[8:9], v[32:33]
    v_pk_fma_f32 v[34:35], v[98:99], v[8:9], v[34:35]
    v_cvt_pk_bf16_f32 v56, v32, v33
    v_cvt_pk_bf16_f32 v57, v34, v35
    s_waitcnt lgkmcnt(12)
    v_pk_add_f32 v[100:101], v[100:101], v[120:121]
    v_pk_add_f32 v[140:141], v[140:141], v[160:161]
    v_pk_add_f32 v[102:103], v[102:103], v[122:123]
    v_pk_add_f32 v[142:143], v[142:143], v[162:163]
    v_pk_add_f32 v[100:101], v[100:101], v[140:141]
    v_pk_add_f32 v[102:103], v[102:103], v[142:143]
    v_pk_fma_f32 v[36:37], v[100:101], v[8:9], v[36:37]
    v_pk_fma_f32 v[38:39], v[102:103], v[8:9], v[38:39]
    v_cvt_pk_bf16_f32 v58, v36, v37
    v_cvt_pk_bf16_f32 v59, v38, v39
    buffer_store_dwordx4 v[56:59], v10, s[16:19], 0 offen
    s_waitcnt lgkmcnt(8)
    v_pk_add_f32 v[104:105], v[104:105], v[124:125]
    v_pk_add_f32 v[144:145], v[144:145], v[164:165]
    v_pk_add_f32 v[106:107], v[106:107], v[126:127]
    v_pk_add_f32 v[146:147], v[146:147], v[166:167]
    v_pk_add_f32 v[104:105], v[104:105], v[144:145]
    v_pk_add_f32 v[106:107], v[106:107], v[146:147]
    v_pk_fma_f32 v[40:41], v[104:105], v[8:9], v[40:41]
    v_pk_fma_f32 v[42:43], v[106:107], v[8:9], v[42:43]
    v_cvt_pk_bf16_f32 v60, v40, v41
    v_cvt_pk_bf16_f32 v61, v42, v43
    s_waitcnt lgkmcnt(4)
    v_pk_add_f32 v[108:109], v[108:109], v[128:129]
    v_pk_add_f32 v[148:149], v[148:149], v[168:169]
    v_pk_add_f32 v[110:111], v[110:111], v[130:131]
    v_pk_add_f32 v[150:151], v[150:151], v[170:171]
    v_pk_add_f32 v[108:109], v[108:109], v[148:149]
    v_pk_add_f32 v[110:111], v[110:111], v[150:151]
    v_pk_fma_f32 v[44:45], v[108:109], v[8:9], v[44:45]
    v_pk_fma_f32 v[46:47], v[110:111], v[8:9], v[46:47]
    v_cvt_pk_bf16_f32 v62, v44, v45
    v_cvt_pk_bf16_f32 v63, v46, v47
    buffer_store_dwordx4 v[60:63], v10, s[16:19], 0 offen offset:64
    s_waitcnt lgkmcnt(0)
    v_pk_add_f32 v[112:113], v[112:113], v[132:133]
    v_pk_add_f32 v[152:153], v[152:153], v[172:173]
    v_pk_add_f32 v[114:115], v[114:115], v[134:135]
    v_pk_add_f32 v[154:155], v[154:155], v[174:175]
    v_pk_add_f32 v[112:113], v[112:113], v[152:153]
    v_pk_add_f32 v[114:115], v[114:115], v[154:155]
    v_pk_fma_f32 v[48:49], v[112:113], v[8:9], v[48:49]
    v_pk_fma_f32 v[50:51], v[114:115], v[8:9], v[50:51]
    v_cvt_pk_bf16_f32 v64, v48, v49
    v_cvt_pk_bf16_f32 v65, v50, v51
    s_mov_b64 exec, 0xffffffff
    buffer_store_dwordx2 v[64:65], v11, s[16:19], 0 offen offset:128
    s_mov_b64 exec, -1
gated_mix__ssm_conv_s4d__mixer_gmlp__prompt_kernel_exit:
    s_endpgm
gated_mix__ssm_conv_s4d__mixer_gmlp__prompt_kernel_Chelp:
    v_lshlrev_b32 v20, 16, v8
    v_lshlrev_b32 v12, 16, v4
    v_and_b32 v13, 0xffff0000, v4
    v_lshlrev_b32 v14, 16, v5
    v_and_b32 v15, 0xffff0000, v5
    v_lshlrev_b32 v16, 16, v6
    v_and_b32 v18, 0xffff0000, v6
    v_lshlrev_b32 v17, 16, v7
    v_and_b32 v19, 0xffff0000, v7
    v_mov_b32 v23, 0x3fb8aa3b
    v_mov_b32 v24, 0x32a57060
    v_max_f32 v25, abs(v16), abs(v17)
    v_mul_f32 v48, v20, v23
    v_mul_f32 v51, v12, v23
    v_mul_f32 v54, v13, v23
    v_max3_f32 v25, v25, abs(v18), abs(v19)
    v_fma_f32 v49, v20, v23, -v48
    v_fma_f32 v52, v12, v23, -v51
    v_fma_f32 v55, v13, v23, -v54
    v_max_f32_dpp v25, v25, v25 row_ror:8 row_mask:0xf bank_mask:0xf
    v_fmac_f32 v49, v20, v24
    v_fmac_f32 v52, v12, v24
    v_fmac_f32 v55, v13, v24
    v_max_f32_dpp v25, v25, v25 row_ror:4 row_mask:0xf bank_mask:0xf
    v_rndne_f32 v50, v48
    v_rndne_f32 v53, v51
    v_rndne_f32 v56, v54
    v_max_f32_dpp v25, v25, v25 row_ror:2 row_mask:0xf bank_mask:0xf
    v_sub_f32 v48, v48, v50
    v_sub_f32 v51, v51, v53
    v_sub_f32 v54, v54, v56
    v_max_f32_dpp v25, v25, v25 row_ror:1 row_mask:0xf bank_mask:0xf
    v_add_f32 v48, v48, v49
    v_add_f32 v51, v51, v52
    v_add_f32 v54, v54, v55
    v_mov_b32 v26, v25
    v_exp_f32 v48, v48
    v_exp_f32 v51, v51
    v_exp_f32 v54, v54
    v_permlane16_swap_b32 v25, v26
    v_cvt_i32_f32 v50, v50
    v_cvt_i32_f32 v53, v53
    v_cvt_i32_f32 v56, v56
    v_max_f32 v25, v25, v26
    v_ldexp_f32 v20, v48, v50
    v_ldexp_f32 v12, v51, v53
    v_ldexp_f32 v13, v54, v56
    v_mov_b32 v26, v25
    v_cvt_pk_bf16_f32 v20, v20, v20
    v_cvt_pk_bf16_f32 v12, v12, v12
    v_cvt_pk_bf16_f32 v13, v13, v13
    v_permlane32_swap_b32 v25, v26
    v_and_b32 v20, 0xffff0000, v20
    v_and_b32 v12, 0xffff0000, v12
    v_and_b32 v13, 0xffff0000, v13
    v_max_f32 v25, v25, v26
    v_mul_f32 v12, v12, v20
    v_mul_f32 v14, v14, v20
    v_mul_f32 v12, 0xbfb8aa3b, v12
    v_mul_f32 v13, v13, v20
    v_mul_f32 v15, v15, v20
    v_mul_f32 v13, 0xbfb8aa3b, v13
    v_and_b32 v25, 0x7f800000, v25
    v_max_u32 v25, 0x00800000, v25
    v_min_u32 v25, 0x7e800000, v25
    v_sub_u32 v26, 0x7f000000, v25
    v_mul_f32 v16, v16, v26
    v_mul_f32 v17, v17, v26
    v_mul_f32 v18, v18, v26
    v_mul_f32 v19, v19, v26
    v_mul_f32 v22, v25, v20
    v_add_f32 v22, v22, v22
    v_mov_b32 v23, 0x3e22f983
    v_mov_b32 v24, 0x31dc9c88
    v_mul_f32 v48, 0x44800000, v12
    v_mul_f32 v52, 0x44800000, v13
    v_mul_f32 v49, 0x44800000, v14
    v_mul_f32 v53, 0x44800000, v15
    v_exp_f32 v48, v48
    v_exp_f32 v52, v52
    v_mul_f32 v50, v49, v23
    v_mul_f32 v54, v53, v23
    v_fma_f32 v51, v49, v23, -v50
    v_fma_f32 v55, v53, v23, -v54
    v_fmac_f32 v51, v49, v24
    v_fmac_f32 v55, v53, v24
    v_fract_f32 v50, v50
    v_fract_f32 v54, v54
    v_add_f32 v50, v50, v51
    v_add_f32 v54, v54, v55
    v_cos_f32 v49, v50
    v_cos_f32 v53, v54
    v_sin_f32 v51, v50
    v_sin_f32 v55, v54
    v_mul_f32 v28, v48, v49
    v_mul_f32 v30, v52, v53
    v_mul_f32 v29, v48, v51
    v_mul_f32 v31, v52, v55
    v_mul_f32 v48, 0x41000000, v12
    v_mul_f32 v52, 0x41000000, v13
    v_mul_f32 v49, 0xc1000000, v14
    v_mul_f32 v53, 0xc1000000, v15
    v_exp_f32 v48, v48
    v_exp_f32 v52, v52
    v_mul_f32 v50, v49, v23
    v_mul_f32 v54, v53, v23
    v_fma_f32 v51, v49, v23, -v50
    v_fma_f32 v55, v53, v23, -v54
    v_fmac_f32 v51, v49, v24
    v_fmac_f32 v55, v53, v24
    v_fract_f32 v50, v50
    v_fract_f32 v54, v54
    v_add_f32 v50, v50, v51
    v_add_f32 v54, v54, v55
    v_cos_f32 v49, v50
    v_cos_f32 v53, v54
    v_sin_f32 v51, v50
    v_sin_f32 v55, v54
    v_mul_f32 v32, v48, v49
    v_mul_f32 v34, v52, v53
    v_mul_f32 v33, v48, v51
    v_mul_f32 v35, v52, v55
    v_mul_f32 v48, 0x43000000, v12
    v_mul_f32 v52, 0x43000000, v13
    v_mul_f32 v49, 0x43000000, v14
    v_mul_f32 v53, 0x43000000, v15
    v_exp_f32 v48, v48
    v_exp_f32 v52, v52
    v_mul_f32 v50, v49, v23
    v_mul_f32 v54, v53, v23
    v_fma_f32 v51, v49, v23, -v50
    v_fma_f32 v55, v53, v23, -v54
    v_fmac_f32 v51, v49, v24
    v_fmac_f32 v55, v53, v24
    v_fract_f32 v50, v50
    v_fract_f32 v54, v54
    v_add_f32 v50, v50, v51
    v_add_f32 v54, v54, v55
    v_cos_f32 v49, v50
    v_cos_f32 v53, v54
    v_sin_f32 v51, v50
    v_sin_f32 v55, v54
    v_mul_f32 v36, v48, v49
    v_mul_f32 v38, v52, v53
    v_mul_f32 v37, v48, v51
    v_mul_f32 v39, v52, v55
    v_lshlrev_b32 v2, 3, v0
    v_add_u32 v2, s1, v2
    v_and_b32 v4, 15, v0
    v_lshrrev_b32 v5, 4, v0
    v_and_b32 v3, 7, v0
    v_mul_u32_u24 v3, 528, v3
    v_lshl_add_u32 v3, v5, 4, v3
    v_add_u32 v3, s1, v3
    v_pk_mul_f32 v[52:53], v[16:17], v[28:29] op_sel:[0,0] op_sel_hi:[0,1]
    v_pk_mul_f32 v[54:55], v[18:19], v[30:31] op_sel:[0,0] op_sel_hi:[0,1]
    v_pk_fma_f32 v[16:17], v[16:17], v[28:29], v[52:53] op_sel:[1,1,0] op_sel_hi:[1,0,1] neg_lo:[0,1,0]
    v_pk_fma_f32 v[18:19], v[18:19], v[30:31], v[54:55] op_sel:[1,1,0] op_sel_hi:[1,0,1] neg_lo:[0,1,0]
    v_mov_b32 v160, 0
    v_mov_b32 v161, 0
    v_mov_b32 v162, 0
    v_mov_b32 v163, 0
    v_mov_b32 v164, 0
    v_mov_b32 v165, 0
    v_mov_b32 v166, 0
    v_mov_b32 v167, 0
    v_mov_b32 v168, 0
    v_mov_b32 v169, 0
    v_mov_b32 v170, 0
    v_mov_b32 v171, 0
    v_mov_b32 v48, 1.0
    v_mov_b32 v49, 0
    v_mov_b32 v50, 1.0
    v_mov_b32 v51, 0
    v_cvt_pk_f16_f32 v56, v48, v49
    v_cvt_pk_f16_f32 v57, v50, v51
    v_pk_mul_f32 v[52:53], v[48:49], v[32:33] op_sel:[0,0] op_sel_hi:[0,1]
    v_pk_mul_f32 v[54:55], v[50:51], v[34:35] op_sel:[0,0] op_sel_hi:[0,1]
    v_pk_fma_f32 v[48:49], v[48:49], v[32:33], v[52:53] op_sel:[1,1,0] op_sel_hi:[1,0,1] neg_lo:[0,1,0]
    v_pk_fma_f32 v[50:51], v[50:51], v[34:35], v[54:55] op_sel:[1,1,0] op_sel_hi:[1,0,1] neg_lo:[0,1,0]
    ds_write_b64 v2, v[56:57] offset:0
    v_cvt_pk_f16_f32 v58, v48, v49
    v_cvt_pk_f16_f32 v59, v50, v51
    v_pk_mul_f32 v[52:53], v[48:49], v[32:33] op_sel:[0,0] op_sel_hi:[0,1]
    v_pk_mul_f32 v[54:55], v[50:51], v[34:35] op_sel:[0,0] op_sel_hi:[0,1]
    v_pk_fma_f32 v[48:49], v[48:49], v[32:33], v[52:53] op_sel:[1,1,0] op_sel_hi:[1,0,1] neg_lo:[0,1,0]
    v_pk_fma_f32 v[50:51], v[50:51], v[34:35], v[54:55] op_sel:[1,1,0] op_sel_hi:[1,0,1] neg_lo:[0,1,0]
    ds_write_b64 v2, v[58:59] offset:528
    v_cvt_pk_f16_f32 v56, v48, v49
    v_cvt_pk_f16_f32 v57, v50, v51
    v_pk_mul_f32 v[52:53], v[48:49], v[32:33] op_sel:[0,0] op_sel_hi:[0,1]
    v_pk_mul_f32 v[54:55], v[50:51], v[34:35] op_sel:[0,0] op_sel_hi:[0,1]
    v_pk_fma_f32 v[48:49], v[48:49], v[32:33], v[52:53] op_sel:[1,1,0] op_sel_hi:[1,0,1] neg_lo:[0,1,0]
    v_pk_fma_f32 v[50:51], v[50:51], v[34:35], v[54:55] op_sel:[1,1,0] op_sel_hi:[1,0,1] neg_lo:[0,1,0]
    ds_write_b64 v2, v[56:57] offset:1056
    v_cvt_pk_f16_f32 v58, v48, v49
    v_cvt_pk_f16_f32 v59, v50, v51
    v_pk_mul_f32 v[52:53], v[48:49], v[32:33] op_sel:[0,0] op_sel_hi:[0,1]
    v_pk_mul_f32 v[54:55], v[50:51], v[34:35] op_sel:[0,0] op_sel_hi:[0,1]
    v_pk_fma_f32 v[48:49], v[48:49], v[32:33], v[52:53] op_sel:[1,1,0] op_sel_hi:[1,0,1] neg_lo:[0,1,0]
    v_pk_fma_f32 v[50:51], v[50:51], v[34:35], v[54:55] op_sel:[1,1,0] op_sel_hi:[1,0,1] neg_lo:[0,1,0]
    ds_write_b64 v2, v[58:59] offset:1584
    v_cvt_pk_f16_f32 v56, v48, v49
    v_cvt_pk_f16_f32 v57, v50, v51
    v_pk_mul_f32 v[52:53], v[48:49], v[32:33] op_sel:[0,0] op_sel_hi:[0,1]
    v_pk_mul_f32 v[54:55], v[50:51], v[34:35] op_sel:[0,0] op_sel_hi:[0,1]
    v_pk_fma_f32 v[48:49], v[48:49], v[32:33], v[52:53] op_sel:[1,1,0] op_sel_hi:[1,0,1] neg_lo:[0,1,0]
    v_pk_fma_f32 v[50:51], v[50:51], v[34:35], v[54:55] op_sel:[1,1,0] op_sel_hi:[1,0,1] neg_lo:[0,1,0]
    ds_write_b64 v2, v[56:57] offset:2112
    v_cvt_pk_f16_f32 v58, v48, v49
    v_cvt_pk_f16_f32 v59, v50, v51
    v_pk_mul_f32 v[52:53], v[48:49], v[32:33] op_sel:[0,0] op_sel_hi:[0,1]
    v_pk_mul_f32 v[54:55], v[50:51], v[34:35] op_sel:[0,0] op_sel_hi:[0,1]
    v_pk_fma_f32 v[48:49], v[48:49], v[32:33], v[52:53] op_sel:[1,1,0] op_sel_hi:[1,0,1] neg_lo:[0,1,0]
    v_pk_fma_f32 v[50:51], v[50:51], v[34:35], v[54:55] op_sel:[1,1,0] op_sel_hi:[1,0,1] neg_lo:[0,1,0]
    ds_write_b64 v2, v[58:59] offset:2640
    v_cvt_pk_f16_f32 v56, v48, v49
    v_cvt_pk_f16_f32 v57, v50, v51
    v_pk_mul_f32 v[52:53], v[48:49], v[32:33] op_sel:[0,0] op_sel_hi:[0,1]
    v_pk_mul_f32 v[54:55], v[50:51], v[34:35] op_sel:[0,0] op_sel_hi:[0,1]
    v_pk_fma_f32 v[48:49], v[48:49], v[32:33], v[52:53] op_sel:[1,1,0] op_sel_hi:[1,0,1] neg_lo:[0,1,0]
    v_pk_fma_f32 v[50:51], v[50:51], v[34:35], v[54:55] op_sel:[1,1,0] op_sel_hi:[1,0,1] neg_lo:[0,1,0]
    ds_write_b64 v2, v[56:57] offset:3168
    v_cvt_pk_f16_f32 v58, v48, v49
    v_cvt_pk_f16_f32 v59, v50, v51
    v_pk_mul_f32 v[52:53], v[48:49], v[32:33] op_sel:[0,0] op_sel_hi:[0,1]
    v_pk_mul_f32 v[54:55], v[50:51], v[34:35] op_sel:[0,0] op_sel_hi:[0,1]
    v_pk_fma_f32 v[48:49], v[48:49], v[32:33], v[52:53] op_sel:[1,1,0] op_sel_hi:[1,0,1] neg_lo:[0,1,0]
    v_pk_fma_f32 v[50:51], v[50:51], v[34:35], v[54:55] op_sel:[1,1,0] op_sel_hi:[1,0,1] neg_lo:[0,1,0]
    ds_write_b64 v2, v[58:59] offset:3696
    s_mov_b32 exec_lo, 0xff00ff
    s_mov_b32 exec_hi, 0xff00ff
    ds_read_b128 v[64:67], v3 offset:0
    ds_read_b128 v[68:71], v3 offset:64
    ds_read_b128 v[72:75], v3 offset:128
    ds_read_b128 v[76:79], v3 offset:192
    ds_read_b128 v[80:83], v3 offset:256
    ds_read_b128 v[84:87], v3 offset:320
    ds_read_b128 v[88:91], v3 offset:384
    ds_read_b128 v[92:95], v3 offset:448
    s_mov_b64 exec, -1
    v_cvt_pk_f16_f32 v56, v48, v49
    v_cvt_pk_f16_f32 v57, v50, v51
    v_pk_mul_f32 v[52:53], v[48:49], v[32:33] op_sel:[0,0] op_sel_hi:[0,1]
    v_pk_mul_f32 v[54:55], v[50:51], v[34:35] op_sel:[0,0] op_sel_hi:[0,1]
    v_pk_fma_f32 v[48:49], v[48:49], v[32:33], v[52:53] op_sel:[1,1,0] op_sel_hi:[1,0,1] neg_lo:[0,1,0]
    v_pk_fma_f32 v[50:51], v[50:51], v[34:35], v[54:55] op_sel:[1,1,0] op_sel_hi:[1,0,1] neg_lo:[0,1,0]
    ds_write_b64 v2, v[56:57] offset:0
    v_cvt_pk_f16_f32 v58, v48, v49
    v_cvt_pk_f16_f32 v59, v50, v51
    v_pk_mul_f32 v[52:53], v[48:49], v[32:33] op_sel:[0,0] op_sel_hi:[0,1]
    v_pk_mul_f32 v[54:55], v[50:51], v[34:35] op_sel:[0,0] op_sel_hi:[0,1]
    v_pk_fma_f32 v[48:49], v[48:49], v[32:33], v[52:53] op_sel:[1,1,0] op_sel_hi:[1,0,1] neg_lo:[0,1,0]
    v_pk_fma_f32 v[50:51], v[50:51], v[34:35], v[54:55] op_sel:[1,1,0] op_sel_hi:[1,0,1] neg_lo:[0,1,0]
    ds_write_b64 v2, v[58:59] offset:528
    v_cvt_pk_f16_f32 v56, v48, v49
    v_cvt_pk_f16_f32 v57, v50, v51
    v_pk_mul_f32 v[52:53], v[48:49], v[32:33] op_sel:[0,0] op_sel_hi:[0,1]
    v_pk_mul_f32 v[54:55], v[50:51], v[34:35] op_sel:[0,0] op_sel_hi:[0,1]
    v_pk_fma_f32 v[48:49], v[48:49], v[32:33], v[52:53] op_sel:[1,1,0] op_sel_hi:[1,0,1] neg_lo:[0,1,0]
    v_pk_fma_f32 v[50:51], v[50:51], v[34:35], v[54:55] op_sel:[1,1,0] op_sel_hi:[1,0,1] neg_lo:[0,1,0]
    ds_write_b64 v2, v[56:57] offset:1056
    v_cvt_pk_f16_f32 v58, v48, v49
    v_cvt_pk_f16_f32 v59, v50, v51
    v_pk_mul_f32 v[52:53], v[48:49], v[32:33] op_sel:[0,0] op_sel_hi:[0,1]
    v_pk_mul_f32 v[54:55], v[50:51], v[34:35] op_sel:[0,0] op_sel_hi:[0,1]
    v_pk_fma_f32 v[48:49], v[48:49], v[32:33], v[52:53] op_sel:[1,1,0] op_sel_hi:[1,0,1] neg_lo:[0,1,0]
    v_pk_fma_f32 v[50:51], v[50:51], v[34:35], v[54:55] op_sel:[1,1,0] op_sel_hi:[1,0,1] neg_lo:[0,1,0]
    ds_write_b64 v2, v[58:59] offset:1584
    v_cvt_pk_f16_f32 v56, v48, v49
    v_cvt_pk_f16_f32 v57, v50, v51
    v_pk_mul_f32 v[52:53], v[48:49], v[32:33] op_sel:[0,0] op_sel_hi:[0,1]
    v_pk_mul_f32 v[54:55], v[50:51], v[34:35] op_sel:[0,0] op_sel_hi:[0,1]
    v_pk_fma_f32 v[48:49], v[48:49], v[32:33], v[52:53] op_sel:[1,1,0] op_sel_hi:[1,0,1] neg_lo:[0,1,0]
    v_pk_fma_f32 v[50:51], v[50:51], v[34:35], v[54:55] op_sel:[1,1,0] op_sel_hi:[1,0,1] neg_lo:[0,1,0]
    ds_write_b64 v2, v[56:57] offset:2112
    v_cvt_pk_f16_f32 v58, v48, v49
    v_cvt_pk_f16_f32 v59, v50, v51
    v_pk_mul_f32 v[52:53], v[48:49], v[32:33] op_sel:[0,0] op_sel_hi:[0,1]
    v_pk_mul_f32 v[54:55], v[50:51], v[34:35] op_sel:[0,0] op_sel_hi:[0,1]
    v_pk_fma_f32 v[48:49], v[48:49], v[32:33], v[52:53] op_sel:[1,1,0] op_sel_hi:[1,0,1] neg_lo:[0,1,0]
    v_pk_fma_f32 v[50:51], v[50:51], v[34:35], v[54:55] op_sel:[1,1,0] op_sel_hi:[1,0,1] neg_lo:[0,1,0]
    ds_write_b64 v2, v[58:59] offset:2640
    v_cvt_pk_f16_f32 v56, v48, v49
    v_cvt_pk_f16_f32 v57, v50, v51
    v_pk_mul_f32 v[52:53], v[48:49], v[32:33] op_sel:[0,0] op_sel_hi:[0,1]
    v_pk_mul_f32 v[54:55], v[50:51], v[34:35] op_sel:[0,0] op_sel_hi:[0,1]
    v_pk_fma_f32 v[48:49], v[48:49], v[32:33], v[52:53] op_sel:[1,1,0] op_sel_hi:[1,0,1] neg_lo:[0,1,0]
    v_pk_fma_f32 v[50:51], v[50:51], v[34:35], v[54:55] op_sel:[1,1,0] op_sel_hi:[1,0,1] neg_lo:[0,1,0]
    ds_write_b64 v2, v[56:57] offset:3168
    v_cvt_pk_f16_f32 v58, v48, v49
    v_cvt_pk_f16_f32 v59, v50, v51
    ds_write_b64 v2, v[58:59] offset:3696
    s_mov_b32 exec_lo, 0xff00ff00
    s_mov_b32 exec_hi, 0xff00ff00
    ds_read_b128 v[64:67], v3 offset:0
    ds_read_b128 v[68:71], v3 offset:64
    ds_read_b128 v[72:75], v3 offset:128
    ds_read_b128 v[76:79], v3 offset:192
    ds_read_b128 v[80:83], v3 offset:256
    ds_read_b128 v[84:87], v3 offset:320
    ds_read_b128 v[88:91], v3 offset:384
    ds_read_b128 v[92:95], v3 offset:448
    s_mov_b64 exec, -1
    v_cvt_pk_f16_f32 v56, v16, v17
    v_cvt_pk_f16_f32 v57, v18, v19
    v_pk_mul_f32 v[52:53], v[16:17], v[36:37] op_sel:[0,0] op_sel_hi:[0,1]
    v_pk_mul_f32 v[54:55], v[18:19], v[38:39] op_sel:[0,0] op_sel_hi:[0,1]
    v_pk_fma_f32 v[16:17], v[16:17], v[36:37], v[52:53] op_sel:[1,1,0] op_sel_hi:[1,0,1] neg_lo:[0,1,0]
    v_pk_fma_f32 v[18:19], v[18:19], v[38:39], v[54:55] op_sel:[1,1,0] op_sel_hi:[1,0,1] neg_lo:[0,1,0]
    ds_write_b64 v2, v[56:57] offset:0
    v_cvt_pk_f16_f32 v58, v16, v17
    v_cvt_pk_f16_f32 v59, v18, v19
    v_pk_mul_f32 v[52:53], v[16:17], v[36:37] op_sel:[0,0] op_sel_hi:[0,1]
    v_pk_mul_f32 v[54:55], v[18:19], v[38:39] op_sel:[0,0] op_sel_hi:[0,1]
    v_pk_fma_f32 v[16:17], v[16:17], v[36:37], v[52:53] op_sel:[1,1,0] op_sel_hi:[1,0,1] neg_lo:[0,1,0]
    v_pk_fma_f32 v[18:19], v[18:19], v[38:39], v[54:55] op_sel:[1,1,0] op_sel_hi:[1,0,1] neg_lo:[0,1,0]
    ds_write_b64 v2, v[58:59] offset:528
    v_cvt_pk_f16_f32 v56, v16, v17
    v_cvt_pk_f16_f32 v57, v18, v19
    v_pk_mul_f32 v[52:53], v[16:17], v[36:37] op_sel:[0,0] op_sel_hi:[0,1]
    v_pk_mul_f32 v[54:55], v[18:19], v[38:39] op_sel:[0,0] op_sel_hi:[0,1]
    v_pk_fma_f32 v[16:17], v[16:17], v[36:37], v[52:53] op_sel:[1,1,0] op_sel_hi:[1,0,1] neg_lo:[0,1,0]
    v_pk_fma_f32 v[18:19], v[18:19], v[38:39], v[54:55] op_sel:[1,1,0] op_sel_hi:[1,0,1] neg_lo:[0,1,0]
    ds_write_b64 v2, v[56:57] offset:1056
    v_cvt_pk_f16_f32 v58, v16, v17
    v_cvt_pk_f16_f32 v59, v18, v19
    v_pk_mul_f32 v[52:53], v[16:17], v[36:37] op_sel:[0,0] op_sel_hi:[0,1]
    v_pk_mul_f32 v[54:55], v[18:19], v[38:39] op_sel:[0,0] op_sel_hi:[0,1]
    v_pk_fma_f32 v[16:17], v[16:17], v[36:37], v[52:53] op_sel:[1,1,0] op_sel_hi:[1,0,1] neg_lo:[0,1,0]
    v_pk_fma_f32 v[18:19], v[18:19], v[38:39], v[54:55] op_sel:[1,1,0] op_sel_hi:[1,0,1] neg_lo:[0,1,0]
    ds_write_b64 v2, v[58:59] offset:1584
    v_cvt_pk_f16_f32 v56, v16, v17
    v_cvt_pk_f16_f32 v57, v18, v19
    v_pk_mul_f32 v[52:53], v[16:17], v[36:37] op_sel:[0,0] op_sel_hi:[0,1]
    v_pk_mul_f32 v[54:55], v[18:19], v[38:39] op_sel:[0,0] op_sel_hi:[0,1]
    v_pk_fma_f32 v[16:17], v[16:17], v[36:37], v[52:53] op_sel:[1,1,0] op_sel_hi:[1,0,1] neg_lo:[0,1,0]
    v_pk_fma_f32 v[18:19], v[18:19], v[38:39], v[54:55] op_sel:[1,1,0] op_sel_hi:[1,0,1] neg_lo:[0,1,0]
    ds_write_b64 v2, v[56:57] offset:2112
    v_cvt_pk_f16_f32 v58, v16, v17
    v_cvt_pk_f16_f32 v59, v18, v19
    v_pk_mul_f32 v[52:53], v[16:17], v[36:37] op_sel:[0,0] op_sel_hi:[0,1]
    v_pk_mul_f32 v[54:55], v[18:19], v[38:39] op_sel:[0,0] op_sel_hi:[0,1]
    v_pk_fma_f32 v[16:17], v[16:17], v[36:37], v[52:53] op_sel:[1,1,0] op_sel_hi:[1,0,1] neg_lo:[0,1,0]
    v_pk_fma_f32 v[18:19], v[18:19], v[38:39], v[54:55] op_sel:[1,1,0] op_sel_hi:[1,0,1] neg_lo:[0,1,0]
    ds_write_b64 v2, v[58:59] offset:2640
    v_cvt_pk_f16_f32 v56, v16, v17
    v_cvt_pk_f16_f32 v57, v18, v19
    v_pk_mul_f32 v[52:53], v[16:17], v[36:37] op_sel:[0,0] op_sel_hi:[0,1]
    v_pk_mul_f32 v[54:55], v[18:19], v[38:39] op_sel:[0,0] op_sel_hi:[0,1]
    v_pk_fma_f32 v[16:17], v[16:17], v[36:37], v[52:53] op_sel:[1,1,0] op_sel_hi:[1,0,1] neg_lo:[0,1,0]
    v_pk_fma_f32 v[18:19], v[18:19], v[38:39], v[54:55] op_sel:[1,1,0] op_sel_hi:[1,0,1] neg_lo:[0,1,0]
    ds_write_b64 v2, v[56:57] offset:3168
    v_cvt_pk_f16_f32 v58, v16, v17
    v_cvt_pk_f16_f32 v59, v18, v19
    v_pk_mul_f32 v[52:53], v[16:17], v[36:37] op_sel:[0,0] op_sel_hi:[0,1]
    v_pk_mul_f32 v[54:55], v[18:19], v[38:39] op_sel:[0,0] op_sel_hi:[0,1]
    v_pk_fma_f32 v[16:17], v[16:17], v[36:37], v[52:53] op_sel:[1,1,0] op_sel_hi:[1,0,1] neg_lo:[0,1,0]
    v_pk_fma_f32 v[18:19], v[18:19], v[38:39], v[54:55] op_sel:[1,1,0] op_sel_hi:[1,0,1] neg_lo:[0,1,0]
    ds_write_b64 v2, v[58:59] offset:3696
    s_mov_b32 exec_lo, 0xff00ff
    s_mov_b32 exec_hi, 0xff00ff
    ds_read_b128 v[96:99], v3 offset:0
    ds_read_b128 v[100:103], v3 offset:64
    ds_read_b128 v[104:107], v3 offset:128
    ds_read_b128 v[108:111], v3 offset:192
    ds_read_b128 v[112:115], v3 offset:256
    ds_read_b128 v[116:119], v3 offset:320
    ds_read_b128 v[120:123], v3 offset:384
    ds_read_b128 v[124:127], v3 offset:448
    s_mov_b64 exec, -1
    v_cvt_pk_f16_f32 v56, v16, v17
    v_cvt_pk_f16_f32 v57, v18, v19
    ds_write_b64 v2, v[56:57] offset:0
    s_mov_b32 exec_lo, 0xff00ff00
    s_mov_b32 exec_hi, 0xff00ff00
    ds_read_b128 v[96:99], v3 offset:0
    ds_read_b128 v[100:103], v3 offset:64
    ds_read_b128 v[104:107], v3 offset:128
    ds_read_b128 v[108:111], v3 offset:192
    ds_read_b128 v[112:115], v3 offset:256
    ds_read_b128 v[116:119], v3 offset:320
    ds_read_b128 v[120:123], v3 offset:384
    ds_read_b128 v[124:127], v3 offset:448
    s_mov_b64 exec, -1
    s_waitcnt lgkmcnt(0)
    v_mfma_f32_16x16x32_f16 v[168:171], v[96:99], v[64:67], v[168:171]
    v_mfma_f32_16x16x32_f16 v[168:171], v[100:103], v[68:71], v[168:171]
    v_mfma_f32_16x16x32_f16 v[168:171], v[104:107], v[72:75], v[168:171]
    v_mfma_f32_16x16x32_f16 v[168:171], v[108:111], v[76:79], v[168:171]
    v_mfma_f32_16x16x32_f16 v[168:171], v[112:115], v[80:83], v[168:171]
    v_mfma_f32_16x16x32_f16 v[168:171], v[116:119], v[84:87], v[168:171]
    v_mfma_f32_16x16x32_f16 v[168:171], v[120:123], v[88:91], v[168:171]
    v_mfma_f32_16x16x32_f16 v[168:171], v[124:127], v[92:95], v[168:171]
    v_lshlrev_b32 v8, 4, v4
    v_sub_u32 v8, s0, v8
    v_lshlrev_b32 v9, 10, v5
    v_sub_u32 v9, v8, v9
    v_lshlrev_b32 v10, 9, v5
    v_sub_u32 v10, v8, v10
    v_lshlrev_b32 v11, 8, v5
    v_sub_u32 v11, v8, v11
    v_lshrrev_b32 v6, 1, v5
    v_lshlrev_b32 v6, 8, v6
    v_and_b32 v7, 1, v5
    v_lshl_add_u32 v6, v7, 3, v6
    v_sub_u32 v8, v8, v6
    v_mul_f32 v168, v168, v22
    v_mul_f32 v169, v169, v22
    v_mul_f32 v170, v170, v22
    v_mul_f32 v171, v171, v22
    v_cvt_pk_bf16_f32 v64, v168, v168
    v_mov_b32 v65, v64
    v_cvt_pk_bf16_f32 v66, v169, v169
    v_mov_b32 v67, v66
    v_cvt_pk_bf16_f32 v68, v170, v170
    v_mov_b32 v69, v68
    v_cvt_pk_bf16_f32 v70, v171, v171
    v_mov_b32 v71, v70
    s_mov_b32 exec_lo, -1
    s_mov_b32 exec_hi, 1
    ds_write_b64 v9, v[64:65] offset:2064
    ds_write_b32 v9, v64 offset:2072
    s_mov_b32 exec_lo, 0xfffffffe
    ds_write_b16 v9, v64 offset:2076
    s_mov_b32 exec_lo, 0x55555554
    ds_write_b16 v9, v64 offset:2078
    s_mov_b32 exec_lo, 0x55555555
    ds_write_b16 v9, v64 offset:2062
    s_mov_b32 exec_lo, -1
    s_mov_b32 exec_hi, 0
    ds_write_b64 v9, v[66:67] offset:1808
    ds_write_b32 v9, v66 offset:1816
    ds_write_b16 v9, v66 offset:1820
    s_mov_b32 exec_lo, 0x55555555
    ds_write_b16 v9, v66 offset:1822
    ds_write_b16 v9, v66 offset:1806
    s_mov_b32 exec_lo, -1
    s_mov_b32 exec_hi, 0
    ds_write_b64 v9, v[68:69] offset:1552
    ds_write_b32 v9, v68 offset:1560
    ds_write_b16 v9, v68 offset:1564
    s_mov_b32 exec_lo, 0x55555555
    ds_write_b16 v9, v68 offset:1566
    ds_write_b16 v9, v68 offset:1550
    s_mov_b32 exec_lo, -1
    s_mov_b32 exec_hi, 0
    ds_write_b64 v9, v[70:71] offset:1296
    ds_write_b32 v9, v70 offset:1304
    ds_write_b16 v9, v70 offset:1308
    s_mov_b32 exec_lo, 0x55555555
    ds_write_b16 v9, v70 offset:1310
    ds_write_b16 v9, v70 offset:1294
    s_mov_b64 exec, -1
    v_lshlrev_b32 v1, 4, v0
    v_add_u32 v2, s0, v1
    ds_read_b128 v[64:67], v2 offset:0
    ds_read_b128 v[68:71], v2 offset:1024
    ds_read_b128 v[72:75], v2 offset:2048
    s_mul_i32 s64, s67, 2304
    s_add_u32 s64, s64, 41943040
    s_add_u32 s4, s62, s64
    s_addc_u32 s5, s63, 0
    s_mov_b32 s6, 2304
    s_mov_b32 s7, 0x20000
    s_waitcnt lgkmcnt(0)
    buffer_store_dwordx4 v[64:67], v1, s[4:7], 0 offen offset:0 sc1
    buffer_store_dwordx4 v[68:71], v1, s[4:7], 0 offen offset:1024 sc1
    buffer_store_dwordx4 v[72:75], v1, s[4:7], 0 offen offset:2048 sc1
    s_setpc_b64 s[70:71]
gated_mix__ssm_conv_s4d__mixer_gmlp__prompt_kernel_end:
.section .rodata,"a"
.p2align 6
.amdhsa_kernel gated_mix__ssm_conv_s4d__mixer_gmlp__prompt_kernel
  .amdhsa_next_free_vgpr 256
  .amdhsa_next_free_sgpr 102
  .amdhsa_accum_offset 256
  .amdhsa_group_segment_fixed_size 0
  .amdhsa_kernarg_size 128
  .amdhsa_user_sgpr_count 2
  .amdhsa_user_sgpr_kernarg_segment_ptr 1
  .amdhsa_system_sgpr_workgroup_id_x 1
.end_amdhsa_kernel
```
